```python
import torch

def _softmax(x, axis=-1):
    return torch.softmax(x, dim=axis)
def _gelu(x):
    return torch.nn.functional.gelu(x, approximate="tanh")
def _silu(x):
    return torch.nn.functional.silu(x)
def _sigmoid(x):
    return torch.sigmoid(x)
def _layernorm(x, axis=-1, eps=1e-5):
    m = x.mean(dim=axis, keepdim=True)
    v = x.var(dim=axis, keepdim=True, unbiased=False)
    return (x - m) / torch.sqrt(v + eps)
def _scatter_add(tgt, idx, src, axis=0):
    return tgt.clone().index_add_(axis, idx, src)
def _segment_sum(src, seg, n):
    out = torch.zeros((n,) + src.shape[1:], dtype=src.dtype)
    return out.index_add_(0, seg, src)
def _pad(x, pw):
    flat = tuple(v for pair in reversed(pw) for v in pair)
    return torch.nn.functional.pad(x, flat)

kernel_name = 'sequential_preLN__ssm_conv_h3__glu_gated_bilinear__prompt'

def setup_inputs():

    _w = (lambda a: (lambda t: t.to(torch.bfloat16) if t.is_floating_point() else t)(torch.as_tensor(a)))
    def _A_setup():
        B, S, D = 1, 2048, 640
        ks = 4
        return {
            "q": _w((lambda *s: torch.randn(*s, dtype=torch.bfloat16) * 0.05)(B, S, D)),
            "k": _w((lambda *s: torch.randn(*s, dtype=torch.bfloat16) * 0.2)(B, S, D)),
            "v": _w((lambda *s: torch.randn(*s, dtype=torch.bfloat16) * 0.2)(B, S, D)),
            "shift_k": _w((lambda *s: torch.randn(*s, dtype=torch.bfloat16) * 0.2)(D, ks) * 0.5),
            "ssm_k": _w((lambda *s: torch.randn(*s, dtype=torch.bfloat16) * 0.4)(D, S) * (1.0 / S ** 0.5)),
            "ssm_D": _w((lambda *s: torch.randn(*s, dtype=torch.bfloat16) * 0.2)(D)),
        }
    _A_in = _A_setup()

    def _B_setup():
        B, S, D, F = 1, 2048, 640, 1536
        return {
            "x": _w((lambda *s: torch.randn(*s, dtype=torch.bfloat16) * 0.05)(B, S, D)),
            "w_gate": _w((lambda *s: torch.randn(*s, dtype=torch.bfloat16) * 0.2)(D, F) * (D ** -0.5)),
            "w_up": _w((lambda *s: torch.randn(*s, dtype=torch.bfloat16) * 0.2)(D, F) * (D ** -0.5)),
            "w_down": _w((lambda *s: torch.randn(*s, dtype=torch.bfloat16) * 0.2)(F, D) * (F ** -0.5)),
        }
    _B_in = _B_setup()

    return {
        "A_q": _A_in["q"],
        "A_k": _A_in["k"],
        "A_v": _A_in["v"],
        "A_shift_k": _A_in["shift_k"],
        "A_ssm_k": _A_in["ssm_k"],
        "A_ssm_D": _A_in["ssm_D"],
        "B_x": _B_in["x"],
        "B_w_gate": _B_in["w_gate"],
        "B_w_up": _B_in["w_up"],
        "B_w_down": _B_in["w_down"],
    }

def reference(A_q, A_k, A_v, A_shift_k, A_ssm_k, A_ssm_D, B_x, B_w_gate, B_w_up, B_w_down):
    def _A_ref(q, k, v, shift_k, ssm_k, ssm_D):
        B, S, D = q.shape
        ks = shift_k.shape[-1]
        k_pad = _pad(k, ((0, 0), (ks - 1, 0), (0, 0)))
        k_shift = torch.zeros_like(k)
        for t in range(ks):
            k_shift = k_shift + k_pad[:, t:t + S, :] * shift_k[:, ks - 1 - t][None, None, :]
        kv = k_shift * v
        L = 2 * S
        kv_pad = _pad(kv, ((0, 0), (0, S), (0, 0)))
        kf_pad = _pad(ssm_k, ((0, 0), (0, S)))
        kv_f = (lambda x, axes=(-2,-1): torch.fft.rfft2(x.float(), dim=axes))(kv_pad[:, None, :, :], axes=(1, 2))
        kf_f = (lambda x, axes=(-2,-1): torch.fft.rfft2(x.float(), dim=axes))(kf_pad[:, None, :], axes=(1, 2))
        kf_f = (lambda x, *d: x.permute(*d))(kf_f, 1, 2, 0)
        y_f = kv_f * kf_f[None, :, :, :]
        y = (lambda x, s, axes=(-2,-1): torch.fft.irfft2(x, s=s, dim=axes).to(torch.bfloat16))(y_f, (1, L), axes=(1, 2))[:, 0, :S, :]
        y = y + kv * ssm_D[None, None, :]
        return q * y

    def _B_ref(x, w_gate, w_up, w_down):
        g = torch.einsum("bsd,df->bsf", x, w_gate)
        u = torch.einsum("bsd,df->bsf", x, w_up)
        h = g * u
        return torch.einsum("bsf,fd->bsd", h, w_down)

    x = A_q
    h = x + _A_ref(_layernorm(x, axis=-1), A_k, A_v, A_shift_k, A_ssm_k, A_ssm_D)
    h2 = h + _B_ref(_layernorm(h, axis=-1), B_w_gate, B_w_up, B_w_down)
    return h2
```

```asm
; @launch grid=(256,1,1) block=(256,1,1) lds=163840
.amdgcn_target "amdgcn-amd-amdhsa--gfx950"
.text
.globl sequential_preLN__ssm_conv_h3__glu_gated_bilinear__prompt_kernel
.p2align 8
.type sequential_preLN__ssm_conv_h3__glu_gated_bilinear__prompt_kernel,@function
sequential_preLN__ssm_conv_h3__glu_gated_bilinear__prompt_kernel:
    s_cmp_ge_u32 s2, 256
    s_cbranch_scc1 FZ_END
    s_load_dwordx4 s[4:7], s[0:1], 0
    s_load_dwordx4 s[8:11], s[0:1], 16
    s_load_dwordx4 s[12:15], s[0:1], 32
    s_load_dwordx2 s[56:57], s[0:1], 96
    s_load_dwordx4 s[40:43], s[0:1], 56
    s_load_dwordx2 s[44:45], s[0:1], 72
    v_lshrrev_b32 v3, 6, v0
    v_and_b32 v1, 15, v0
    v_lshrrev_b32 v2, 4, v0
    v_readfirstlane_b32 s3, v3
    s_mov_b32 s61, 20000
    s_cmp_ge_u32 s2, 208
    s_cbranch_scc1 FZ_STATS
    s_cmp_ge_u32 s2, 160
    s_cbranch_scc1 FZ_AROLE
    s_and_b32 s32, s2, 15
    s_lshr_b32 s33, s2, 4
    s_mul_i32 s34, s32, 128*1280
    s_lshl_b32 s36, s33, 7
    s_add_u32 s34, s34, s36
    v_mul_u32_u24 v3, 8*1280, v2
    v_lshlrev_b32 v4, 3, v1
    v_add3_u32 v3, v3, v4, s34
    v_add_u32 v4, 4*1280, v3
    v_subrev_u32 v5, 3*1280, v3
    s_lshl_b32 s36, s33, 9
    v_lshlrev_b32 v6, 5, v1
    v_add_u32 v6, s36, v6
    s_lshl_b32 s35, s2, 2
    s_add_u32 s35, s35, s3
    s_lshl_b32 s36, s35, 12
    s_lshr_b32 s37, s35, 1
    s_lshl_b32 s37, s37, 2
    s_waitcnt lgkmcnt(0)
    s_mov_b32 s20, s6
    s_mov_b32 s21, s7
    s_mov_b32 s22, 2621440
    s_mov_b32 s23, 0x00020000
    s_mov_b32 s28, s10
    s_mov_b32 s29, s11
    s_mov_b32 s30, 5120
    s_mov_b32 s31, 0x00020000
    buffer_load_dwordx4 v[62:65], v6, s[28:31], 0 offen
    buffer_load_dwordx4 v[66:69], v6, s[28:31], 0 offen offset:16
    buffer_load_dwordx2 v[8:9], v5, s[20:23], 0 offen offset:0 nt
    buffer_load_dwordx2 v[10:11], v5, s[20:23], 0 offen offset:1280 nt
    buffer_load_dwordx2 v[12:13], v5, s[20:23], 0 offen offset:2560 nt
    buffer_load_dwordx2 v[14:15], v3, s[20:23], 0 offen offset:0 nt
    buffer_load_dwordx2 v[16:17], v3, s[20:23], 0 offen offset:1280 nt
    buffer_load_dwordx2 v[18:19], v3, s[20:23], 0 offen offset:2560 nt
    buffer_load_dwordx2 v[20:21], v3, s[20:23], 0 offen offset:3840 nt
    buffer_load_dwordx2 v[22:23], v4, s[20:23], 0 offen offset:0 nt
    buffer_load_dwordx2 v[24:25], v4, s[20:23], 0 offen offset:1280 nt
    buffer_load_dwordx2 v[26:27], v4, s[20:23], 0 offen offset:2560 nt
    buffer_load_dwordx2 v[28:29], v4, s[20:23], 0 offen offset:3840 nt
    s_mov_b32 s24, s8
    s_mov_b32 s25, s9
    s_mov_b32 s26, 2621440
    s_mov_b32 s27, 0x00020000
    buffer_load_dwordx2 v[30:31], v3, s[24:27], 0 offen offset:0 nt
    buffer_load_dwordx2 v[32:33], v3, s[24:27], 0 offen offset:1280 nt
    buffer_load_dwordx2 v[34:35], v3, s[24:27], 0 offen offset:2560 nt
    buffer_load_dwordx2 v[36:37], v3, s[24:27], 0 offen offset:3840 nt
    buffer_load_dwordx2 v[38:39], v4, s[24:27], 0 offen offset:0 nt
    buffer_load_dwordx2 v[40:41], v4, s[24:27], 0 offen offset:1280 nt
    buffer_load_dwordx2 v[42:43], v4, s[24:27], 0 offen offset:2560 nt
    buffer_load_dwordx2 v[44:45], v4, s[24:27], 0 offen offset:3840 nt
    s_mov_b32 s16, s4
    s_mov_b32 s17, s5
    s_mov_b32 s18, 2621440
    s_mov_b32 s19, 0x00020000
    buffer_load_dwordx2 v[46:47], v3, s[16:19], 0 offen offset:0 nt
    buffer_load_dwordx2 v[48:49], v3, s[16:19], 0 offen offset:1280 nt
    buffer_load_dwordx2 v[50:51], v3, s[16:19], 0 offen offset:2560 nt
    buffer_load_dwordx2 v[52:53], v3, s[16:19], 0 offen offset:3840 nt
    buffer_load_dwordx2 v[54:55], v4, s[16:19], 0 offen offset:0 nt
    buffer_load_dwordx2 v[56:57], v4, s[16:19], 0 offen offset:1280 nt
    buffer_load_dwordx2 v[58:59], v4, s[16:19], 0 offen offset:2560 nt
    buffer_load_dwordx2 v[60:61], v4, s[16:19], 0 offen offset:3840 nt
    s_mov_b32 s58, 25165824
    s_mov_b32 s59, 0x00020000
    s_mov_b32 s60, 24641536
    s_load_dword s60, s[56:57], s60
    s_load_dword s47, s[14:15], s37
    s_add_u32 s48, s12, s36
    s_addc_u32 s49, s13, 0
    s_mul_i32 s46, s3, 21248
    s_add_u32 s46, s46, 78848
    v_and_b32 v124, 63, v0
    v_lshlrev_b32 v124, 4, v124
    v_add_u32 v125, 2, v124
    v_add_u32 v126, 4, v124
    v_add_u32 v127, 6, v124
    s_mov_b32 s50, 4096
    s_mov_b32 s51, 0x00020000
    s_mov_b32 s52, s48
    s_mov_b32 s53, s49
    s_mov_b32 s54, 4094
    s_mov_b32 s55, 0x00020000
    s_lshl_b32 s36, s33, 18
    s_lshl_b32 s37, s32, 8
    s_add_u32 s36, s36, s37
    v_lshlrev_b32 v6, 14, v1
    v_lshlrev_b32 v7, 4, v2
    v_add3_u32 v6, v6, v7, s36
    v_add_u32 v7, 0x2000, v6
    s_mov_b32 s38, 0xffff0000
    s_mov_b32 s39, 2621440
    s_mov_b32 s40, 0x05040100
    s_mov_b32 s41, 0x07060302
    s_mov_b32 s42, 4096
    s_mov_b32 s43, 2625536
    s_waitcnt vmcnt(27)
    v_lshlrev_b32 v70, 16, v62
    v_and_b32 v74, s38, v62
    v_lshlrev_b32 v78, 16, v63
    v_and_b32 v82, s38, v63
    v_lshlrev_b32 v71, 16, v64
    v_and_b32 v75, s38, v64
    v_lshlrev_b32 v79, 16, v65
    v_and_b32 v83, s38, v65
    v_lshlrev_b32 v72, 16, v66
    v_and_b32 v76, s38, v66
    v_lshlrev_b32 v80, 16, v67
    v_and_b32 v84, s38, v67
    v_lshlrev_b32 v73, 16, v68
    v_and_b32 v77, s38, v68
    v_lshlrev_b32 v81, 16, v69
    v_and_b32 v85, s38, v69
    s_waitcnt vmcnt(16)
    v_lshlrev_b32 v86, 16, v8
    v_and_b32 v87, s38, v8
    v_lshlrev_b32 v88, 16, v10
    v_and_b32 v89, s38, v10
    v_lshlrev_b32 v90, 16, v12
    v_and_b32 v91, s38, v12
    v_lshlrev_b32 v92, 16, v14
    v_and_b32 v93, s38, v14
    v_lshlrev_b32 v94, 16, v16
    v_and_b32 v95, s38, v16
    v_lshlrev_b32 v96, 16, v18
    v_and_b32 v97, s38, v18
    v_lshlrev_b32 v98, 16, v20
    v_and_b32 v99, s38, v20
    v_lshlrev_b32 v100, 16, v22
    v_and_b32 v101, s38, v22
    v_lshlrev_b32 v102, 16, v24
    v_and_b32 v103, s38, v24
    v_lshlrev_b32 v104, 16, v26
    v_and_b32 v105, s38, v26
    v_lshlrev_b32 v106, 16, v28
    v_and_b32 v107, s38, v28
    v_pk_mul_f32 v[108:109], v[92:93], v[70:71]
    v_pk_fma_f32 v[108:109], v[90:91], v[74:75], v[108:109]
    v_pk_fma_f32 v[108:109], v[88:89], v[78:79], v[108:109]
    v_pk_fma_f32 v[108:109], v[86:87], v[82:83], v[108:109]
    v_pk_mul_f32 v[110:111], v[94:95], v[70:71]
    v_pk_fma_f32 v[110:111], v[92:93], v[74:75], v[110:111]
    v_pk_fma_f32 v[110:111], v[90:91], v[78:79], v[110:111]
    v_pk_fma_f32 v[110:111], v[88:89], v[82:83], v[110:111]
    v_pk_mul_f32 v[112:113], v[96:97], v[70:71]
    v_pk_fma_f32 v[112:113], v[94:95], v[74:75], v[112:113]
    v_pk_fma_f32 v[112:113], v[92:93], v[78:79], v[112:113]
    v_pk_fma_f32 v[112:113], v[90:91], v[82:83], v[112:113]
    v_pk_mul_f32 v[114:115], v[98:99], v[70:71]
    v_pk_fma_f32 v[114:115], v[96:97], v[74:75], v[114:115]
    v_pk_fma_f32 v[114:115], v[94:95], v[78:79], v[114:115]
    v_pk_fma_f32 v[114:115], v[92:93], v[82:83], v[114:115]
    v_pk_mul_f32 v[116:117], v[100:101], v[70:71]
    v_pk_fma_f32 v[116:117], v[98:99], v[74:75], v[116:117]
    v_pk_fma_f32 v[116:117], v[96:97], v[78:79], v[116:117]
    v_pk_fma_f32 v[116:117], v[94:95], v[82:83], v[116:117]
    v_pk_mul_f32 v[118:119], v[102:103], v[70:71]
    v_pk_fma_f32 v[118:119], v[100:101], v[74:75], v[118:119]
    v_pk_fma_f32 v[118:119], v[98:99], v[78:79], v[118:119]
    v_pk_fma_f32 v[118:119], v[96:97], v[82:83], v[118:119]
    v_pk_mul_f32 v[120:121], v[104:105], v[70:71]
    v_pk_fma_f32 v[120:121], v[102:103], v[74:75], v[120:121]
    v_pk_fma_f32 v[120:121], v[100:101], v[78:79], v[120:121]
    v_pk_fma_f32 v[120:121], v[98:99], v[82:83], v[120:121]
    v_pk_mul_f32 v[122:123], v[106:107], v[70:71]
    v_pk_fma_f32 v[122:123], v[104:105], v[74:75], v[122:123]
    v_pk_fma_f32 v[122:123], v[102:103], v[78:79], v[122:123]
    v_pk_fma_f32 v[122:123], v[100:101], v[82:83], v[122:123]
    s_waitcnt vmcnt(8)
    v_lshlrev_b32 v86, 16, v30
    v_and_b32 v87, s38, v30
    v_lshlrev_b32 v88, 16, v32
    v_and_b32 v89, s38, v32
    v_lshlrev_b32 v90, 16, v34
    v_and_b32 v91, s38, v34
    v_lshlrev_b32 v92, 16, v36
    v_and_b32 v93, s38, v36
    v_lshlrev_b32 v94, 16, v38
    v_and_b32 v95, s38, v38
    v_lshlrev_b32 v96, 16, v40
    v_and_b32 v97, s38, v40
    v_lshlrev_b32 v98, 16, v42
    v_and_b32 v99, s38, v42
    v_lshlrev_b32 v100, 16, v44
    v_and_b32 v101, s38, v44
    v_pk_mul_f32 v[108:109], v[108:109], v[86:87]
    v_pk_mul_f32 v[110:111], v[110:111], v[88:89]
    v_pk_mul_f32 v[112:113], v[112:113], v[90:91]
    v_pk_mul_f32 v[114:115], v[114:115], v[92:93]
    v_pk_mul_f32 v[116:117], v[116:117], v[94:95]
    v_pk_mul_f32 v[118:119], v[118:119], v[96:97]
    v_pk_mul_f32 v[120:121], v[120:121], v[98:99]
    v_pk_mul_f32 v[122:123], v[122:123], v[100:101]
    v_cvt_pk_bf16_f32 v62, v122, v120
    v_cvt_pk_bf16_f32 v63, v118, v116
    v_cvt_pk_bf16_f32 v64, v114, v112
    v_cvt_pk_bf16_f32 v65, v110, v108
    buffer_store_dwordx4 v[62:65], v6, s[56:59], 0 offen sc1
    v_cvt_pk_bf16_f32 v66, v123, v121
    v_cvt_pk_bf16_f32 v67, v119, v117
    v_cvt_pk_bf16_f32 v68, v115, v113
    v_cvt_pk_bf16_f32 v69, v111, v109
    buffer_store_dwordx4 v[66:69], v6, s[56:59], s42 offen sc1
    s_nop 1
    v_lshlrev_b32 v86, 16, v9
    v_and_b32 v87, s38, v9
    v_lshlrev_b32 v88, 16, v11
    v_and_b32 v89, s38, v11
    v_lshlrev_b32 v90, 16, v13
    v_and_b32 v91, s38, v13
    v_lshlrev_b32 v92, 16, v15
    v_and_b32 v93, s38, v15
    v_lshlrev_b32 v94, 16, v17
    v_and_b32 v95, s38, v17
    v_lshlrev_b32 v96, 16, v19
    v_and_b32 v97, s38, v19
    v_lshlrev_b32 v98, 16, v21
    v_and_b32 v99, s38, v21
    v_lshlrev_b32 v100, 16, v23
    v_and_b32 v101, s38, v23
    v_lshlrev_b32 v102, 16, v25
    v_and_b32 v103, s38, v25
    v_lshlrev_b32 v104, 16, v27
    v_and_b32 v105, s38, v27
    v_lshlrev_b32 v106, 16, v29
    v_and_b32 v107, s38, v29
    v_pk_mul_f32 v[108:109], v[92:93], v[72:73]
    v_pk_fma_f32 v[108:109], v[90:91], v[76:77], v[108:109]
    v_pk_fma_f32 v[108:109], v[88:89], v[80:81], v[108:109]
    v_pk_fma_f32 v[108:109], v[86:87], v[84:85], v[108:109]
    v_pk_mul_f32 v[110:111], v[94:95], v[72:73]
    v_pk_fma_f32 v[110:111], v[92:93], v[76:77], v[110:111]
    v_pk_fma_f32 v[110:111], v[90:91], v[80:81], v[110:111]
    v_pk_fma_f32 v[110:111], v[88:89], v[84:85], v[110:111]
    v_pk_mul_f32 v[112:113], v[96:97], v[72:73]
    v_pk_fma_f32 v[112:113], v[94:95], v[76:77], v[112:113]
    v_pk_fma_f32 v[112:113], v[92:93], v[80:81], v[112:113]
    v_pk_fma_f32 v[112:113], v[90:91], v[84:85], v[112:113]
    v_pk_mul_f32 v[114:115], v[98:99], v[72:73]
    v_pk_fma_f32 v[114:115], v[96:97], v[76:77], v[114:115]
    v_pk_fma_f32 v[114:115], v[94:95], v[80:81], v[114:115]
    v_pk_fma_f32 v[114:115], v[92:93], v[84:85], v[114:115]
    v_pk_mul_f32 v[116:117], v[100:101], v[72:73]
    v_pk_fma_f32 v[116:117], v[98:99], v[76:77], v[116:117]
    v_pk_fma_f32 v[116:117], v[96:97], v[80:81], v[116:117]
    v_pk_fma_f32 v[116:117], v[94:95], v[84:85], v[116:117]
    v_pk_mul_f32 v[118:119], v[102:103], v[72:73]
    v_pk_fma_f32 v[118:119], v[100:101], v[76:77], v[118:119]
    v_pk_fma_f32 v[118:119], v[98:99], v[80:81], v[118:119]
    v_pk_fma_f32 v[118:119], v[96:97], v[84:85], v[118:119]
    v_pk_mul_f32 v[120:121], v[104:105], v[72:73]
    v_pk_fma_f32 v[120:121], v[102:103], v[76:77], v[120:121]
    v_pk_fma_f32 v[120:121], v[100:101], v[80:81], v[120:121]
    v_pk_fma_f32 v[120:121], v[98:99], v[84:85], v[120:121]
    v_pk_mul_f32 v[122:123], v[106:107], v[72:73]
    v_pk_fma_f32 v[122:123], v[104:105], v[76:77], v[122:123]
    v_pk_fma_f32 v[122:123], v[102:103], v[80:81], v[122:123]
    v_pk_fma_f32 v[122:123], v[100:101], v[84:85], v[122:123]
    v_lshlrev_b32 v86, 16, v31
    v_and_b32 v87, s38, v31
    v_lshlrev_b32 v88, 16, v33
    v_and_b32 v89, s38, v33
    v_lshlrev_b32 v90, 16, v35
    v_and_b32 v91, s38, v35
    v_lshlrev_b32 v92, 16, v37
    v_and_b32 v93, s38, v37
    v_lshlrev_b32 v94, 16, v39
    v_and_b32 v95, s38, v39
    v_lshlrev_b32 v96, 16, v41
    v_and_b32 v97, s38, v41
    v_lshlrev_b32 v98, 16, v43
    v_and_b32 v99, s38, v43
    v_lshlrev_b32 v100, 16, v45
    v_and_b32 v101, s38, v45
    v_pk_mul_f32 v[108:109], v[108:109], v[86:87]
    v_pk_mul_f32 v[110:111], v[110:111], v[88:89]
    v_pk_mul_f32 v[112:113], v[112:113], v[90:91]
    v_pk_mul_f32 v[114:115], v[114:115], v[92:93]
    v_pk_mul_f32 v[116:117], v[116:117], v[94:95]
    v_pk_mul_f32 v[118:119], v[118:119], v[96:97]
    v_pk_mul_f32 v[120:121], v[120:121], v[98:99]
    v_pk_mul_f32 v[122:123], v[122:123], v[100:101]
    v_cvt_pk_bf16_f32 v62, v122, v120
    v_cvt_pk_bf16_f32 v63, v118, v116
    v_cvt_pk_bf16_f32 v64, v114, v112
    v_cvt_pk_bf16_f32 v65, v110, v108
    buffer_store_dwordx4 v[62:65], v7, s[56:59], 0 offen sc1
    v_cvt_pk_bf16_f32 v66, v123, v121
    v_cvt_pk_bf16_f32 v67, v119, v117
    v_cvt_pk_bf16_f32 v68, v115, v113
    v_cvt_pk_bf16_f32 v69, v111, v109
    buffer_store_dwordx4 v[66:69], v7, s[56:59], s42 offen sc1
    s_waitcnt vmcnt(4)
    v_perm_b32 v86, v48, v46, s40
    v_perm_b32 v87, v52, v50, s40
    v_perm_b32 v88, v56, v54, s40
    v_perm_b32 v89, v60, v58, s40
    buffer_store_dwordx4 v[86:89], v6, s[56:59], s39 offen sc1
    v_perm_b32 v90, v48, v46, s41
    v_perm_b32 v91, v52, v50, s41
    v_perm_b32 v92, v56, v54, s41
    v_perm_b32 v93, v60, v58, s41
    buffer_store_dwordx4 v[90:93], v6, s[56:59], s43 offen sc1
    v_perm_b32 v94, v49, v47, s40
    v_perm_b32 v95, v53, v51, s40
    v_perm_b32 v96, v57, v55, s40
    v_perm_b32 v97, v61, v59, s40
    buffer_store_dwordx4 v[94:97], v7, s[56:59], s39 offen sc1
    v_perm_b32 v98, v49, v47, s41
    v_perm_b32 v99, v53, v51, s41
    v_perm_b32 v100, v57, v55, s41
    v_perm_b32 v101, v61, v59, s41
    buffer_store_dwordx4 v[98:101], v7, s[56:59], s43 offen sc1
    s_waitcnt lgkmcnt(0)
    s_mul_i32 s60, s60, 1664525
    s_add_u32 s60, s60, 1013904223
    v_cmp_eq_u32 vcc, 0, v0
    v_mov_b32 v11, 0x80000000
    v_and_b32 v0, 63, v0
    v_cndmask_b32 v11, v11, 0, vcc
    v_and_b32 v6, 15, v0
    v_lshrrev_b32 v7, 4, v0
    v_mov_b32 v8, 0
    v_mov_b32 v9, 0
    v_lshlrev_b32 v10, 3, v0
    v_add_u32 v10, s46, v10
    ds_write_b64 v10, v[8:9] offset:16640
    s_mov_b64 exec, 15
    ds_write_b64 v10, v[8:9]
    s_mov_b64 exec, -1
    v_add_u32 v1, 1, v6
    v_and_b32 v1, 3, v1
    v_sub_u32 v2, v6, v1
    v_lshlrev_b32 v8, 3, v7
    v_sub_u32 v2, v2, v8
    v_add_u32 v2, 25, v2
    v_lshlrev_b32 v2, 1, v2
    v_mul_u32_u24 v1, 4160, v1
    v_add3_u32 v1, v1, v2, s46
    v_sub_u32 v16, v6, v8
    v_add_u32 v16, 25, v16
    v_lshlrev_b32 v16, 1, v16
    v_add_u32 v16, s46, v16
    v_lshlrev_b32 v2, 5, v6
    v_lshl_add_u32 v4, v7, 3, v2
    v_lshlrev_b32 v5, 1, v4
    v_lshl_add_u32 v2, v7, 4, v2
    s_add_u32 s36, s46, 16672
    v_add_u32 v2, s36, v2
    s_and_b32 s37, s35, 1
    s_lshl_b32 s37, s37, 4
    s_lshr_b32 s47, s47, s37
    s_and_b32 s47, s47, 0xffff
    v_sub_u32 v8, v8, v6
    v_subrev_u32 v8, 9, v8
    v_and_b32 v9, 1, v8
    v_lshlrev_b32 v9, 4, v9
    v_lshlrev_b32 v9, v9, s47
    v_ashrrev_i32 v8, 1, v8
    v_mov_b32 v3, s60
    s_lshl_b32 s34, s2, 7
    s_add_u32 s33, s34, 24645632
    s_waitcnt vmcnt(0)
    s_barrier
    buffer_store_dword v3, v11, s[56:59], s33 offen sc1
    s_add_u32 m0, s46, 32
    s_nop 0
    buffer_load_dwordx4 v124, s[48:51], 0 offen offset:0 lds
    buffer_load_dwordx4 v124, s[48:51], 0 offen offset:1024 lds
    buffer_load_dwordx4 v124, s[48:51], 0 offen offset:2048 lds
    buffer_load_dwordx4 v124, s[48:51], 0 offen offset:3072 lds
    s_add_u32 m0, s46, 4192
    s_nop 0
    buffer_load_dwordx4 v125, s[52:55], 0 offen offset:0 lds
    buffer_load_dwordx4 v125, s[52:55], 0 offen offset:1024 lds
    buffer_load_dwordx4 v125, s[52:55], 0 offen offset:2048 lds
    buffer_load_dwordx4 v125, s[52:55], 0 offen offset:3072 lds
    s_add_u32 m0, s46, 8352
    s_nop 0
    buffer_load_dwordx4 v126, s[48:51], 0 offen offset:0 lds
    buffer_load_dwordx4 v126, s[48:51], 0 offen offset:1024 lds
    buffer_load_dwordx4 v126, s[48:51], 0 offen offset:2048 lds
    buffer_load_dwordx4 v126, s[48:51], 0 offen offset:3072 lds
    s_add_u32 m0, s46, 12512
    s_nop 0
    buffer_load_dwordx4 v127, s[52:55], 0 offen offset:0 lds
    buffer_load_dwordx4 v127, s[52:55], 0 offen offset:1024 lds
    buffer_load_dwordx4 v127, s[52:55], 0 offen offset:2048 lds
    buffer_load_dwordx4 v127, s[52:55], 0 offen offset:3072 lds
    v_cmp_eq_u32 vcc, 0, v8
    s_nop 1
    v_cndmask_b32 v12, 0, v9, vcc
    v_cmp_eq_u32 vcc, 1, v8
    s_nop 1
    v_cndmask_b32 v13, 0, v9, vcc
    v_cmp_eq_u32 vcc, 2, v8
    s_nop 1
    v_cndmask_b32 v14, 0, v9, vcc
    v_cmp_eq_u32 vcc, 3, v8
    s_nop 1
    v_cndmask_b32 v15, 0, v9, vcc
    v_and_b32 v8, 1, v7
    v_lshlrev_b32 v8, 2, v8
    v_lshrrev_b32 v9, 2, v6
    v_add_u32 v8, v8, v9
    v_mul_u32_u24 v10, 81920, v8
    v_and_b32 v8, 3, v6
    v_lshl_add_u32 v10, v8, 5, v10
    v_lshrrev_b32 v8, 1, v7
    v_lshl_add_u32 v10, v8, 4, v10
    s_lshl_b32 s40, s35, 7
    s_add_u32 s40, s40, 6291456
    s_add_u32 s41, s40, 655360
    s_add_u32 s42, s40, 1310720
    s_add_u32 s43, s40, 1966080
    s_and_b32 s32, s2, 0xf0
    v_cmp_gt_u32 vcc, 16, v0
    v_mov_b32 v17, s32
    v_mov_b32 v8, 192
    v_cndmask_b32 v17, v8, v17, vcc
    v_add_u32 v17, v17, v0
    v_lshlrev_b32 v17, 7, v17
    s_mov_b32 s32, 24645632
    s_lshl_b32 s36, s35, 12
    s_add_u32 s37, s36, 2621440
    s_lshl_b32 s44, s3, 12
    s_add_u32 s45, s44, 5242880
    s_add_u32 s48, s34, 24707072
    s_add_u32 s49, s34, 24739840
    v_lshlrev_b32 v3, 4, v0
    s_bfe_u32 s20, s2, 0x20001
    s_lshl_b32 s20, s20, 2
    s_bfe_u32 s21, s2, 0x20003
    s_add_u32 s20, s20, s21
    s_and_b32 s21, s2, 1
    s_lshl_b32 s21, s21, 3
    s_lshr_b32 s22, s2, 5
    s_add_u32 s21, s21, s22
    s_lshl_b32 s22, s21, 2
    s_add_u32 s22, s22, s3
    s_mul_i32 s24, s22, 30720
    s_add_u32 s24, s24, 9437184
    s_add_u32 s25, s24, 4096
    s_add_u32 s26, s24, 8192
    s_add_u32 s27, s24, 1966080
    s_add_u32 s28, s25, 1966080
    s_add_u32 s29, s26, 1966080
    s_mov_b32 s30, 24666112
    s_lshr_b32 s23, s2, 7
    s_lshl_b32 s31, s3, 3
    s_add_u32 s23, s23, s31
    s_lshl_b32 s23, s23, 7
    s_add_u32 s23, s23, 24690688
    s_lshr_b32 s53, s2, 5
    s_mul_i32 s53, s53, 245760
    s_mul_i32 s31, s3, 61440
    s_add_u32 s53, s53, s31
    s_add_u32 s53, s53, 13631488
    s_lshl_b32 s50, s3, 12
    s_mul_i32 s51, s20, 81920
    s_add_u32 s51, s51, s50
    s_add_u32 s51, s51, 6291456
    v_lshrrev_b32 v8, 4, v0
    v_and_b32 v9, 7, v0
    v_lshl_add_u32 v8, v8, 3, v9
    v_lshlrev_b32 v8, 4, v8
    v_bfe_u32 v9, v0, 3, 1
    v_mul_u32_u24 v6, 10240, v9
    v_add_u32 v6, v6, v8
    v_mul_u32_u24 v7, 1966080, v9
    v_add_u32 v8, 20480, v8
    v_add_u32 v7, v7, v8
    s_mul_i32 s31, s22, 3
    v_and_b32 v170, 1, v0
    v_lshl_add_u32 v170, v170, 1, s31
    v_lshrrev_b32 v170, 3, v170
    v_bfe_u32 v171, v0, 1, 1
    v_mul_u32_u24 v171, 24, v171
    v_add_lshl_u32 v170, v170, v171, 7
    s_mul_i32 s54, s35, 10240
    v_mov_b32 v172, -1
    s_add_u32 s54, s54, 16777216
    v_mov_b32 v173, -1
    v_mov_b32 v174, -1
    v_mov_b32 v175, -1
    v_mov_b32 v171, v3
    s_mov_b32 s55, s30
L_sequen_pl_1:
    buffer_load_dword v18, v17, s[56:59], s32 offen sc1
    s_waitcnt vmcnt(0)
    v_cmp_ne_u32 vcc, s60, v18
    s_cbranch_vccz L_sequen_pd_2
    s_sub_u32 s61, s61, 1
    s_cbranch_scc0 L_sequen_pl_1
    s_mov_b32 s61, 0
L_sequen_pd_2:
    s_add_u32 m0, s46, 17152
    s_nop 0
    buffer_load_dwordx4 v3, s[56:59], s36 offen offset:0 sc1 lds
    buffer_load_dwordx4 v3, s[56:59], s36 offen offset:1024 sc1 lds
    s_mov_b32 m0, s44
    s_nop 0
    buffer_load_dwordx4 v3, s[56:59], s45 offen offset:0 sc1 lds
    buffer_load_dwordx4 v3, s[56:59], s45 offen offset:1024 sc1 lds
    buffer_load_dwordx4 v3, s[56:59], s45 offen offset:2048 sc1 lds
    buffer_load_dwordx4 v3, s[56:59], s45 offen offset:3072 sc1 lds
    buffer_load_dwordx2 v[176:177], v4, s[56:59], s37 offen offset:0 sc1
    buffer_load_dwordx2 v[178:179], v4, s[56:59], s37 offen offset:512 sc1
    s_add_u32 m0, s46, 17152
    s_nop 0
    buffer_load_dwordx4 v3, s[56:59], s36 offen offset:2048 sc1 lds
    buffer_load_dwordx4 v3, s[56:59], s36 offen offset:3072 sc1 lds
    buffer_load_dwordx2 v[180:181], v4, s[56:59], s37 offen offset:1024 sc1
    buffer_load_dwordx2 v[182:183], v4, s[56:59], s37 offen offset:1536 sc1
    buffer_load_dwordx2 v[184:185], v4, s[56:59], s37 offen offset:2048 sc1
    buffer_load_dwordx2 v[186:187], v4, s[56:59], s37 offen offset:2560 sc1
    buffer_load_dwordx2 v[188:189], v4, s[56:59], s37 offen offset:3072 sc1
    buffer_load_dwordx2 v[190:191], v4, s[56:59], s37 offen offset:3584 sc1
    s_waitcnt lgkmcnt(0)
    ds_read_b128 a[0:3], v16
    ds_read_b64 a[4:5], v1 offset:64
    ds_read_b64 a[6:7], v1 offset:72
    ds_read_b64 a[8:9], v1 offset:128
    ds_read_b64 a[10:11], v1 offset:136
    ds_read_b64 a[12:13], v1 offset:192
    ds_read_b64 a[14:15], v1 offset:200
    ds_read_b64 a[16:17], v1 offset:256
    ds_read_b64 a[18:19], v1 offset:264
    ds_read_b64 a[20:21], v1 offset:320
    ds_read_b64 a[22:23], v1 offset:328
    ds_read_b64 a[24:25], v1 offset:384
    ds_read_b64 a[26:27], v1 offset:392
    ds_read_b64 a[28:29], v1 offset:448
    ds_read_b64 a[30:31], v1 offset:456
    ds_read_b64 a[32:33], v1 offset:512
    ds_read_b64 a[34:35], v1 offset:520
    ds_read_b64 a[36:37], v1 offset:576
    ds_read_b64 a[38:39], v1 offset:584
    ds_read_b64 a[40:41], v1 offset:640
    ds_read_b64 a[42:43], v1 offset:648
    ds_read_b64 a[44:45], v1 offset:704
    ds_read_b64 a[46:47], v1 offset:712
    ds_read_b64 a[48:49], v1 offset:768
    ds_read_b64 a[50:51], v1 offset:776
    ds_read_b64 a[52:53], v1 offset:832
    ds_read_b64 a[54:55], v1 offset:840
    ds_read_b64 a[56:57], v1 offset:896
    ds_read_b64 a[58:59], v1 offset:904
    ds_read_b64 a[60:61], v1 offset:960
    ds_read_b64 a[62:63], v1 offset:968
    ds_read_b64 a[64:65], v1 offset:1024
    ds_read_b64 a[66:67], v1 offset:1032
    ds_read_b64 a[68:69], v1 offset:1088
    ds_read_b64 a[70:71], v1 offset:1096
    ds_read_b64 a[72:73], v1 offset:1152
    ds_read_b64 a[74:75], v1 offset:1160
    ds_read_b64 a[76:77], v1 offset:1216
    ds_read_b64 a[78:79], v1 offset:1224
    ds_read_b64 a[80:81], v1 offset:1280
    ds_read_b64 a[82:83], v1 offset:1288
    ds_read_b64 a[84:85], v1 offset:1344
    ds_read_b64 a[86:87], v1 offset:1352
    ds_read_b64 a[88:89], v1 offset:1408
    ds_read_b64 a[90:91], v1 offset:1416
    ds_read_b64 a[92:93], v1 offset:1472
    ds_read_b64 a[94:95], v1 offset:1480
    ds_read_b64 a[96:97], v1 offset:1536
    ds_read_b64 a[98:99], v1 offset:1544
    ds_read_b64 a[100:101], v1 offset:1600
    ds_read_b64 a[102:103], v1 offset:1608
    ds_read_b64 a[104:105], v1 offset:1664
    ds_read_b64 a[106:107], v1 offset:1672
    ds_read_b64 a[108:109], v1 offset:1728
    ds_read_b64 a[110:111], v1 offset:1736
    ds_read_b64 a[112:113], v1 offset:1792
    ds_read_b64 a[114:115], v1 offset:1800
    ds_read_b64 a[116:117], v1 offset:1856
    ds_read_b64 a[118:119], v1 offset:1864
    ds_read_b64 a[120:121], v1 offset:1920
    ds_read_b64 a[122:123], v1 offset:1928
    ds_read_b64 a[124:125], v1 offset:1984
    ds_read_b64 a[126:127], v1 offset:1992
    ds_read_b64 v[80:81], v1 offset:2048
    ds_read_b64 v[82:83], v1 offset:2056
    ds_read_b64 v[84:85], v1 offset:2112
    ds_read_b64 v[86:87], v1 offset:2120
    ds_read_b64 v[88:89], v1 offset:2176
    ds_read_b64 v[90:91], v1 offset:2184
    ds_read_b64 v[92:93], v1 offset:2240
    ds_read_b64 v[94:95], v1 offset:2248
    ds_read_b64 v[96:97], v1 offset:2304
    ds_read_b64 v[98:99], v1 offset:2312
    ds_read_b64 v[100:101], v1 offset:2368
    ds_read_b64 v[102:103], v1 offset:2376
    ds_read_b64 v[104:105], v1 offset:2432
    ds_read_b64 v[106:107], v1 offset:2440
    ds_read_b64 v[108:109], v1 offset:2496
    ds_read_b64 v[110:111], v1 offset:2504
    v_mov_b32 v3, s60
    s_waitcnt lgkmcnt(0)
    s_waitcnt vmcnt(15)
    ds_read_b128 a[156:159], v2 offset:448
    ds_read_b128 a[152:155], v2 offset:384
    ds_read_b128 a[148:151], v2 offset:320
    ds_read_b128 a[144:147], v2 offset:256
    ds_read_b128 a[140:143], v2 offset:192
    ds_read_b128 a[136:139], v2 offset:128
    ds_read_b128 a[132:135], v2 offset:64
    ds_read_b128 a[128:131], v2 offset:0
    s_waitcnt lgkmcnt(7)
    v_mfma_f32_16x16x32_bf16 v[16:19], a[0:3], a[156:159], 0
    buffer_load_dword v169, v170, s[56:59], s55 offen sc1
    v_mfma_f32_16x16x32_bf16 v[16:19], v[12:15], a[156:159], v[16:19]
    s_waitcnt lgkmcnt(6)
    v_mfma_f32_16x16x32_bf16 v[16:19], a[4:7], a[152:155], v[16:19]
    s_waitcnt lgkmcnt(5)
    v_mfma_f32_16x16x32_bf16 v[16:19], a[8:11], a[148:151], v[16:19]
    s_waitcnt lgkmcnt(4)
    v_mfma_f32_16x16x32_bf16 v[16:19], a[12:15], a[144:147], v[16:19]
    s_waitcnt lgkmcnt(3)
    v_mfma_f32_16x16x32_bf16 v[16:19], a[16:19], a[140:143], v[16:19]
    s_waitcnt lgkmcnt(2)
    v_mfma_f32_16x16x32_bf16 v[16:19], a[20:23], a[136:139], v[16:19]
    s_waitcnt lgkmcnt(1)
    v_mfma_f32_16x16x32_bf16 v[16:19], a[24:27], a[132:135], v[16:19]
    s_waitcnt lgkmcnt(0)
    v_mfma_f32_16x16x32_bf16 v[16:19], a[28:31], a[128:131], v[16:19]
    ds_read_b128 a[188:191], v2 offset:960
    s_waitcnt lgkmcnt(0)
    v_mfma_f32_16x16x32_bf16 v[20:23], a[0:3], a[188:191], 0
    v_mfma_f32_16x16x32_bf16 v[20:23], v[12:15], a[188:191], v[20:23]
    ds_read_b128 a[184:187], v2 offset:896
    s_waitcnt lgkmcnt(0)
    v_mfma_f32_16x16x32_bf16 v[20:23], a[4:7], a[184:187], v[20:23]
    ds_read_b128 a[180:183], v2 offset:832
    s_waitcnt lgkmcnt(0)
    v_mfma_f32_16x16x32_bf16 v[20:23], a[8:11], a[180:183], v[20:23]
    ds_read_b128 a[176:179], v2 offset:768
    s_waitcnt lgkmcnt(0)
    v_mfma_f32_16x16x32_bf16 v[20:23], a[12:15], a[176:179], v[20:23]
    ds_read_b128 a[172:175], v2 offset:704
    s_waitcnt lgkmcnt(0)
    v_mfma_f32_16x16x32_bf16 v[20:23], a[16:19], a[172:175], v[20:23]
    ds_read_b128 a[168:171], v2 offset:640
    s_waitcnt lgkmcnt(0)
    v_mfma_f32_16x16x32_bf16 v[20:23], a[20:23], a[168:171], v[20:23]
    ds_read_b128 a[164:167], v2 offset:576
    s_waitcnt lgkmcnt(0)
    v_mfma_f32_16x16x32_bf16 v[20:23], a[24:27], a[164:167], v[20:23]
    ds_read_b128 a[160:163], v2 offset:512
    s_waitcnt lgkmcnt(0)
    v_mfma_f32_16x16x32_bf16 v[20:23], a[28:31], a[160:163], v[20:23]
    s_waitcnt vmcnt(15)
    v_mfma_f32_16x16x32_bf16 v[20:23], a[32:35], a[156:159], v[20:23]
    v_mfma_f32_16x16x32_bf16 v[20:23], a[36:39], a[152:155], v[20:23]
    v_mfma_f32_16x16x32_bf16 v[20:23], a[40:43], a[148:151], v[20:23]
    v_mfma_f32_16x16x32_bf16 v[20:23], a[44:47], a[144:147], v[20:23]
    v_mfma_f32_16x16x32_bf16 v[20:23], a[48:51], a[140:143], v[20:23]
    v_mfma_f32_16x16x32_bf16 v[20:23], a[52:55], a[136:139], v[20:23]
    v_mfma_f32_16x16x32_bf16 v[20:23], a[56:59], a[132:135], v[20:23]
    v_mfma_f32_16x16x32_bf16 v[20:23], a[60:63], a[128:131], v[20:23]
    s_waitcnt vmcnt(11)
    s_barrier
    ds_read_b128 a[220:223], v2 offset:1472
    s_waitcnt lgkmcnt(0)
    v_mfma_f32_16x16x32_bf16 v[24:27], a[0:3], a[220:223], 0
    v_mfma_f32_16x16x32_bf16 v[24:27], v[12:15], a[220:223], v[24:27]
    ds_read_b128 a[216:219], v2 offset:1408
    s_waitcnt lgkmcnt(0)
    v_mfma_f32_16x16x32_bf16 v[24:27], a[4:7], a[216:219], v[24:27]
    ds_read_b128 a[212:215], v2 offset:1344
    s_waitcnt lgkmcnt(0)
    v_mfma_f32_16x16x32_bf16 v[24:27], a[8:11], a[212:215], v[24:27]
    ds_read_b128 a[208:211], v2 offset:1280
    s_waitcnt lgkmcnt(0)
    v_mfma_f32_16x16x32_bf16 v[24:27], a[12:15], a[208:211], v[24:27]
    ds_read_b128 a[204:207], v2 offset:1216
    s_waitcnt lgkmcnt(0)
    v_mfma_f32_16x16x32_bf16 v[24:27], a[16:19], a[204:207], v[24:27]
    ds_read_b128 a[200:203], v2 offset:1152
    s_waitcnt lgkmcnt(0)
    v_mfma_f32_16x16x32_bf16 v[24:27], a[20:23], a[200:203], v[24:27]
    ds_read_b128 a[196:199], v2 offset:1088
    s_waitcnt lgkmcnt(0)
    v_mfma_f32_16x16x32_bf16 v[24:27], a[24:27], a[196:199], v[24:27]
    ds_read_b128 a[192:195], v2 offset:1024
    s_waitcnt lgkmcnt(0)
    v_mfma_f32_16x16x32_bf16 v[24:27], a[28:31], a[192:195], v[24:27]
    v_mfma_f32_16x16x32_bf16 v[24:27], a[32:35], a[188:191], v[24:27]
    v_mfma_f32_16x16x32_bf16 v[24:27], a[36:39], a[184:187], v[24:27]
    v_mfma_f32_16x16x32_bf16 v[24:27], a[40:43], a[180:183], v[24:27]
    v_mfma_f32_16x16x32_bf16 v[24:27], a[44:47], a[176:179], v[24:27]
    v_mfma_f32_16x16x32_bf16 v[24:27], a[48:51], a[172:175], v[24:27]
    v_mfma_f32_16x16x32_bf16 v[24:27], a[52:55], a[168:171], v[24:27]
    v_mfma_f32_16x16x32_bf16 v[24:27], a[56:59], a[164:167], v[24:27]
    v_mfma_f32_16x16x32_bf16 v[24:27], a[60:63], a[160:163], v[24:27]
    s_waitcnt vmcnt(0)
    v_cmp_ne_u32 vcc, s60, v169
    s_cmp_lg_u64 vcc, 0
    v_mfma_f32_16x16x32_bf16 v[24:27], a[64:67], a[156:159], v[24:27]
    s_cselect_b32 s62, 0x80000000, 0
    v_xor_b32 v6, s62, v6
    v_mfma_f32_16x16x32_bf16 v[24:27], a[68:71], a[152:155], v[24:27]
    v_xor_b32 v7, s62, v7
    buffer_load_dwordx4 v[208:211], v6, s[56:59], s24 offen offset:0 sc1
    v_mfma_f32_16x16x32_bf16 v[24:27], a[72:75], a[148:151], v[24:27]
    ds_read_b128 v[192:195], v5 offset:0
    v_mfma_f32_16x16x32_bf16 v[24:27], a[76:79], a[144:147], v[24:27]
    buffer_load_dwordx4 v[212:215], v6, s[56:59], s27 offen offset:0 sc1
    v_mfma_f32_16x16x32_bf16 v[24:27], a[80:83], a[140:143], v[24:27]
    ds_read_b128 v[196:199], v5 offset:8192
    v_mfma_f32_16x16x32_bf16 v[24:27], a[84:87], a[136:139], v[24:27]
    v_mfma_f32_16x16x32_bf16 v[24:27], a[88:91], a[132:135], v[24:27]
    ds_read_b128 v[200:203], v5 offset:1024
    v_mfma_f32_16x16x32_bf16 v[24:27], a[92:95], a[128:131], v[24:27]
    buffer_load_dwordx4 v[216:219], v7, s[56:59], s24 offen offset:0 sc1
    ds_read_b128 a[252:255], v2 offset:1984
    s_waitcnt lgkmcnt(0)
    v_mfma_f32_16x16x32_bf16 v[28:31], a[0:3], a[252:255], 0
    v_mfma_f32_16x16x32_bf16 v[28:31], v[12:15], a[252:255], v[28:31]
    ds_read_b128 a[248:251], v2 offset:1920
    s_waitcnt lgkmcnt(0)
    v_mfma_f32_16x16x32_bf16 v[28:31], a[4:7], a[248:251], v[28:31]
    ds_read_b128 a[244:247], v2 offset:1856
    s_waitcnt lgkmcnt(0)
    v_mfma_f32_16x16x32_bf16 v[28:31], a[8:11], a[244:247], v[28:31]
    buffer_load_dwordx4 v[220:223], v6, s[56:59], s24 offen offset:512 sc1
    ds_read_b128 a[240:243], v2 offset:1792
    s_waitcnt lgkmcnt(0)
    v_mfma_f32_16x16x32_bf16 v[28:31], a[12:15], a[240:243], v[28:31]
    ds_read_b128 a[236:239], v2 offset:1728
    s_waitcnt lgkmcnt(0)
    v_mfma_f32_16x16x32_bf16 v[28:31], a[16:19], a[236:239], v[28:31]
    ds_read_b128 a[232:235], v2 offset:1664
    s_waitcnt lgkmcnt(0)
    v_mfma_f32_16x16x32_bf16 v[28:31], a[20:23], a[232:235], v[28:31]
    ds_read_b128 a[228:231], v2 offset:1600
    s_waitcnt lgkmcnt(0)
    v_mfma_f32_16x16x32_bf16 v[28:31], a[24:27], a[228:231], v[28:31]
    buffer_load_dwordx4 v[224:227], v6, s[56:59], s27 offen offset:512 sc1
    ds_read_b128 a[224:227], v2 offset:1536
    s_waitcnt lgkmcnt(0)
    v_mfma_f32_16x16x32_bf16 v[28:31], a[28:31], a[224:227], v[28:31]
    v_mfma_f32_16x16x32_bf16 v[28:31], a[32:35], a[220:223], v[28:31]
    v_mfma_f32_16x16x32_bf16 v[28:31], a[36:39], a[216:219], v[28:31]
    v_mfma_f32_16x16x32_bf16 v[28:31], a[40:43], a[212:215], v[28:31]
    buffer_load_dwordx4 v[228:231], v7, s[56:59], s24 offen offset:512 sc1
    v_mfma_f32_16x16x32_bf16 v[28:31], a[44:47], a[208:211], v[28:31]
    v_mfma_f32_16x16x32_bf16 v[28:31], a[48:51], a[204:207], v[28:31]
    v_mfma_f32_16x16x32_bf16 v[28:31], a[52:55], a[200:203], v[28:31]
    v_mfma_f32_16x16x32_bf16 v[28:31], a[56:59], a[196:199], v[28:31]
    buffer_load_dwordx4 v[232:235], v6, s[56:59], s24 offen offset:1024 sc1
    v_mfma_f32_16x16x32_bf16 v[28:31], a[60:63], a[192:195], v[28:31]
    ds_read_b128 v[204:207], v5 offset:9216
    v_mfma_f32_16x16x32_bf16 v[28:31], a[64:67], a[188:191], v[28:31]
    v_mfma_f32_16x16x32_bf16 v[28:31], a[68:71], a[184:187], v[28:31]
    ds_read_b128 v[76:79], v2 offset:2496
    v_mfma_f32_16x16x32_bf16 v[28:31], a[72:75], a[180:183], v[28:31]
    buffer_load_dwordx4 v[236:239], v6, s[56:59], s27 offen offset:1024 sc1
    v_mfma_f32_16x16x32_bf16 v[28:31], a[76:79], a[176:179], v[28:31]
    ds_read_b128 v[72:75], v2 offset:2432
    v_mfma_f32_16x16x32_bf16 v[28:31], a[80:83], a[172:175], v[28:31]
    v_lshlrev_b32 v8, 16, v176
    v_and_b32 v9, s38, v176
    v_mfma_f32_16x16x32_bf16 v[28:31], a[84:87], a[168:171], v[28:31]
    ds_read_b128 v[68:71], v2 offset:2368
    v_pk_fma_f32 v[192:193], v[8:9], v[192:193], v[196:197]
    v_mfma_f32_16x16x32_bf16 v[28:31], a[88:91], a[164:167], v[28:31]
    buffer_load_dwordx4 v[240:243], v7, s[56:59], s24 offen offset:1024 sc1
    v_pk_fma_f32 v[192:193], v[192:193], v[16:17], v[8:9]
    v_mfma_f32_16x16x32_bf16 v[28:31], a[92:95], a[160:163], v[28:31]
    ds_read_b128 v[64:67], v2 offset:2304
    v_lshlrev_b32 v8, 16, v177
    v_mfma_f32_16x16x32_bf16 v[28:31], a[96:99], a[156:159], v[28:31]
    v_and_b32 v9, s38, v177
    v_pk_fma_f32 v[194:195], v[8:9], v[194:195], v[198:199]
    v_mfma_f32_16x16x32_bf16 v[28:31], a[100:103], a[152:155], v[28:31]
    ds_read_b128 v[60:63], v2 offset:2240
    v_pk_fma_f32 v[194:195], v[194:195], v[18:19], v[8:9]
    v_mfma_f32_16x16x32_bf16 v[28:31], a[104:107], a[148:151], v[28:31]
    buffer_load_dwordx4 v[244:247], v6, s[56:59], s24 offen offset:1536 sc1
    v_cvt_pk_bf16_f32 v196, v192, v193
    v_mfma_f32_16x16x32_bf16 v[28:31], a[108:111], a[144:147], v[28:31]
    ds_read_b128 v[56:59], v2 offset:2176
    v_cvt_pk_bf16_f32 v197, v194, v195
    v_mfma_f32_16x16x32_bf16 v[28:31], a[112:115], a[140:143], v[28:31]
    s_waitcnt lgkmcnt(6)
    v_lshlrev_b32 v8, 16, v178
    v_and_b32 v9, s38, v178
    v_mfma_f32_16x16x32_bf16 v[28:31], a[116:119], a[136:139], v[28:31]
    ds_read_b128 v[52:55], v2 offset:2112
    v_pk_fma_f32 v[200:201], v[8:9], v[200:201], v[204:205]
    v_mfma_f32_16x16x32_bf16 v[28:31], a[120:123], a[132:135], v[28:31]
    buffer_load_dwordx4 v[248:251], v6, s[56:59], s27 offen offset:1536 sc1
    v_pk_fma_f32 v[200:201], v[200:201], v[20:21], v[8:9]
    v_mfma_f32_16x16x32_bf16 v[28:31], a[124:127], a[128:131], v[28:31]
    ds_read_b128 v[48:51], v2 offset:2048
    v_lshlrev_b32 v8, 16, v179
    v_mfma_f32_16x16x32_bf16 v[32:35], a[32:35], a[252:255], 0
    v_and_b32 v9, s38, v179
    v_pk_fma_f32 v[202:203], v[8:9], v[202:203], v[206:207]
    v_mfma_f32_16x16x32_bf16 v[32:35], a[36:39], a[248:251], v[32:35]
    v_pk_fma_f32 v[202:203], v[202:203], v[22:23], v[8:9]
    v_cvt_pk_bf16_f32 v198, v200, v201
    v_mfma_f32_16x16x32_bf16 v[32:35], a[40:43], a[244:247], v[32:35]
    buffer_load_dwordx4 v[252:255], v7, s[56:59], s24 offen offset:1536 sc1
    v_cvt_pk_bf16_f32 v199, v202, v203
    v_mfma_f32_16x16x32_bf16 v[32:35], a[44:47], a[240:243], v[32:35]
    v_mfma_f32_16x16x32_bf16 v[32:35], a[48:51], a[236:239], v[32:35]
    v_permlane16_swap_b32 v196, v198
    v_permlane16_swap_b32 v197, v199
    v_mfma_f32_16x16x32_bf16 v[32:35], a[52:55], a[232:235], v[32:35]
    v_mfma_f32_16x16x32_bf16 v[32:35], a[56:59], a[228:231], v[32:35]
    buffer_store_dwordx4 v[196:199], v10, s[56:59], s40 offen sc1
    ds_read_b128 v[192:195], v5 offset:2048
    v_mfma_f32_16x16x32_bf16 v[32:35], a[60:63], a[224:227], v[32:35]
    ds_read_b128 v[196:199], v5 offset:10240
    v_mfma_f32_16x16x32_bf16 v[32:35], a[64:67], a[220:223], v[32:35]
    ds_read_b128 v[200:203], v5 offset:3072
    v_mfma_f32_16x16x32_bf16 v[32:35], a[68:71], a[216:219], v[32:35]
    v_mfma_f32_16x16x32_bf16 v[32:35], a[72:75], a[212:215], v[32:35]
    ds_read_b128 v[204:207], v5 offset:11264
    buffer_load_dwordx4 v[112:115], v6, s[56:59], s24 offen offset:2048 sc1
    v_mfma_f32_16x16x32_bf16 v[32:35], a[76:79], a[208:211], v[32:35]
    s_waitcnt lgkmcnt(2)
    v_lshlrev_b32 v8, 16, v180
    v_and_b32 v9, s38, v180
    v_mfma_f32_16x16x32_bf16 v[32:35], a[80:83], a[204:207], v[32:35]
    v_pk_fma_f32 v[192:193], v[8:9], v[192:193], v[196:197]
    v_pk_fma_f32 v[192:193], v[192:193], v[24:25], v[8:9]
    v_mfma_f32_16x16x32_bf16 v[32:35], a[84:87], a[200:203], v[32:35]
    v_lshlrev_b32 v8, 16, v181
    v_and_b32 v9, s38, v181
    v_mfma_f32_16x16x32_bf16 v[32:35], a[88:91], a[196:199], v[32:35]
    buffer_load_dwordx4 v[116:119], v6, s[56:59], s27 offen offset:2048 sc1
    v_pk_fma_f32 v[194:195], v[8:9], v[194:195], v[198:199]
    v_mfma_f32_16x16x32_bf16 v[32:35], a[92:95], a[192:195], v[32:35]
    v_pk_fma_f32 v[194:195], v[194:195], v[26:27], v[8:9]
    v_cvt_pk_bf16_f32 v196, v192, v193
    v_mfma_f32_16x16x32_bf16 v[32:35], a[96:99], a[188:191], v[32:35]
    v_cvt_pk_bf16_f32 v197, v194, v195
    s_waitcnt lgkmcnt(0)
    v_lshlrev_b32 v8, 16, v182
    v_mfma_f32_16x16x32_bf16 v[32:35], a[100:103], a[184:187], v[32:35]
    v_and_b32 v9, s38, v182
    v_pk_fma_f32 v[200:201], v[8:9], v[200:201], v[204:205]
    v_mfma_f32_16x16x32_bf16 v[32:35], a[104:107], a[180:183], v[32:35]
    buffer_load_dwordx4 v[120:123], v7, s[56:59], s24 offen offset:2048 sc1
    v_pk_fma_f32 v[200:201], v[200:201], v[28:29], v[8:9]
    v_mfma_f32_16x16x32_bf16 v[32:35], a[108:111], a[176:179], v[32:35]
    v_lshlrev_b32 v8, 16, v183
    v_and_b32 v9, s38, v183
    v_mfma_f32_16x16x32_bf16 v[32:35], a[112:115], a[172:175], v[32:35]
    v_pk_fma_f32 v[202:203], v[8:9], v[202:203], v[206:207]
    v_pk_fma_f32 v[202:203], v[202:203], v[30:31], v[8:9]
    v_mfma_f32_16x16x32_bf16 v[32:35], a[116:119], a[168:171], v[32:35]
    v_cvt_pk_bf16_f32 v198, v200, v201
    v_cvt_pk_bf16_f32 v199, v202, v203
    v_mfma_f32_16x16x32_bf16 v[32:35], a[120:123], a[164:167], v[32:35]
    buffer_load_dwordx4 v[124:127], v6, s[56:59], s24 offen offset:2560 sc1
    v_mfma_f32_16x16x32_bf16 v[32:35], a[124:127], a[160:163], v[32:35]
    v_permlane16_swap_b32 v196, v198
    v_mfma_f32_16x16x32_bf16 v[36:39], a[64:67], a[252:255], 0
    v_permlane16_swap_b32 v197, v199
    v_mfma_f32_16x16x32_bf16 v[36:39], a[68:71], a[248:251], v[36:39]
    v_mfma_f32_16x16x32_bf16 v[36:39], a[72:75], a[244:247], v[36:39]
    buffer_store_dwordx4 v[196:199], v10, s[56:59], s41 offen sc1
    v_min_u32 v8, 39, v0
    v_mfma_f32_16x16x32_bf16 v[36:39], a[76:79], a[240:243], v[36:39]
    s_lshl_b32 s30, s3, 10
    v_and_b32 v9, 7, v8
    v_mfma_f32_16x16x32_bf16 v[36:39], a[80:83], a[236:239], v[36:39]
    v_lshrrev_b32 v8, 3, v8
    s_add_u32 s30, s30, 24707072
    v_mfma_f32_16x16x32_bf16 v[36:39], a[84:87], a[232:235], v[36:39]
    v_lshl_add_u32 v8, v8, 5, v9
    s_add_u32 s31, s30, 32768
    v_mfma_f32_16x16x32_bf16 v[36:39], a[88:91], a[228:231], v[36:39]
    buffer_load_dwordx4 v[128:131], v6, s[56:59], s27 offen offset:2560 sc1
    v_lshlrev_b32 v4, 7, v8
    v_mfma_f32_16x16x32_bf16 v[36:39], a[92:95], a[224:227], v[36:39]
    v_and_b32 v178, 3, v0
    v_lshlrev_b32 v178, 8, v178
    v_mfma_f32_16x16x32_bf16 v[36:39], a[96:99], a[220:223], v[36:39]
    ds_read_b128 v[192:195], v5 offset:4096
    ds_read_b128 v[196:199], v5 offset:12288
    v_mfma_f32_16x16x32_bf16 v[36:39], a[100:103], a[216:219], v[36:39]
    v_mfma_f32_16x16x32_bf16 v[36:39], a[104:107], a[212:215], v[36:39]
    buffer_load_dword v177, v178, s[56:59], s23 offen sc1
    v_mfma_f32_16x16x32_bf16 v[36:39], a[108:111], a[208:211], v[36:39]
    buffer_load_dwordx4 v[132:135], v7, s[56:59], s24 offen offset:2560 sc1
    v_mfma_f32_16x16x32_bf16 v[36:39], a[112:115], a[204:207], v[36:39]
    v_mfma_f32_16x16x32_bf16 v[36:39], a[116:119], a[200:203], v[36:39]
    v_mfma_f32_16x16x32_bf16 v[36:39], a[120:123], a[196:199], v[36:39]
    v_mfma_f32_16x16x32_bf16 v[36:39], a[124:127], a[192:195], v[36:39]
    buffer_load_dwordx4 v[136:139], v6, s[56:59], s24 offen offset:3072 sc1
    v_mfma_f32_16x16x32_bf16 v[40:43], a[96:99], a[252:255], 0
    v_mfma_f32_16x16x32_bf16 v[40:43], a[100:103], a[248:251], v[40:43]
    v_mfma_f32_16x16x32_bf16 v[40:43], a[104:107], a[244:247], v[40:43]
    v_mfma_f32_16x16x32_bf16 v[40:43], a[108:111], a[240:243], v[40:43]
    buffer_load_dwordx4 v[140:143], v6, s[56:59], s27 offen offset:3072 sc1
    v_mfma_f32_16x16x32_bf16 v[40:43], a[112:115], a[236:239], v[40:43]
    v_mfma_f32_16x16x32_bf16 v[40:43], a[116:119], a[232:235], v[40:43]
    v_mfma_f32_16x16x32_bf16 v[40:43], a[120:123], a[228:231], v[40:43]
    v_mfma_f32_16x16x32_bf16 v[40:43], a[124:127], a[224:227], v[40:43]
    buffer_load_dwordx4 v[144:147], v7, s[56:59], s24 offen offset:3072 sc1
    v_mfma_f32_16x16x32_bf16 v[44:47], a[96:99], v[76:79], 0
    v_mfma_f32_16x16x32_bf16 v[44:47], a[100:103], v[72:75], v[44:47]
    v_mfma_f32_16x16x32_bf16 v[44:47], a[104:107], v[68:71], v[44:47]
    v_mfma_f32_16x16x32_bf16 v[44:47], a[108:111], v[64:67], v[44:47]
    buffer_load_dwordx4 v[148:151], v6, s[56:59], s24 offen offset:3584 sc1
    v_mfma_f32_16x16x32_bf16 v[44:47], a[112:115], v[60:63], v[44:47]
    v_mfma_f32_16x16x32_bf16 v[44:47], a[116:119], v[56:59], v[44:47]
    v_mfma_f32_16x16x32_bf16 v[44:47], a[120:123], v[52:55], v[44:47]
    v_mfma_f32_16x16x32_bf16 v[44:47], a[124:127], v[48:51], v[44:47]
    buffer_load_dwordx4 v[152:155], v6, s[56:59], s27 offen offset:3584 sc1
    ds_read_b64 a[96:97], v1 offset:3584
    v_mfma_f32_16x16x32_bf16 v[40:43], a[64:67], v[76:79], v[40:43]
    ds_read_b64 a[98:99], v1 offset:3592
    ds_read_b64 a[100:101], v1 offset:3648
    v_mfma_f32_16x16x32_bf16 v[40:43], a[68:71], v[72:75], v[40:43]
    ds_read_b64 a[102:103], v1 offset:3656
    ds_read_b64 a[104:105], v1 offset:3712
    v_mfma_f32_16x16x32_bf16 v[40:43], a[72:75], v[68:71], v[40:43]
    ds_read_b64 a[106:107], v1 offset:3720
    v_mfma_f32_16x16x32_bf16 v[40:43], a[76:79], v[64:67], v[40:43]
    buffer_load_dwordx4 v[156:159], v7, s[56:59], s24 offen offset:3584 sc1
    v_mov_b32 v182, v170
    v_mfma_f32_16x16x32_bf16 v[40:43], a[80:83], v[60:63], v[40:43]
    ds_read_b64 a[108:109], v1 offset:3776
    ds_read_b64 a[110:111], v1 offset:3784
    v_mfma_f32_16x16x32_bf16 v[40:43], a[84:87], v[56:59], v[40:43]
    ds_read_b64 a[112:113], v1 offset:3840
    v_mfma_f32_16x16x32_bf16 v[40:43], a[88:91], v[52:55], v[40:43]
    ds_read_b64 a[114:115], v1 offset:3848
    v_mfma_f32_16x16x32_bf16 v[40:43], a[92:95], v[48:51], v[40:43]
    buffer_load_dword v183, v182, s[56:59], s55 offen sc1
    ds_read_b64 a[116:117], v1 offset:3904
    v_mfma_f32_16x16x32_bf16 v[36:39], a[32:35], v[76:79], v[36:39]
    buffer_load_dwordx4 v[160:163], v6, s[56:59], s25 offen offset:0 sc1
    ds_read_b64 a[118:119], v1 offset:3912
    v_mfma_f32_16x16x32_bf16 v[36:39], a[36:39], v[72:75], v[36:39]
    ds_read_b64 a[120:121], v1 offset:3968
    v_mfma_f32_16x16x32_bf16 v[36:39], a[40:43], v[68:71], v[36:39]
    ds_read_b64 a[122:123], v1 offset:3976
    v_mfma_f32_16x16x32_bf16 v[36:39], a[44:47], v[64:67], v[36:39]
    ds_read_b64 a[124:125], v1 offset:4032
    v_mfma_f32_16x16x32_bf16 v[36:39], a[48:51], v[60:63], v[36:39]
    buffer_load_dwordx4 v[164:167], v6, s[56:59], s28 offen offset:0 sc1
    ds_read_b64 a[126:127], v1 offset:4040
    v_mfma_f32_16x16x32_bf16 v[36:39], a[52:55], v[56:59], v[36:39]
    v_mfma_f32_16x16x32_bf16 v[36:39], a[56:59], v[52:55], v[36:39]
    v_mfma_f32_16x16x32_bf16 v[36:39], a[60:63], v[48:51], v[36:39]
    s_waitcnt vmcnt(12)
    s_barrier
    v_mfma_f32_16x16x32_bf16 v[32:35], a[0:3], v[76:79], v[32:35]
    buffer_store_dword v3, v11, s[56:59], s48 offen sc1
    v_mfma_f32_16x16x32_bf16 v[32:35], v[12:15], v[76:79], v[32:35]
    buffer_load_dwordx4 v[168:171], v7, s[56:59], s25 offen offset:0 sc1
    v_mfma_f32_16x16x32_bf16 v[32:35], a[4:7], v[72:75], v[32:35]
    v_mfma_f32_16x16x32_bf16 v[32:35], a[8:11], v[68:71], v[32:35]
    v_mfma_f32_16x16x32_bf16 v[32:35], a[12:15], v[64:67], v[32:35]
    v_mfma_f32_16x16x32_bf16 v[32:35], a[16:19], v[60:63], v[32:35]
    buffer_load_dwordx4 v[172:175], v6, s[56:59], s25 offen offset:512 sc1
    v_mfma_f32_16x16x32_bf16 v[32:35], a[20:23], v[56:59], v[32:35]
    v_mfma_f32_16x16x32_bf16 v[32:35], a[24:27], v[52:55], v[32:35]
    v_mfma_f32_16x16x32_bf16 v[32:35], a[28:31], v[48:51], v[32:35]
    ds_read_b128 v[76:79], v2 offset:3008
    ds_read_b128 v[72:75], v2 offset:2944
    v_mfma_f32_16x16x32_bf16 v[44:47], v[80:83], a[252:255], v[44:47]
    v_mfma_f32_16x16x32_bf16 v[44:47], v[84:87], a[248:251], v[44:47]
    ds_read_b128 v[68:71], v2 offset:2880
    v_mfma_f32_16x16x32_bf16 v[44:47], v[88:91], a[244:247], v[44:47]
    v_mfma_f32_16x16x32_bf16 v[44:47], v[92:95], a[240:243], v[44:47]
    ds_read_b128 v[64:67], v2 offset:2816
    v_mfma_f32_16x16x32_bf16 v[44:47], v[96:99], a[236:239], v[44:47]
    v_mfma_f32_16x16x32_bf16 v[44:47], v[100:103], a[232:235], v[44:47]
    ds_read_b128 v[60:63], v2 offset:2752
    v_mfma_f32_16x16x32_bf16 v[44:47], v[104:107], a[228:231], v[44:47]
    v_mfma_f32_16x16x32_bf16 v[44:47], v[108:111], a[224:227], v[44:47]
    s_waitcnt vmcnt(5)
    v_cmp_ne_u32 vcc, s60, v183
    s_cmp_lg_u64 vcc, 0
    v_mfma_f32_16x16x32_bf16 v[40:43], v[80:83], a[220:223], v[40:43]
    s_cselect_b32 s63, 0x80000000, 0
    s_xor_b32 s52, s62, s63
    v_mfma_f32_16x16x32_bf16 v[40:43], v[84:87], a[216:219], v[40:43]
    v_xor_b32 v6, s52, v6
    v_xor_b32 v7, s52, v7
    v_mfma_f32_16x16x32_bf16 v[40:43], v[88:91], a[212:215], v[40:43]
    buffer_load_dwordx4 a[224:227], v6, s[56:59], s28 offen offset:512 sc1
    ds_read_b128 v[56:59], v2 offset:2688
    v_mfma_f32_16x16x32_bf16 v[40:43], v[92:95], a[208:211], v[40:43]
    ds_read_b128 v[52:55], v2 offset:2624
    v_mfma_f32_16x16x32_bf16 v[40:43], v[96:99], a[204:207], v[40:43]
    buffer_load_dwordx4 a[228:231], v7, s[56:59], s25 offen offset:512 sc1
    ds_read_b128 v[48:51], v2 offset:2560
    v_mfma_f32_16x16x32_bf16 v[40:43], v[100:103], a[200:203], v[40:43]
    v_mfma_f32_16x16x32_bf16 v[40:43], v[104:107], a[196:199], v[40:43]
    v_mfma_f32_16x16x32_bf16 v[40:43], v[108:111], a[192:195], v[40:43]
    v_mfma_f32_16x16x32_bf16 v[36:39], v[80:83], a[188:191], v[36:39]
    buffer_load_dwordx4 a[232:235], v6, s[56:59], s25 offen offset:1024 sc1
    v_mfma_f32_16x16x32_bf16 v[36:39], v[84:87], a[184:187], v[36:39]
    v_mfma_f32_16x16x32_bf16 v[36:39], v[88:91], a[180:183], v[36:39]
    v_mfma_f32_16x16x32_bf16 v[36:39], v[92:95], a[176:179], v[36:39]
    v_mfma_f32_16x16x32_bf16 v[36:39], v[96:99], a[172:175], v[36:39]
    buffer_load_dwordx4 a[236:239], v6, s[56:59], s28 offen offset:1024 sc1
    v_mfma_f32_16x16x32_bf16 v[36:39], v[100:103], a[168:171], v[36:39]
    v_mfma_f32_16x16x32_bf16 v[36:39], v[104:107], a[164:167], v[36:39]
    v_mfma_f32_16x16x32_bf16 v[36:39], v[108:111], a[160:163], v[36:39]
    v_mfma_f32_16x16x32_bf16 v[32:35], v[80:83], a[156:159], v[32:35]
    buffer_load_dwordx4 a[240:243], v7, s[56:59], s25 offen offset:1024 sc1
    v_mfma_f32_16x16x32_bf16 v[32:35], v[84:87], a[152:155], v[32:35]
    v_mfma_f32_16x16x32_bf16 v[32:35], v[88:91], a[148:151], v[32:35]
    v_mfma_f32_16x16x32_bf16 v[32:35], v[92:95], a[144:147], v[32:35]
    v_mfma_f32_16x16x32_bf16 v[32:35], v[96:99], a[140:143], v[32:35]
    buffer_load_dwordx4 a[244:247], v6, s[56:59], s25 offen offset:1536 sc1
    v_mfma_f32_16x16x32_bf16 v[32:35], v[100:103], a[136:139], v[32:35]
    v_mfma_f32_16x16x32_bf16 v[32:35], v[104:107], a[132:135], v[32:35]
    v_mfma_f32_16x16x32_bf16 v[32:35], v[108:111], a[128:131], v[32:35]
    ds_read_b64 v[80:81], v1 offset:2560
    ds_read_b64 v[82:83], v1 offset:2568
    s_waitcnt lgkmcnt(9)
    v_mfma_f32_16x16x32_bf16 v[44:47], a[64:67], v[76:79], v[44:47]
    buffer_load_dwordx4 a[248:251], v6, s[56:59], s28 offen offset:1536 sc1
    ds_read_b64 v[84:85], v1 offset:2624
    s_waitcnt lgkmcnt(9)
    v_mfma_f32_16x16x32_bf16 v[44:47], a[68:71], v[72:75], v[44:47]
    ds_read_b64 v[86:87], v1 offset:2632
    ds_read_b64 v[88:89], v1 offset:2688
    s_waitcnt lgkmcnt(10)
    v_mfma_f32_16x16x32_bf16 v[44:47], a[72:75], v[68:71], v[44:47]
    ds_read_b64 v[90:91], v1 offset:2696
    v_lshlrev_b32 v8, 16, v184
    s_waitcnt lgkmcnt(10)
    v_mfma_f32_16x16x32_bf16 v[44:47], a[76:79], v[64:67], v[44:47]
    ds_read_b64 v[92:93], v1 offset:2752
    v_and_b32 v9, s38, v184
    s_waitcnt lgkmcnt(10)
    v_mfma_f32_16x16x32_bf16 v[44:47], a[80:83], v[60:63], v[44:47]
    buffer_load_dwordx4 a[252:255], v7, s[56:59], s25 offen offset:1536 sc1
    ds_read_b64 v[94:95], v1 offset:2760
    s_waitcnt lgkmcnt(10)
    v_mfma_f32_16x16x32_bf16 v[44:47], a[84:87], v[56:59], v[44:47]
    ds_read_b64 v[96:97], v1 offset:2816
    v_pk_fma_f32 v[192:193], v[8:9], v[192:193], v[196:197]
    s_waitcnt lgkmcnt(10)
    v_mfma_f32_16x16x32_bf16 v[44:47], a[88:91], v[52:55], v[44:47]
    ds_read_b64 v[98:99], v1 offset:2824
    v_pk_fma_f32 v[192:193], v[192:193], v[32:33], v[8:9]
    s_waitcnt lgkmcnt(10)
    v_mfma_f32_16x16x32_bf16 v[44:47], a[92:95], v[48:51], v[44:47]
    ds_read_b64 v[100:101], v1 offset:2880
    v_lshlrev_b32 v8, 16, v185
    v_mfma_f32_16x16x32_bf16 v[40:43], a[32:35], v[76:79], v[40:43]
    buffer_load_dwordx4 a[64:67], v6, s[56:59], s25 offen offset:2048 sc1
    ds_read_b64 v[102:103], v1 offset:2888
    v_mfma_f32_16x16x32_bf16 v[40:43], a[36:39], v[72:75], v[40:43]
    ds_read_b64 v[104:105], v1 offset:2944
    v_and_b32 v9, s38, v185
    v_mfma_f32_16x16x32_bf16 v[40:43], a[40:43], v[68:71], v[40:43]
    ds_read_b64 v[106:107], v1 offset:2952
    v_pk_fma_f32 v[194:195], v[8:9], v[194:195], v[198:199]
    v_mfma_f32_16x16x32_bf16 v[40:43], a[44:47], v[64:67], v[40:43]
    ds_read_b64 v[108:109], v1 offset:3008
    v_pk_fma_f32 v[194:195], v[194:195], v[34:35], v[8:9]
    v_mfma_f32_16x16x32_bf16 v[40:43], a[48:51], v[60:63], v[40:43]
    buffer_load_dwordx4 a[68:71], v6, s[56:59], s28 offen offset:2048 sc1
    ds_read_b64 v[110:111], v1 offset:3016
    v_mfma_f32_16x16x32_bf16 v[40:43], a[52:55], v[56:59], v[40:43]
    v_cvt_pk_bf16_f32 v196, v192, v193
    v_cvt_pk_bf16_f32 v197, v194, v195
    v_mfma_f32_16x16x32_bf16 v[40:43], a[56:59], v[52:55], v[40:43]
    ds_read_b128 v[200:203], v5 offset:5120
    v_mfma_f32_16x16x32_bf16 v[40:43], a[60:63], v[48:51], v[40:43]
    ds_read_b128 v[204:207], v5 offset:13312
    v_mfma_f32_16x16x32_bf16 v[36:39], a[0:3], v[76:79], v[36:39]
    buffer_load_dwordx4 a[72:75], v7, s[56:59], s25 offen offset:2048 sc1
    v_mfma_f32_16x16x32_bf16 v[36:39], v[12:15], v[76:79], v[36:39]
    v_mfma_f32_16x16x32_bf16 v[36:39], a[4:7], v[72:75], v[36:39]
    v_mfma_f32_16x16x32_bf16 v[36:39], a[8:11], v[68:71], v[36:39]
    v_mfma_f32_16x16x32_bf16 v[36:39], a[12:15], v[64:67], v[36:39]
    buffer_load_dwordx4 a[76:79], v6, s[56:59], s25 offen offset:2560 sc1
    v_mfma_f32_16x16x32_bf16 v[36:39], a[16:19], v[60:63], v[36:39]
    v_mfma_f32_16x16x32_bf16 v[36:39], a[20:23], v[56:59], v[36:39]
    v_mfma_f32_16x16x32_bf16 v[36:39], a[24:27], v[52:55], v[36:39]
    v_mfma_f32_16x16x32_bf16 v[36:39], a[28:31], v[48:51], v[36:39]
    buffer_load_dwordx4 a[80:83], v6, s[56:59], s28 offen offset:2560 sc1
    ds_read_b128 v[76:79], v2 offset:3520
    s_waitcnt lgkmcnt(15)
    v_mfma_f32_16x16x32_bf16 v[44:47], v[80:83], a[220:223], v[44:47]
    ds_read_b128 v[72:75], v2 offset:3456
    v_mfma_f32_16x16x32_bf16 v[44:47], v[84:87], a[216:219], v[44:47]
    ds_read_b128 v[68:71], v2 offset:3392
    s_waitcnt lgkmcnt(15)
    v_mfma_f32_16x16x32_bf16 v[44:47], v[88:91], a[212:215], v[44:47]
    s_waitcnt lgkmcnt(13)
    v_mfma_f32_16x16x32_bf16 v[44:47], v[92:95], a[208:211], v[44:47]
    buffer_load_dwordx4 a[84:87], v7, s[56:59], s25 offen offset:2560 sc1
    ds_read_b128 v[64:67], v2 offset:3328
    s_waitcnt lgkmcnt(12)
    v_mfma_f32_16x16x32_bf16 v[44:47], v[96:99], a[204:207], v[44:47]
    s_waitcnt lgkmcnt(10)
    v_mfma_f32_16x16x32_bf16 v[44:47], v[100:103], a[200:203], v[44:47]
    ds_read_b128 v[60:63], v2 offset:3264
    s_waitcnt lgkmcnt(9)
    v_mfma_f32_16x16x32_bf16 v[44:47], v[104:107], a[196:199], v[44:47]
    s_waitcnt lgkmcnt(7)
    v_mfma_f32_16x16x32_bf16 v[44:47], v[108:111], a[192:195], v[44:47]
    buffer_load_dwordx4 a[88:91], v6, s[56:59], s25 offen offset:3072 sc1
    ds_read_b128 v[56:59], v2 offset:3200
    v_mfma_f32_16x16x32_bf16 v[40:43], v[80:83], a[188:191], v[40:43]
    v_mfma_f32_16x16x32_bf16 v[40:43], v[84:87], a[184:187], v[40:43]
    ds_read_b128 v[52:55], v2 offset:3136
    v_mfma_f32_16x16x32_bf16 v[40:43], v[88:91], a[180:183], v[40:43]
    v_mfma_f32_16x16x32_bf16 v[40:43], v[92:95], a[176:179], v[40:43]
    buffer_load_dwordx4 a[92:95], v6, s[56:59], s28 offen offset:3072 sc1
    ds_read_b128 v[48:51], v2 offset:3072
    v_mfma_f32_16x16x32_bf16 v[40:43], v[96:99], a[172:175], v[40:43]
    v_mfma_f32_16x16x32_bf16 v[40:43], v[100:103], a[168:171], v[40:43]
    v_mfma_f32_16x16x32_bf16 v[40:43], v[104:107], a[164:167], v[40:43]
    v_mfma_f32_16x16x32_bf16 v[40:43], v[108:111], a[160:163], v[40:43]
    buffer_load_dwordx4 a[192:195], v7, s[56:59], s25 offen offset:3072 sc1
    v_mfma_f32_16x16x32_bf16 v[36:39], v[80:83], a[156:159], v[36:39]
    v_mfma_f32_16x16x32_bf16 v[36:39], v[84:87], a[152:155], v[36:39]
    v_mfma_f32_16x16x32_bf16 v[36:39], v[88:91], a[148:151], v[36:39]
    v_mfma_f32_16x16x32_bf16 v[36:39], v[92:95], a[144:147], v[36:39]
    buffer_load_dwordx4 a[196:199], v6, s[56:59], s25 offen offset:3584 sc1
    v_mfma_f32_16x16x32_bf16 v[36:39], v[96:99], a[140:143], v[36:39]
    v_mfma_f32_16x16x32_bf16 v[36:39], v[100:103], a[136:139], v[36:39]
    v_mfma_f32_16x16x32_bf16 v[36:39], v[104:107], a[132:135], v[36:39]
    v_mfma_f32_16x16x32_bf16 v[36:39], v[108:111], a[128:131], v[36:39]
    buffer_load_dwordx4 a[200:203], v6, s[56:59], s28 offen offset:3584 sc1
    ds_read_b64 v[80:81], v1 offset:3072
    s_waitcnt lgkmcnt(8)
    v_mfma_f32_16x16x32_bf16 v[44:47], a[32:35], v[76:79], v[44:47]
    ds_read_b64 v[82:83], v1 offset:3080
    ds_read_b64 v[84:85], v1 offset:3136
    s_waitcnt lgkmcnt(9)
    v_mfma_f32_16x16x32_bf16 v[44:47], a[36:39], v[72:75], v[44:47]
    ds_read_b64 v[86:87], v1 offset:3144
    ds_read_b64 v[88:89], v1 offset:3200
    s_waitcnt lgkmcnt(10)
    v_mfma_f32_16x16x32_bf16 v[44:47], a[40:43], v[68:71], v[44:47]
    ds_read_b64 v[90:91], v1 offset:3208
    v_lshlrev_b32 v8, 16, v186
    s_waitcnt lgkmcnt(10)
    v_mfma_f32_16x16x32_bf16 v[44:47], a[44:47], v[64:67], v[44:47]
    buffer_load_dwordx4 a[204:207], v7, s[56:59], s25 offen offset:3584 sc1
    ds_read_b64 v[92:93], v1 offset:3264
    s_waitcnt lgkmcnt(10)
    v_mfma_f32_16x16x32_bf16 v[44:47], a[48:51], v[60:63], v[44:47]
    ds_read_b64 v[94:95], v1 offset:3272
    v_and_b32 v9, s38, v186
    s_waitcnt lgkmcnt(10)
    v_mfma_f32_16x16x32_bf16 v[44:47], a[52:55], v[56:59], v[44:47]
    ds_read_b64 v[96:97], v1 offset:3328
    v_pk_fma_f32 v[200:201], v[8:9], v[200:201], v[204:205]
    s_waitcnt lgkmcnt(10)
    v_mfma_f32_16x16x32_bf16 v[44:47], a[56:59], v[52:55], v[44:47]
    ds_read_b64 v[98:99], v1 offset:3336
    v_pk_fma_f32 v[200:201], v[200:201], v[36:37], v[8:9]
    s_waitcnt lgkmcnt(10)
    v_mfma_f32_16x16x32_bf16 v[44:47], a[60:63], v[48:51], v[44:47]
    buffer_load_dwordx4 a[208:211], v6, s[56:59], s26 offen offset:0 sc1
    ds_read_b64 v[100:101], v1 offset:3392
    v_mfma_f32_16x16x32_bf16 v[40:43], a[0:3], v[76:79], v[40:43]
    ds_read_b64 v[102:103], v1 offset:3400
    v_lshlrev_b32 v8, 16, v187
    v_mfma_f32_16x16x32_bf16 v[40:43], v[12:15], v[76:79], v[40:43]
    ds_read_b64 v[104:105], v1 offset:3456
    v_and_b32 v9, s38, v187
    v_mfma_f32_16x16x32_bf16 v[40:43], a[4:7], v[72:75], v[40:43]
    ds_read_b64 v[106:107], v1 offset:3464
    v_pk_fma_f32 v[202:203], v[8:9], v[202:203], v[206:207]
    v_mfma_f32_16x16x32_bf16 v[40:43], a[8:11], v[68:71], v[40:43]
    buffer_load_dwordx4 a[212:215], v6, s[56:59], s29 offen offset:0 sc1
    ds_read_b64 v[108:109], v1 offset:3520
    v_mfma_f32_16x16x32_bf16 v[40:43], a[12:15], v[64:67], v[40:43]
    ds_read_b64 v[110:111], v1 offset:3528
    v_pk_fma_f32 v[202:203], v[202:203], v[38:39], v[8:9]
    v_mfma_f32_16x16x32_bf16 v[40:43], a[16:19], v[60:63], v[40:43]
    v_cvt_pk_bf16_f32 v198, v200, v201
    v_cvt_pk_bf16_f32 v199, v202, v203
    v_mfma_f32_16x16x32_bf16 v[40:43], a[20:23], v[56:59], v[40:43]
    v_mfma_f32_16x16x32_bf16 v[40:43], a[24:27], v[52:55], v[40:43]
    buffer_load_dwordx4 a[216:219], v7, s[56:59], s26 offen offset:0 sc1
    v_permlane16_swap_b32 v196, v198
    v_mfma_f32_16x16x32_bf16 v[40:43], a[28:31], v[48:51], v[40:43]
    ds_read_b128 v[76:79], v2 offset:4032
    ds_read_b128 v[72:75], v2 offset:3968
    s_waitcnt lgkmcnt(15)
    v_mfma_f32_16x16x32_bf16 v[44:47], v[80:83], a[188:191], v[44:47]
    v_permlane16_swap_b32 v197, v199
    s_waitcnt lgkmcnt(14)
    v_mfma_f32_16x16x32_bf16 v[44:47], v[84:87], a[184:187], v[44:47]
    ds_read_b128 v[68:71], v2 offset:3904
    s_waitcnt lgkmcnt(13)
    v_mfma_f32_16x16x32_bf16 v[44:47], v[88:91], a[180:183], v[44:47]
    buffer_store_dwordx4 v[196:199], v10, s[56:59], s42 offen sc1
    s_waitcnt lgkmcnt(11)
    v_mfma_f32_16x16x32_bf16 v[44:47], v[92:95], a[176:179], v[44:47]
    ds_read_b128 v[192:195], v5 offset:6144
    s_waitcnt lgkmcnt(10)
    v_mfma_f32_16x16x32_bf16 v[44:47], v[96:99], a[172:175], v[44:47]
    s_waitcnt lgkmcnt(8)
    v_mfma_f32_16x16x32_bf16 v[44:47], v[100:103], a[168:171], v[44:47]
    ds_read_b128 v[196:199], v5 offset:14336
    s_waitcnt lgkmcnt(7)
    v_mfma_f32_16x16x32_bf16 v[44:47], v[104:107], a[164:167], v[44:47]
    buffer_load_dwordx4 a[220:223], v6, s[56:59], s26 offen offset:512 sc1
    s_waitcnt lgkmcnt(5)
    v_mfma_f32_16x16x32_bf16 v[44:47], v[108:111], a[160:163], v[44:47]
    ds_read_b128 v[200:203], v5 offset:7168
    v_mfma_f32_16x16x32_bf16 v[40:43], v[80:83], a[156:159], v[40:43]
    v_mfma_f32_16x16x32_bf16 v[40:43], v[84:87], a[152:155], v[40:43]
    ds_read_b128 v[204:207], v5 offset:15360
    v_lshrrev_b32 v180, 3, v0
    v_mfma_f32_16x16x32_bf16 v[40:43], v[88:91], a[148:151], v[40:43]
    buffer_load_dwordx4 a[32:35], v6, s[56:59], s29 offen offset:512 sc1
    v_bfe_u32 v181, v0, 1, 2
    v_mfma_f32_16x16x32_bf16 v[40:43], v[92:95], a[144:147], v[40:43]
    ds_read_b128 v[64:67], v2 offset:3840
    v_and_b32 v5, 3, v180
    v_mfma_f32_16x16x32_bf16 v[40:43], v[96:99], a[140:143], v[40:43]
    v_xor_b32 v181, v181, v5
    v_lshlrev_b32 v5, 7, v180
    v_mfma_f32_16x16x32_bf16 v[40:43], v[100:103], a[136:139], v[40:43]
    ds_read_b128 v[60:63], v2 offset:3776
    v_lshl_add_u32 v5, v181, 5, v5
    v_mfma_f32_16x16x32_bf16 v[40:43], v[104:107], a[132:135], v[40:43]
    buffer_load_dwordx4 a[36:39], v7, s[56:59], s26 offen offset:512 sc1
    v_and_b32 v181, 1, v0
    v_mfma_f32_16x16x32_bf16 v[40:43], v[108:111], a[128:131], v[40:43]
    ds_read_b128 v[56:59], v2 offset:3712
    v_lshl_add_u32 v5, v181, 4, v5
    s_waitcnt lgkmcnt(9)
    v_mfma_f32_16x16x32_bf16 v[44:47], a[0:3], v[76:79], v[44:47]
    v_mfma_f32_16x16x32_bf16 v[44:47], v[12:15], v[76:79], v[44:47]
    ds_read_b128 v[52:55], v2 offset:3648
    s_waitcnt lgkmcnt(9)
    v_mfma_f32_16x16x32_bf16 v[44:47], a[4:7], v[72:75], v[44:47]
    buffer_load_dword v176, v4, s[56:59], s30 offen sc1
    s_waitcnt lgkmcnt(6)
    v_lshlrev_b32 v8, 16, v188
    v_mfma_f32_16x16x32_bf16 v[44:47], a[8:11], v[68:71], v[44:47]
    buffer_load_dwordx4 a[40:43], v6, s[56:59], s26 offen offset:1024 sc1
    ds_read_b128 v[48:51], v2 offset:3584
    s_waitcnt lgkmcnt(4)
    v_mfma_f32_16x16x32_bf16 v[44:47], a[12:15], v[64:67], v[44:47]
    v_and_b32 v9, s38, v188
    v_pk_fma_f32 v[192:193], v[8:9], v[192:193], v[196:197]
    s_waitcnt lgkmcnt(3)
    v_mfma_f32_16x16x32_bf16 v[44:47], a[16:19], v[60:63], v[44:47]
    v_pk_fma_f32 v[192:193], v[192:193], v[40:41], v[8:9]
    v_lshlrev_b32 v8, 16, v189
    s_waitcnt lgkmcnt(2)
    v_mfma_f32_16x16x32_bf16 v[44:47], a[20:23], v[56:59], v[44:47]
    v_and_b32 v9, s38, v189
    v_pk_fma_f32 v[194:195], v[8:9], v[194:195], v[198:199]
    s_waitcnt lgkmcnt(1)
    v_mfma_f32_16x16x32_bf16 v[44:47], a[24:27], v[52:55], v[44:47]
    buffer_load_dwordx4 a[44:47], v6, s[56:59], s29 offen offset:1024 sc1
    v_pk_fma_f32 v[194:195], v[194:195], v[42:43], v[8:9]
    s_waitcnt lgkmcnt(0)
    v_mfma_f32_16x16x32_bf16 v[44:47], a[28:31], v[48:51], v[44:47]
    v_cvt_pk_bf16_f32 v196, v192, v193
    v_cvt_pk_bf16_f32 v197, v194, v195
    v_mfma_f32_16x16x32_bf16 v[44:47], a[96:99], a[156:159], v[44:47]
    v_mfma_f32_16x16x32_bf16 v[44:47], a[100:103], a[152:155], v[44:47]
    v_mfma_f32_16x16x32_bf16 v[44:47], a[104:107], a[148:151], v[44:47]
    buffer_load_dwordx4 a[48:51], v7, s[56:59], s26 offen offset:1024 sc1
    v_mfma_f32_16x16x32_bf16 v[44:47], a[108:111], a[144:147], v[44:47]
    v_mfma_f32_16x16x32_bf16 v[44:47], a[112:115], a[140:143], v[44:47]
    v_mfma_f32_16x16x32_bf16 v[44:47], a[116:119], a[136:139], v[44:47]
    v_mfma_f32_16x16x32_bf16 v[44:47], a[120:123], a[132:135], v[44:47]
    buffer_load_dwordx4 a[52:55], v6, s[56:59], s26 offen offset:1536 sc1
    v_mfma_f32_16x16x32_bf16 v[44:47], a[124:127], a[128:131], v[44:47]
    s_nop 7
    v_lshlrev_b32 v8, 16, v190
    v_and_b32 v9, s38, v190
    v_pk_fma_f32 v[200:201], v[8:9], v[200:201], v[204:205]
    v_pk_fma_f32 v[200:201], v[200:201], v[44:45], v[8:9]
    v_lshlrev_b32 v8, 16, v191
    v_and_b32 v9, s38, v191
    v_pk_fma_f32 v[202:203], v[8:9], v[202:203], v[206:207]
    v_pk_fma_f32 v[202:203], v[202:203], v[46:47], v[8:9]
    v_cvt_pk_bf16_f32 v198, v200, v201
    v_cvt_pk_bf16_f32 v199, v202, v203
    s_nop 1
    v_permlane16_swap_b32 v196, v198
    v_permlane16_swap_b32 v197, v199
    buffer_store_dwordx4 v[196:199], v10, s[56:59], s43 offen sc1
    buffer_load_dwordx4 a[56:59], v6, s[56:59], s29 offen offset:1536 sc1
    buffer_load_dwordx4 a[60:63], v7, s[56:59], s26 offen offset:1536 sc1
    s_or_b32 s52, s62, s63
    s_cbranch_scc0 FZ_WOK
    v_xor_b32 v6, s63, v6
    v_xor_b32 v7, s63, v7
    s_cmp_eq_u32 s63, 0
    s_cbranch_scc1 FZ_W28
L_sequen_pl_3:
    buffer_load_dword v183, v182, s[56:59], s55 offen sc1
    s_waitcnt vmcnt(0)
    v_cmp_ne_u32 vcc, s60, v183
    s_cbranch_vccz L_sequen_pd_4
    s_sub_u32 s61, s61, 1
    s_cbranch_scc0 L_sequen_pl_3
    s_mov_b32 s61, 0
L_sequen_pd_4:
    buffer_load_dwordx4 a[224:227], v6, s[56:59], s28 offen offset:512 sc1
    buffer_load_dwordx4 a[228:231], v7, s[56:59], s25 offen offset:512 sc1
    buffer_load_dwordx4 a[232:235], v6, s[56:59], s25 offen offset:1024 sc1
    buffer_load_dwordx4 a[236:239], v6, s[56:59], s28 offen offset:1024 sc1
    buffer_load_dwordx4 a[240:243], v7, s[56:59], s25 offen offset:1024 sc1
    buffer_load_dwordx4 a[244:247], v6, s[56:59], s25 offen offset:1536 sc1
    buffer_load_dwordx4 a[248:251], v6, s[56:59], s28 offen offset:1536 sc1
    buffer_load_dwordx4 a[252:255], v7, s[56:59], s25 offen offset:1536 sc1
    buffer_load_dwordx4 a[64:67], v6, s[56:59], s25 offen offset:2048 sc1
    buffer_load_dwordx4 a[68:71], v6, s[56:59], s28 offen offset:2048 sc1
    buffer_load_dwordx4 a[72:75], v7, s[56:59], s25 offen offset:2048 sc1
    buffer_load_dwordx4 a[76:79], v6, s[56:59], s25 offen offset:2560 sc1
    buffer_load_dwordx4 a[80:83], v6, s[56:59], s28 offen offset:2560 sc1
    buffer_load_dwordx4 a[84:87], v7, s[56:59], s25 offen offset:2560 sc1
    buffer_load_dwordx4 a[88:91], v6, s[56:59], s25 offen offset:3072 sc1
    buffer_load_dwordx4 a[92:95], v6, s[56:59], s28 offen offset:3072 sc1
    buffer_load_dwordx4 a[192:195], v7, s[56:59], s25 offen offset:3072 sc1
    buffer_load_dwordx4 a[196:199], v6, s[56:59], s25 offen offset:3584 sc1
    buffer_load_dwordx4 a[200:203], v6, s[56:59], s28 offen offset:3584 sc1
    buffer_load_dwordx4 a[204:207], v7, s[56:59], s25 offen offset:3584 sc1
    buffer_load_dwordx4 a[208:211], v6, s[56:59], s26 offen offset:0 sc1
    buffer_load_dwordx4 a[212:215], v6, s[56:59], s29 offen offset:0 sc1
    buffer_load_dwordx4 a[216:219], v7, s[56:59], s26 offen offset:0 sc1
    buffer_load_dwordx4 a[220:223], v6, s[56:59], s26 offen offset:512 sc1
    buffer_load_dwordx4 a[32:35], v6, s[56:59], s29 offen offset:512 sc1
    buffer_load_dwordx4 a[36:39], v7, s[56:59], s26 offen offset:512 sc1
    buffer_load_dwordx4 a[40:43], v6, s[56:59], s26 offen offset:1024 sc1
    buffer_load_dwordx4 a[44:47], v6, s[56:59], s29 offen offset:1024 sc1
    buffer_load_dwordx4 a[48:51], v7, s[56:59], s26 offen offset:1024 sc1
    buffer_load_dwordx4 a[52:55], v6, s[56:59], s26 offen offset:1536 sc1
    buffer_load_dwordx4 a[56:59], v6, s[56:59], s29 offen offset:1536 sc1
    buffer_load_dwordx4 a[60:63], v7, s[56:59], s26 offen offset:1536 sc1
FZ_W28:
    buffer_load_dwordx4 v[208:211], v6, s[56:59], s24 offen offset:0 sc1
    buffer_load_dwordx4 v[212:215], v6, s[56:59], s27 offen offset:0 sc1
    buffer_load_dwordx4 v[216:219], v7, s[56:59], s24 offen offset:0 sc1
    buffer_load_dwordx4 v[220:223], v6, s[56:59], s24 offen offset:512 sc1
    buffer_load_dwordx4 v[224:227], v6, s[56:59], s27 offen offset:512 sc1
    buffer_load_dwordx4 v[228:231], v7, s[56:59], s24 offen offset:512 sc1
    buffer_load_dwordx4 v[232:235], v6, s[56:59], s24 offen offset:1024 sc1
    buffer_load_dwordx4 v[236:239], v6, s[56:59], s27 offen offset:1024 sc1
    buffer_load_dwordx4 v[240:243], v7, s[56:59], s24 offen offset:1024 sc1
    buffer_load_dwordx4 v[244:247], v6, s[56:59], s24 offen offset:1536 sc1
    buffer_load_dwordx4 v[248:251], v6, s[56:59], s27 offen offset:1536 sc1
    buffer_load_dwordx4 v[252:255], v7, s[56:59], s24 offen offset:1536 sc1
    buffer_load_dwordx4 v[112:115], v6, s[56:59], s24 offen offset:2048 sc1
    buffer_load_dwordx4 v[116:119], v6, s[56:59], s27 offen offset:2048 sc1
    buffer_load_dwordx4 v[120:123], v7, s[56:59], s24 offen offset:2048 sc1
    buffer_load_dwordx4 v[124:127], v6, s[56:59], s24 offen offset:2560 sc1
    buffer_load_dwordx4 v[128:131], v6, s[56:59], s27 offen offset:2560 sc1
    buffer_load_dwordx4 v[132:135], v7, s[56:59], s24 offen offset:2560 sc1
    buffer_load_dwordx4 v[136:139], v6, s[56:59], s24 offen offset:3072 sc1
    buffer_load_dwordx4 v[140:143], v6, s[56:59], s27 offen offset:3072 sc1
    buffer_load_dwordx4 v[144:147], v7, s[56:59], s24 offen offset:3072 sc1
    buffer_load_dwordx4 v[148:151], v6, s[56:59], s24 offen offset:3584 sc1
    buffer_load_dwordx4 v[152:155], v6, s[56:59], s27 offen offset:3584 sc1
    buffer_load_dwordx4 v[156:159], v7, s[56:59], s24 offen offset:3584 sc1
    buffer_load_dwordx4 v[160:163], v6, s[56:59], s25 offen offset:0 sc1
    buffer_load_dwordx4 v[164:167], v6, s[56:59], s28 offen offset:0 sc1
    buffer_load_dwordx4 v[168:171], v7, s[56:59], s25 offen offset:0 sc1
    buffer_load_dwordx4 v[172:175], v6, s[56:59], s25 offen offset:512 sc1
FZ_WOK:
    v_xor_b32 v6, 32, v5
    s_barrier
    v_cmp_ne_u32 vcc, s60, v177
    s_cbranch_vccz L_sequen_cd_5
L_sequen_pl_6:
    buffer_load_dword v177, v178, s[56:59], s23 offen sc1
    s_waitcnt vmcnt(0)
    v_cmp_ne_u32 vcc, s60, v177
    s_cbranch_vccz L_sequen_pd_7
    s_sub_u32 s61, s61, 1
    s_cbranch_scc0 L_sequen_pl_6
    s_mov_b32 s61, 0
L_sequen_pd_7:
L_sequen_cd_5:
    s_waitcnt vmcnt(7)
    v_cmp_ne_u32 vcc, s60, v176
    s_cbranch_vccz L_sequen_cd_8
L_sequen_pl_9:
    buffer_load_dword v176, v4, s[56:59], s30 offen sc1
    s_waitcnt vmcnt(0)
    v_cmp_ne_u32 vcc, s60, v176
    s_cbranch_vccz L_sequen_pd_10
    s_sub_u32 s61, s61, 1
    s_cbranch_scc0 L_sequen_pl_9
    s_mov_b32 s61, 0
L_sequen_pd_10:
L_sequen_cd_8:
    s_branch FZ_G1
FZ_AROLE:
    s_lshr_b32 s63, s2, 3
    s_mul_i32 s63, s63, 0
    s_add_u32 s63, s63, s2
    s_and_b32 s63, s63, 7
    s_andn2_b32 s32, s2, 7
    s_or_b32 s63, s63, s32
    s_sub_u32 s32, s63, 160
    s_cmp_ge_u32 s32, 24
    s_cselect_b32 s33, 1, 0
    s_mul_i32 s34, s33, 24
    s_sub_u32 s32, s32, s34
    v_and_b32 v0, 63, v0
    v_lshrrev_b32 v3, 3, v0
    v_bfe_u32 v4, v0, 1, 2
    v_and_b32 v5, 3, v3
    v_xor_b32 v4, v4, v5
    s_and_b32 s34, s3, 1
    v_xor_b32 v4, s34, v4
    v_mul_u32_u24 v3, 3072, v3
    v_lshl_add_u32 v3, v4, 5, v3
    v_and_b32 v4, 1, v0
    v_lshl_add_u32 v3, v4, 4, v3
    s_mul_i32 s34, s3, 24576
    s_lshl_b32 s35, s32, 7
    s_add_u32 s34, s34, s35
    s_lshl_b32 s35, s3, 10
    s_cmp_eq_u32 s33, 1
    s_waitcnt lgkmcnt(0)
    s_cselect_b32 s40, s42, s40
    s_cselect_b32 s41, s43, s41
    s_mov_b32 s20, s40
    s_mov_b32 s21, s41
    s_mov_b32 s22, 1966080
    s_mov_b32 s23, 0x00020000
    s_add_u32 m0, s35, 0
    s_add_u32 s36, s34, 0
    buffer_load_dwordx4 v3, s[20:23], s36 offen nt lds
    s_add_u32 m0, s35, 4096
    s_add_u32 s36, s34, 98304
    buffer_load_dwordx4 v3, s[20:23], s36 offen nt lds
    s_add_u32 m0, s35, 8192
    s_add_u32 s36, s34, 196608
    buffer_load_dwordx4 v3, s[20:23], s36 offen nt lds
    s_add_u32 m0, s35, 12288
    s_add_u32 s36, s34, 294912
    buffer_load_dwordx4 v3, s[20:23], s36 offen nt lds
    s_add_u32 m0, s35, 16384
    s_add_u32 s36, s34, 393216
    buffer_load_dwordx4 v3, s[20:23], s36 offen nt lds
    s_add_u32 m0, s35, 20480
    s_add_u32 s36, s34, 491520
    buffer_load_dwordx4 v3, s[20:23], s36 offen nt lds
    s_add_u32 m0, s35, 24576
    s_add_u32 s36, s34, 589824
    buffer_load_dwordx4 v3, s[20:23], s36 offen nt lds
    s_add_u32 m0, s35, 28672
    s_add_u32 s36, s34, 688128
    buffer_load_dwordx4 v3, s[20:23], s36 offen nt lds
    s_add_u32 m0, s35, 32768
    s_add_u32 s36, s34, 786432
    buffer_load_dwordx4 v3, s[20:23], s36 offen nt lds
    s_add_u32 m0, s35, 36864
    s_add_u32 s36, s34, 884736
    buffer_load_dwordx4 v3, s[20:23], s36 offen nt lds
    s_add_u32 m0, s35, 40960
    s_add_u32 s36, s34, 983040
    buffer_load_dwordx4 v3, s[20:23], s36 offen nt lds
    s_add_u32 m0, s35, 45056
    s_add_u32 s36, s34, 1081344
    buffer_load_dwordx4 v3, s[20:23], s36 offen nt lds
    s_add_u32 m0, s35, 49152
    s_add_u32 s36, s34, 1179648
    buffer_load_dwordx4 v3, s[20:23], s36 offen nt lds
    s_add_u32 m0, s35, 53248
    s_add_u32 s36, s34, 1277952
    buffer_load_dwordx4 v3, s[20:23], s36 offen nt lds
    s_add_u32 m0, s35, 57344
    s_add_u32 s36, s34, 1376256
    buffer_load_dwordx4 v3, s[20:23], s36 offen nt lds
    s_add_u32 m0, s35, 61440
    s_add_u32 s36, s34, 1474560
    buffer_load_dwordx4 v3, s[20:23], s36 offen nt lds
    s_add_u32 m0, s35, 65536
    s_add_u32 s36, s34, 1572864
    buffer_load_dwordx4 v3, s[20:23], s36 offen nt lds
    s_add_u32 m0, s35, 69632
    s_add_u32 s36, s34, 1671168
    buffer_load_dwordx4 v3, s[20:23], s36 offen nt lds
    s_add_u32 m0, s35, 73728
    s_add_u32 s36, s34, 1769472
    buffer_load_dwordx4 v3, s[20:23], s36 offen nt lds
    s_add_u32 m0, s35, 77824
    s_add_u32 s36, s34, 1867776
    buffer_load_dwordx4 v3, s[20:23], s36 offen nt lds
    s_mov_b32 s58, 25165824
    s_mov_b32 s59, 0x00020000
    s_mov_b32 s60, 24641536
    s_load_dword s60, s[56:57], s60
    v_lshrrev_b32 v4, 4, v0
    v_bfe_u32 v5, v0, 2, 2
    v_lshl_add_u32 v6, v4, 3, v5
    v_lshlrev_b32 v6, 7, v6
    v_and_b32 v7, 1, v4
    v_xor_b32 v7, v7, v5
    v_xor_b32 v7, s3, v7
    v_lshl_add_u32 v6, v7, 5, v6
    v_and_b32 v7, 3, v0
    v_lshl_add_u32 v5, v7, 3, v6
    v_add_u32 v8, 0x10000, v5
    v_bfe_u32 v6, v0, 3, 1
    v_mul_u32_u24 v6, 10240, v6
    v_lshl_add_u32 v6, v4, 7, v6
    v_and_b32 v7, 7, v0
    v_lshl_add_u32 v6, v7, 4, v6
    s_lshl_b32 s34, s32, 2
    s_add_u32 s34, s34, s3
    s_mul_i32 s34, s34, 20480
    s_mul_i32 s35, s33, 1966080
    s_add_u32 s34, s34, s35
    s_add_u32 s34, s34, 9437184
    v_mov_b32 v12, 0x3f803f80
    v_mov_b32 v13, v12
    v_mov_b32 v14, v12
    v_mov_b32 v15, v12
    s_mov_b32 s38, 0xffff0000
    s_waitcnt lgkmcnt(0)
    s_mul_i32 s60, s60, 1664525
    s_add_u32 s60, s60, 1013904223
    s_waitcnt vmcnt(0)
    s_barrier
    ds_read_b64_tr_b16 v[16:17], v5 offset:0
    ds_read_b64_tr_b16 v[18:19], v5 offset:512
    ds_read_b64_tr_b16 v[20:21], v5 offset:4096
    ds_read_b64_tr_b16 v[22:23], v5 offset:4608
    ds_read_b64_tr_b16 v[24:25], v5 offset:8192
    ds_read_b64_tr_b16 v[26:27], v5 offset:8704
    ds_read_b64_tr_b16 v[28:29], v5 offset:12288
    ds_read_b64_tr_b16 v[30:31], v5 offset:12800
    ds_read_b64_tr_b16 v[32:33], v5 offset:16384
    ds_read_b64_tr_b16 v[34:35], v5 offset:16896
    ds_read_b64_tr_b16 v[36:37], v5 offset:20480
    ds_read_b64_tr_b16 v[38:39], v5 offset:20992
    ds_read_b64_tr_b16 v[40:41], v5 offset:24576
    ds_read_b64_tr_b16 v[42:43], v5 offset:25088
    s_waitcnt lgkmcnt(12)
    v_mfma_f32_16x16x32_bf16 v[96:99], v[12:15], v[16:19], 0
    ds_read_b64_tr_b16 v[44:45], v5 offset:28672
    ds_read_b64_tr_b16 v[46:47], v5 offset:29184
    s_waitcnt lgkmcnt(12)
    v_mfma_f32_16x16x32_bf16 v[96:99], v[12:15], v[20:23], v[96:99]
    ds_read_b64_tr_b16 v[48:49], v5 offset:32768
    ds_read_b64_tr_b16 v[50:51], v5 offset:33280
    s_waitcnt lgkmcnt(12)
    v_mfma_f32_16x16x32_bf16 v[96:99], v[12:15], v[24:27], v[96:99]
    ds_read_b64_tr_b16 v[52:53], v5 offset:36864
    ds_read_b64_tr_b16 v[54:55], v5 offset:37376
    s_waitcnt lgkmcnt(12)
    v_mfma_f32_16x16x32_bf16 v[96:99], v[12:15], v[28:31], v[96:99]
    ds_read_b64_tr_b16 v[56:57], v5 offset:40960
    ds_read_b64_tr_b16 v[58:59], v5 offset:41472
    s_waitcnt lgkmcnt(12)
    v_mfma_f32_16x16x32_bf16 v[96:99], v[12:15], v[32:35], v[96:99]
    ds_read_b64_tr_b16 v[60:61], v5 offset:45056
    ds_read_b64_tr_b16 v[62:63], v5 offset:45568
    s_waitcnt lgkmcnt(12)
    v_mfma_f32_16x16x32_bf16 v[96:99], v[12:15], v[36:39], v[96:99]
    ds_read_b64_tr_b16 v[64:65], v5 offset:49152
    ds_read_b64_tr_b16 v[66:67], v5 offset:49664
    s_waitcnt lgkmcnt(12)
    v_mfma_f32_16x16x32_bf16 v[96:99], v[12:15], v[40:43], v[96:99]
    ds_read_b64_tr_b16 v[68:69], v5 offset:53248
    ds_read_b64_tr_b16 v[70:71], v5 offset:53760
    s_waitcnt lgkmcnt(12)
    v_mfma_f32_16x16x32_bf16 v[96:99], v[12:15], v[44:47], v[96:99]
    ds_read_b64_tr_b16 v[72:73], v5 offset:57344
    ds_read_b64_tr_b16 v[74:75], v5 offset:57856
    s_waitcnt lgkmcnt(12)
    v_mfma_f32_16x16x32_bf16 v[96:99], v[12:15], v[48:51], v[96:99]
    ds_read_b64_tr_b16 v[76:77], v5 offset:61440
    ds_read_b64_tr_b16 v[78:79], v5 offset:61952
    s_waitcnt lgkmcnt(12)
    v_mfma_f32_16x16x32_bf16 v[96:99], v[12:15], v[52:55], v[96:99]
    ds_read_b64_tr_b16 v[80:81], v8 offset:0
    ds_read_b64_tr_b16 v[82:83], v8 offset:512
    s_waitcnt lgkmcnt(12)
    v_mfma_f32_16x16x32_bf16 v[96:99], v[12:15], v[56:59], v[96:99]
    ds_read_b64_tr_b16 v[84:85], v8 offset:4096
    ds_read_b64_tr_b16 v[86:87], v8 offset:4608
    s_waitcnt lgkmcnt(12)
    v_mfma_f32_16x16x32_bf16 v[96:99], v[12:15], v[60:63], v[96:99]
    ds_read_b64_tr_b16 v[88:89], v8 offset:8192
    ds_read_b64_tr_b16 v[90:91], v8 offset:8704
    s_waitcnt lgkmcnt(12)
    v_mfma_f32_16x16x32_bf16 v[96:99], v[12:15], v[64:67], v[96:99]
    ds_read_b64_tr_b16 v[92:93], v8 offset:12288
    ds_read_b64_tr_b16 v[94:95], v8 offset:12800
    s_waitcnt lgkmcnt(12)
    v_mfma_f32_16x16x32_bf16 v[96:99], v[12:15], v[68:71], v[96:99]
    s_waitcnt lgkmcnt(10)
    v_mfma_f32_16x16x32_bf16 v[96:99], v[12:15], v[72:75], v[96:99]
    s_waitcnt lgkmcnt(8)
    v_mfma_f32_16x16x32_bf16 v[96:99], v[12:15], v[76:79], v[96:99]
    s_waitcnt lgkmcnt(6)
    v_mfma_f32_16x16x32_bf16 v[96:99], v[12:15], v[80:83], v[96:99]
    s_waitcnt lgkmcnt(4)
    v_mfma_f32_16x16x32_bf16 v[96:99], v[12:15], v[84:87], v[96:99]
    s_waitcnt lgkmcnt(2)
    v_mfma_f32_16x16x32_bf16 v[96:99], v[12:15], v[88:91], v[96:99]
    s_waitcnt lgkmcnt(0)
    v_mfma_f32_16x16x32_bf16 v[96:99], v[12:15], v[92:95], v[96:99]
    s_nop 7
    s_nop 1
    v_mul_f32 v96, 0xbacccccd, v96
    v_mov_b32 v97, v96
    v_lshlrev_b32 v100, 16, v16
    v_and_b32 v101, s38, v16
    v_lshlrev_b32 v102, 16, v17
    v_and_b32 v103, s38, v17
    v_lshlrev_b32 v104, 16, v18
    v_and_b32 v105, s38, v18
    v_lshlrev_b32 v106, 16, v19
    v_and_b32 v107, s38, v19
    v_pk_add_f32 v[100:101], v[100:101], v[96:97]
    v_pk_add_f32 v[102:103], v[102:103], v[96:97]
    v_pk_add_f32 v[104:105], v[104:105], v[96:97]
    v_pk_add_f32 v[106:107], v[106:107], v[96:97]
    v_cvt_pk_bf16_f32 v16, v100, v101
    v_cvt_pk_bf16_f32 v17, v102, v103
    v_cvt_pk_bf16_f32 v18, v104, v105
    v_cvt_pk_bf16_f32 v19, v106, v107
    buffer_store_dwordx4 v[16:19], v6, s[56:59], s34 offen offset:0 sc1
    v_lshlrev_b32 v108, 16, v20
    v_and_b32 v109, s38, v20
    v_lshlrev_b32 v110, 16, v21
    v_and_b32 v111, s38, v21
    v_lshlrev_b32 v112, 16, v22
    v_and_b32 v113, s38, v22
    v_lshlrev_b32 v114, 16, v23
    v_and_b32 v115, s38, v23
    v_pk_add_f32 v[108:109], v[108:109], v[96:97]
    v_pk_add_f32 v[110:111], v[110:111], v[96:97]
    v_pk_add_f32 v[112:113], v[112:113], v[96:97]
    v_pk_add_f32 v[114:115], v[114:115], v[96:97]
    v_cvt_pk_bf16_f32 v20, v108, v109
    v_cvt_pk_bf16_f32 v21, v110, v111
    v_cvt_pk_bf16_f32 v22, v112, v113
    v_cvt_pk_bf16_f32 v23, v114, v115
    buffer_store_dwordx4 v[20:23], v6, s[56:59], s34 offen offset:512 sc1
    v_lshlrev_b32 v100, 16, v24
    v_and_b32 v101, s38, v24
    v_lshlrev_b32 v102, 16, v25
    v_and_b32 v103, s38, v25
    v_lshlrev_b32 v104, 16, v26
    v_and_b32 v105, s38, v26
    v_lshlrev_b32 v106, 16, v27
    v_and_b32 v107, s38, v27
    v_pk_add_f32 v[100:101], v[100:101], v[96:97]
    v_pk_add_f32 v[102:103], v[102:103], v[96:97]
    v_pk_add_f32 v[104:105], v[104:105], v[96:97]
    v_pk_add_f32 v[106:107], v[106:107], v[96:97]
    v_cvt_pk_bf16_f32 v24, v100, v101
    v_cvt_pk_bf16_f32 v25, v102, v103
    v_cvt_pk_bf16_f32 v26, v104, v105
    v_cvt_pk_bf16_f32 v27, v106, v107
    buffer_store_dwordx4 v[24:27], v6, s[56:59], s34 offen offset:1024 sc1
    v_lshlrev_b32 v108, 16, v28
    v_and_b32 v109, s38, v28
    v_lshlrev_b32 v110, 16, v29
    v_and_b32 v111, s38, v29
    v_lshlrev_b32 v112, 16, v30
    v_and_b32 v113, s38, v30
    v_lshlrev_b32 v114, 16, v31
    v_and_b32 v115, s38, v31
    v_pk_add_f32 v[108:109], v[108:109], v[96:97]
    v_pk_add_f32 v[110:111], v[110:111], v[96:97]
    v_pk_add_f32 v[112:113], v[112:113], v[96:97]
    v_pk_add_f32 v[114:115], v[114:115], v[96:97]
    v_cvt_pk_bf16_f32 v28, v108, v109
    v_cvt_pk_bf16_f32 v29, v110, v111
    v_cvt_pk_bf16_f32 v30, v112, v113
    v_cvt_pk_bf16_f32 v31, v114, v115
    buffer_store_dwordx4 v[28:31], v6, s[56:59], s34 offen offset:1536 sc1
    v_lshlrev_b32 v100, 16, v32
    v_and_b32 v101, s38, v32
    v_lshlrev_b32 v102, 16, v33
    v_and_b32 v103, s38, v33
    v_lshlrev_b32 v104, 16, v34
    v_and_b32 v105, s38, v34
    v_lshlrev_b32 v106, 16, v35
    v_and_b32 v107, s38, v35
    v_pk_add_f32 v[100:101], v[100:101], v[96:97]
    v_pk_add_f32 v[102:103], v[102:103], v[96:97]
    v_pk_add_f32 v[104:105], v[104:105], v[96:97]
    v_pk_add_f32 v[106:107], v[106:107], v[96:97]
    v_cvt_pk_bf16_f32 v32, v100, v101
    v_cvt_pk_bf16_f32 v33, v102, v103
    v_cvt_pk_bf16_f32 v34, v104, v105
    v_cvt_pk_bf16_f32 v35, v106, v107
    buffer_store_dwordx4 v[32:35], v6, s[56:59], s34 offen offset:2048 sc1
    v_lshlrev_b32 v108, 16, v36
    v_and_b32 v109, s38, v36
    v_lshlrev_b32 v110, 16, v37
    v_and_b32 v111, s38, v37
    v_lshlrev_b32 v112, 16, v38
    v_and_b32 v113, s38, v38
    v_lshlrev_b32 v114, 16, v39
    v_and_b32 v115, s38, v39
    v_pk_add_f32 v[108:109], v[108:109], v[96:97]
    v_pk_add_f32 v[110:111], v[110:111], v[96:97]
    v_pk_add_f32 v[112:113], v[112:113], v[96:97]
    v_pk_add_f32 v[114:115], v[114:115], v[96:97]
    v_cvt_pk_bf16_f32 v36, v108, v109
    v_cvt_pk_bf16_f32 v37, v110, v111
    v_cvt_pk_bf16_f32 v38, v112, v113
    v_cvt_pk_bf16_f32 v39, v114, v115
    buffer_store_dwordx4 v[36:39], v6, s[56:59], s34 offen offset:2560 sc1
    v_lshlrev_b32 v100, 16, v40
    v_and_b32 v101, s38, v40
    v_lshlrev_b32 v102, 16, v41
    v_and_b32 v103, s38, v41
    v_lshlrev_b32 v104, 16, v42
    v_and_b32 v105, s38, v42
    v_lshlrev_b32 v106, 16, v43
    v_and_b32 v107, s38, v43
    v_pk_add_f32 v[100:101], v[100:101], v[96:97]
    v_pk_add_f32 v[102:103], v[102:103], v[96:97]
    v_pk_add_f32 v[104:105], v[104:105], v[96:97]
    v_pk_add_f32 v[106:107], v[106:107], v[96:97]
    v_cvt_pk_bf16_f32 v40, v100, v101
    v_cvt_pk_bf16_f32 v41, v102, v103
    v_cvt_pk_bf16_f32 v42, v104, v105
    v_cvt_pk_bf16_f32 v43, v106, v107
    buffer_store_dwordx4 v[40:43], v6, s[56:59], s34 offen offset:3072 sc1
    v_lshlrev_b32 v108, 16, v44
    v_and_b32 v109, s38, v44
    v_lshlrev_b32 v110, 16, v45
    v_and_b32 v111, s38, v45
    v_lshlrev_b32 v112, 16, v46
    v_and_b32 v113, s38, v46
    v_lshlrev_b32 v114, 16, v47
    v_and_b32 v115, s38, v47
    v_pk_add_f32 v[108:109], v[108:109], v[96:97]
    v_pk_add_f32 v[110:111], v[110:111], v[96:97]
    v_pk_add_f32 v[112:113], v[112:113], v[96:97]
    v_pk_add_f32 v[114:115], v[114:115], v[96:97]
    v_cvt_pk_bf16_f32 v44, v108, v109
    v_cvt_pk_bf16_f32 v45, v110, v111
    v_cvt_pk_bf16_f32 v46, v112, v113
    v_cvt_pk_bf16_f32 v47, v114, v115
    buffer_store_dwordx4 v[44:47], v6, s[56:59], s34 offen offset:3584 sc1
    s_add_u32 s34, s34, 4096
    v_lshlrev_b32 v100, 16, v48
    v_and_b32 v101, s38, v48
    v_lshlrev_b32 v102, 16, v49
    v_and_b32 v103, s38, v49
    v_lshlrev_b32 v104, 16, v50
    v_and_b32 v105, s38, v50
    v_lshlrev_b32 v106, 16, v51
    v_and_b32 v107, s38, v51
    v_pk_add_f32 v[100:101], v[100:101], v[96:97]
    v_pk_add_f32 v[102:103], v[102:103], v[96:97]
    v_pk_add_f32 v[104:105], v[104:105], v[96:97]
    v_pk_add_f32 v[106:107], v[106:107], v[96:97]
    v_cvt_pk_bf16_f32 v48, v100, v101
    v_cvt_pk_bf16_f32 v49, v102, v103
    v_cvt_pk_bf16_f32 v50, v104, v105
    v_cvt_pk_bf16_f32 v51, v106, v107
    buffer_store_dwordx4 v[48:51], v6, s[56:59], s34 offen offset:0 sc1
    v_lshlrev_b32 v108, 16, v52
    v_and_b32 v109, s38, v52
    v_lshlrev_b32 v110, 16, v53
    v_and_b32 v111, s38, v53
    v_lshlrev_b32 v112, 16, v54
    v_and_b32 v113, s38, v54
    v_lshlrev_b32 v114, 16, v55
    v_and_b32 v115, s38, v55
    v_pk_add_f32 v[108:109], v[108:109], v[96:97]
    v_pk_add_f32 v[110:111], v[110:111], v[96:97]
    v_pk_add_f32 v[112:113], v[112:113], v[96:97]
    v_pk_add_f32 v[114:115], v[114:115], v[96:97]
    v_cvt_pk_bf16_f32 v52, v108, v109
    v_cvt_pk_bf16_f32 v53, v110, v111
    v_cvt_pk_bf16_f32 v54, v112, v113
    v_cvt_pk_bf16_f32 v55, v114, v115
    buffer_store_dwordx4 v[52:55], v6, s[56:59], s34 offen offset:512 sc1
    v_lshlrev_b32 v100, 16, v56
    v_and_b32 v101, s38, v56
    v_lshlrev_b32 v102, 16, v57
    v_and_b32 v103, s38, v57
    v_lshlrev_b32 v104, 16, v58
    v_and_b32 v105, s38, v58
    v_lshlrev_b32 v106, 16, v59
    v_and_b32 v107, s38, v59
    v_pk_add_f32 v[100:101], v[100:101], v[96:97]
    v_pk_add_f32 v[102:103], v[102:103], v[96:97]
    v_pk_add_f32 v[104:105], v[104:105], v[96:97]
    v_pk_add_f32 v[106:107], v[106:107], v[96:97]
    v_cvt_pk_bf16_f32 v56, v100, v101
    v_cvt_pk_bf16_f32 v57, v102, v103
    v_cvt_pk_bf16_f32 v58, v104, v105
    v_cvt_pk_bf16_f32 v59, v106, v107
    buffer_store_dwordx4 v[56:59], v6, s[56:59], s34 offen offset:1024 sc1
    v_lshlrev_b32 v108, 16, v60
    v_and_b32 v109, s38, v60
    v_lshlrev_b32 v110, 16, v61
    v_and_b32 v111, s38, v61
    v_lshlrev_b32 v112, 16, v62
    v_and_b32 v113, s38, v62
    v_lshlrev_b32 v114, 16, v63
    v_and_b32 v115, s38, v63
    v_pk_add_f32 v[108:109], v[108:109], v[96:97]
    v_pk_add_f32 v[110:111], v[110:111], v[96:97]
    v_pk_add_f32 v[112:113], v[112:113], v[96:97]
    v_pk_add_f32 v[114:115], v[114:115], v[96:97]
    v_cvt_pk_bf16_f32 v60, v108, v109
    v_cvt_pk_bf16_f32 v61, v110, v111
    v_cvt_pk_bf16_f32 v62, v112, v113
    v_cvt_pk_bf16_f32 v63, v114, v115
    buffer_store_dwordx4 v[60:63], v6, s[56:59], s34 offen offset:1536 sc1
    v_lshlrev_b32 v100, 16, v64
    v_and_b32 v101, s38, v64
    v_lshlrev_b32 v102, 16, v65
    v_and_b32 v103, s38, v65
    v_lshlrev_b32 v104, 16, v66
    v_and_b32 v105, s38, v66
    v_lshlrev_b32 v106, 16, v67
    v_and_b32 v107, s38, v67
    v_pk_add_f32 v[100:101], v[100:101], v[96:97]
    v_pk_add_f32 v[102:103], v[102:103], v[96:97]
    v_pk_add_f32 v[104:105], v[104:105], v[96:97]
    v_pk_add_f32 v[106:107], v[106:107], v[96:97]
    v_cvt_pk_bf16_f32 v64, v100, v101
    v_cvt_pk_bf16_f32 v65, v102, v103
    v_cvt_pk_bf16_f32 v66, v104, v105
    v_cvt_pk_bf16_f32 v67, v106, v107
    buffer_store_dwordx4 v[64:67], v6, s[56:59], s34 offen offset:2048 sc1
    v_lshlrev_b32 v108, 16, v68
    v_and_b32 v109, s38, v68
    v_lshlrev_b32 v110, 16, v69
    v_and_b32 v111, s38, v69
    v_lshlrev_b32 v112, 16, v70
    v_and_b32 v113, s38, v70
    v_lshlrev_b32 v114, 16, v71
    v_and_b32 v115, s38, v71
    v_pk_add_f32 v[108:109], v[108:109], v[96:97]
    v_pk_add_f32 v[110:111], v[110:111], v[96:97]
    v_pk_add_f32 v[112:113], v[112:113], v[96:97]
    v_pk_add_f32 v[114:115], v[114:115], v[96:97]
    v_cvt_pk_bf16_f32 v68, v108, v109
    v_cvt_pk_bf16_f32 v69, v110, v111
    v_cvt_pk_bf16_f32 v70, v112, v113
    v_cvt_pk_bf16_f32 v71, v114, v115
    buffer_store_dwordx4 v[68:71], v6, s[56:59], s34 offen offset:2560 sc1
    v_lshlrev_b32 v100, 16, v72
    v_and_b32 v101, s38, v72
    v_lshlrev_b32 v102, 16, v73
    v_and_b32 v103, s38, v73
    v_lshlrev_b32 v104, 16, v74
    v_and_b32 v105, s38, v74
    v_lshlrev_b32 v106, 16, v75
    v_and_b32 v107, s38, v75
    v_pk_add_f32 v[100:101], v[100:101], v[96:97]
    v_pk_add_f32 v[102:103], v[102:103], v[96:97]
    v_pk_add_f32 v[104:105], v[104:105], v[96:97]
    v_pk_add_f32 v[106:107], v[106:107], v[96:97]
    v_cvt_pk_bf16_f32 v72, v100, v101
    v_cvt_pk_bf16_f32 v73, v102, v103
    v_cvt_pk_bf16_f32 v74, v104, v105
    v_cvt_pk_bf16_f32 v75, v106, v107
    buffer_store_dwordx4 v[72:75], v6, s[56:59], s34 offen offset:3072 sc1
    v_lshlrev_b32 v108, 16, v76
    v_and_b32 v109, s38, v76
    v_lshlrev_b32 v110, 16, v77
    v_and_b32 v111, s38, v77
    v_lshlrev_b32 v112, 16, v78
    v_and_b32 v113, s38, v78
    v_lshlrev_b32 v114, 16, v79
    v_and_b32 v115, s38, v79
    v_pk_add_f32 v[108:109], v[108:109], v[96:97]
    v_pk_add_f32 v[110:111], v[110:111], v[96:97]
    v_pk_add_f32 v[112:113], v[112:113], v[96:97]
    v_pk_add_f32 v[114:115], v[114:115], v[96:97]
    v_cvt_pk_bf16_f32 v76, v108, v109
    v_cvt_pk_bf16_f32 v77, v110, v111
    v_cvt_pk_bf16_f32 v78, v112, v113
    v_cvt_pk_bf16_f32 v79, v114, v115
    buffer_store_dwordx4 v[76:79], v6, s[56:59], s34 offen offset:3584 sc1
    s_add_u32 s34, s34, 4096
    v_lshlrev_b32 v100, 16, v80
    v_and_b32 v101, s38, v80
    v_lshlrev_b32 v102, 16, v81
    v_and_b32 v103, s38, v81
    v_lshlrev_b32 v104, 16, v82
    v_and_b32 v105, s38, v82
    v_lshlrev_b32 v106, 16, v83
    v_and_b32 v107, s38, v83
    v_pk_add_f32 v[100:101], v[100:101], v[96:97]
    v_pk_add_f32 v[102:103], v[102:103], v[96:97]
    v_pk_add_f32 v[104:105], v[104:105], v[96:97]
    v_pk_add_f32 v[106:107], v[106:107], v[96:97]
    v_cvt_pk_bf16_f32 v80, v100, v101
    v_cvt_pk_bf16_f32 v81, v102, v103
    v_cvt_pk_bf16_f32 v82, v104, v105
    v_cvt_pk_bf16_f32 v83, v106, v107
    buffer_store_dwordx4 v[80:83], v6, s[56:59], s34 offen offset:0 sc1
    v_lshlrev_b32 v108, 16, v84
    v_and_b32 v109, s38, v84
    v_lshlrev_b32 v110, 16, v85
    v_and_b32 v111, s38, v85
    v_lshlrev_b32 v112, 16, v86
    v_and_b32 v113, s38, v86
    v_lshlrev_b32 v114, 16, v87
    v_and_b32 v115, s38, v87
    v_pk_add_f32 v[108:109], v[108:109], v[96:97]
    v_pk_add_f32 v[110:111], v[110:111], v[96:97]
    v_pk_add_f32 v[112:113], v[112:113], v[96:97]
    v_pk_add_f32 v[114:115], v[114:115], v[96:97]
    v_cvt_pk_bf16_f32 v84, v108, v109
    v_cvt_pk_bf16_f32 v85, v110, v111
    v_cvt_pk_bf16_f32 v86, v112, v113
    v_cvt_pk_bf16_f32 v87, v114, v115
    buffer_store_dwordx4 v[84:87], v6, s[56:59], s34 offen offset:512 sc1
    v_lshlrev_b32 v100, 16, v88
    v_and_b32 v101, s38, v88
    v_lshlrev_b32 v102, 16, v89
    v_and_b32 v103, s38, v89
    v_lshlrev_b32 v104, 16, v90
    v_and_b32 v105, s38, v90
    v_lshlrev_b32 v106, 16, v91
    v_and_b32 v107, s38, v91
    v_pk_add_f32 v[100:101], v[100:101], v[96:97]
    v_pk_add_f32 v[102:103], v[102:103], v[96:97]
    v_pk_add_f32 v[104:105], v[104:105], v[96:97]
    v_pk_add_f32 v[106:107], v[106:107], v[96:97]
    v_cvt_pk_bf16_f32 v88, v100, v101
    v_cvt_pk_bf16_f32 v89, v102, v103
    v_cvt_pk_bf16_f32 v90, v104, v105
    v_cvt_pk_bf16_f32 v91, v106, v107
    buffer_store_dwordx4 v[88:91], v6, s[56:59], s34 offen offset:1024 sc1
    v_lshlrev_b32 v108, 16, v92
    v_and_b32 v109, s38, v92
    v_lshlrev_b32 v110, 16, v93
    v_and_b32 v111, s38, v93
    v_lshlrev_b32 v112, 16, v94
    v_and_b32 v113, s38, v94
    v_lshlrev_b32 v114, 16, v95
    v_and_b32 v115, s38, v95
    v_pk_add_f32 v[108:109], v[108:109], v[96:97]
    v_pk_add_f32 v[110:111], v[110:111], v[96:97]
    v_pk_add_f32 v[112:113], v[112:113], v[96:97]
    v_pk_add_f32 v[114:115], v[114:115], v[96:97]
    v_cvt_pk_bf16_f32 v92, v108, v109
    v_cvt_pk_bf16_f32 v93, v110, v111
    v_cvt_pk_bf16_f32 v94, v112, v113
    v_cvt_pk_bf16_f32 v95, v114, v115
    buffer_store_dwordx4 v[92:95], v6, s[56:59], s34 offen offset:1536 sc1
    s_lshl_b32 s34, s63, 7
    s_add_u32 s34, s34, 24645632
    s_waitcnt vmcnt(0)
    s_barrier
    s_cmp_eq_u32 s3, 0
    s_cbranch_scc0 L_sequen_pf_11
    v_mov_b32 v4, s60
    v_mov_b32 v5, 0
    s_mov_b64 exec, 1
    buffer_store_dword v4, v5, s[56:59], s34 offen sc1
    s_mov_b64 exec, -1
L_sequen_pf_11:
    s_branch FZ_JOIN
FZ_STATS:
    s_sub_u32 s32, s2, 208
    s_mul_i32 s33, s32, 48
    v_add_u32 v3, s33, v2
    v_mul_u32_u24 v3, 1280, v3
    v_lshl_add_u32 v3, v1, 4, v3
    s_mov_b32 s38, 0xffff0000
    s_mov_b32 s34, 20480
    s_mov_b32 s35, 40960
    s_waitcnt lgkmcnt(0)
    s_mov_b32 s16, s4
    s_mov_b32 s17, s5
    s_mov_b32 s18, 2621440
    s_mov_b32 s19, 0x00020000
    buffer_load_dwordx4 v[8:11], v3, s[16:19], 0 offen offset:0 nt
    buffer_load_dwordx4 v[12:15], v3, s[16:19], 0 offen offset:256 nt
    buffer_load_dwordx4 v[16:19], v3, s[16:19], 0 offen offset:512 nt
    buffer_load_dwordx4 v[20:23], v3, s[16:19], 0 offen offset:768 nt
    buffer_load_dwordx4 v[24:27], v3, s[16:19], 0 offen offset:1024 nt
    buffer_load_dwordx4 v[28:31], v3, s[16:19], s34 offen offset:0 nt
    buffer_load_dwordx4 v[32:35], v3, s[16:19], s34 offen offset:256 nt
    buffer_load_dwordx4 v[36:39], v3, s[16:19], s34 offen offset:512 nt
    buffer_load_dwordx4 v[40:43], v3, s[16:19], s34 offen offset:768 nt
    buffer_load_dwordx4 v[44:47], v3, s[16:19], s34 offen offset:1024 nt
    buffer_load_dwordx4 v[48:51], v3, s[16:19], s35 offen offset:0 nt
    buffer_load_dwordx4 v[52:55], v3, s[16:19], s35 offen offset:256 nt
    buffer_load_dwordx4 v[56:59], v3, s[16:19], s35 offen offset:512 nt
    buffer_load_dwordx4 v[60:63], v3, s[16:19], s35 offen offset:768 nt
    buffer_load_dwordx4 v[64:67], v3, s[16:19], s35 offen offset:1024 nt
    s_mov_b32 s58, 25165824
    s_mov_b32 s59, 0x00020000
    s_mov_b32 s60, 24641536
    s_load_dword s60, s[56:57], s60
    v_lshlrev_b32 v2, 2, v2
    v_cmp_eq_u32 s[36:37], 0, v1
    v_and_b32 v0, 63, v0
    s_waitcnt vmcnt(14)
    v_lshlrev_b32 v72, 16, v8
    v_and_b32 v73, s38, v8
    v_lshlrev_b32 v74, 16, v9
    v_and_b32 v75, s38, v9
    v_lshlrev_b32 v76, 16, v10
    v_and_b32 v77, s38, v10
    v_lshlrev_b32 v78, 16, v11
    v_and_b32 v79, s38, v11
    s_waitcnt vmcnt(13)
    v_lshlrev_b32 v80, 16, v12
    v_and_b32 v81, s38, v12
    v_lshlrev_b32 v82, 16, v13
    v_and_b32 v83, s38, v13
    v_lshlrev_b32 v84, 16, v14
    v_and_b32 v85, s38, v14
    v_lshlrev_b32 v86, 16, v15
    v_and_b32 v87, s38, v15
    s_waitcnt vmcnt(12)
    v_lshlrev_b32 v88, 16, v16
    v_and_b32 v89, s38, v16
    v_lshlrev_b32 v90, 16, v17
    v_and_b32 v91, s38, v17
    v_lshlrev_b32 v92, 16, v18
    v_and_b32 v93, s38, v18
    v_lshlrev_b32 v94, 16, v19
    v_and_b32 v95, s38, v19
    s_waitcnt vmcnt(11)
    v_lshlrev_b32 v96, 16, v20
    v_and_b32 v97, s38, v20
    v_lshlrev_b32 v98, 16, v21
    v_and_b32 v99, s38, v21
    v_lshlrev_b32 v100, 16, v22
    v_and_b32 v101, s38, v22
    v_lshlrev_b32 v102, 16, v23
    v_and_b32 v103, s38, v23
    s_waitcnt vmcnt(10)
    v_lshlrev_b32 v104, 16, v24
    v_and_b32 v105, s38, v24
    v_lshlrev_b32 v106, 16, v25
    v_and_b32 v107, s38, v25
    v_lshlrev_b32 v108, 16, v26
    v_and_b32 v109, s38, v26
    v_lshlrev_b32 v110, 16, v27
    v_and_b32 v111, s38, v27
    v_pk_add_f32 v[4:5], v[72:73], v[74:75]
    v_pk_add_f32 v[6:7], v[76:77], v[78:79]
    v_pk_add_f32 v[4:5], v[4:5], v[80:81]
    v_pk_add_f32 v[6:7], v[6:7], v[82:83]
    v_pk_add_f32 v[4:5], v[4:5], v[84:85]
    v_pk_add_f32 v[6:7], v[6:7], v[86:87]
    v_pk_add_f32 v[4:5], v[4:5], v[88:89]
    v_pk_add_f32 v[6:7], v[6:7], v[90:91]
    v_pk_add_f32 v[4:5], v[4:5], v[92:93]
    v_pk_add_f32 v[6:7], v[6:7], v[94:95]
    v_pk_add_f32 v[4:5], v[4:5], v[96:97]
    v_pk_add_f32 v[6:7], v[6:7], v[98:99]
    v_pk_add_f32 v[4:5], v[4:5], v[100:101]
    v_pk_add_f32 v[6:7], v[6:7], v[102:103]
    v_pk_add_f32 v[4:5], v[4:5], v[104:105]
    v_pk_add_f32 v[6:7], v[6:7], v[106:107]
    v_pk_add_f32 v[4:5], v[4:5], v[108:109]
    v_pk_add_f32 v[6:7], v[6:7], v[110:111]
    v_pk_add_f32 v[4:5], v[4:5], v[6:7]
    v_add_f32 v4, v4, v5
    s_nop 1
    v_add_f32_dpp v4, v4, v4 row_ror:8 row_mask:0xf bank_mask:0xf
    s_nop 1
    v_add_f32_dpp v4, v4, v4 row_ror:4 row_mask:0xf bank_mask:0xf
    s_nop 1
    v_add_f32_dpp v4, v4, v4 row_ror:2 row_mask:0xf bank_mask:0xf
    s_nop 1
    v_add_f32_dpp v4, v4, v4 row_ror:1 row_mask:0xf bank_mask:0xf
    v_mul_f32 v4, 0xbacccccd, v4
    v_mov_b32 v5, v4
    v_pk_add_f32 v[72:73], v[72:73], v[4:5]
    v_pk_add_f32 v[74:75], v[74:75], v[4:5]
    v_pk_add_f32 v[76:77], v[76:77], v[4:5]
    v_pk_add_f32 v[78:79], v[78:79], v[4:5]
    v_pk_add_f32 v[80:81], v[80:81], v[4:5]
    v_pk_add_f32 v[82:83], v[82:83], v[4:5]
    v_pk_add_f32 v[84:85], v[84:85], v[4:5]
    v_pk_add_f32 v[86:87], v[86:87], v[4:5]
    v_pk_add_f32 v[88:89], v[88:89], v[4:5]
    v_pk_add_f32 v[90:91], v[90:91], v[4:5]
    v_pk_add_f32 v[92:93], v[92:93], v[4:5]
    v_pk_add_f32 v[94:95], v[94:95], v[4:5]
    v_pk_add_f32 v[96:97], v[96:97], v[4:5]
    v_pk_add_f32 v[98:99], v[98:99], v[4:5]
    v_pk_add_f32 v[100:101], v[100:101], v[4:5]
    v_pk_add_f32 v[102:103], v[102:103], v[4:5]
    v_pk_add_f32 v[104:105], v[104:105], v[4:5]
    v_pk_add_f32 v[106:107], v[106:107], v[4:5]
    v_pk_add_f32 v[108:109], v[108:109], v[4:5]
    v_pk_add_f32 v[110:111], v[110:111], v[4:5]
    v_pk_mul_f32 v[112:113], v[72:73], v[72:73]
    v_pk_mul_f32 v[6:7], v[74:75], v[74:75]
    v_pk_fma_f32 v[112:113], v[76:77], v[76:77], v[112:113]
    v_pk_fma_f32 v[6:7], v[78:79], v[78:79], v[6:7]
    v_pk_fma_f32 v[112:113], v[80:81], v[80:81], v[112:113]
    v_pk_fma_f32 v[6:7], v[82:83], v[82:83], v[6:7]
    v_pk_fma_f32 v[112:113], v[84:85], v[84:85], v[112:113]
    v_pk_fma_f32 v[6:7], v[86:87], v[86:87], v[6:7]
    v_pk_fma_f32 v[112:113], v[88:89], v[88:89], v[112:113]
    v_pk_fma_f32 v[6:7], v[90:91], v[90:91], v[6:7]
    v_pk_fma_f32 v[112:113], v[92:93], v[92:93], v[112:113]
    v_pk_fma_f32 v[6:7], v[94:95], v[94:95], v[6:7]
    v_pk_fma_f32 v[112:113], v[96:97], v[96:97], v[112:113]
    v_pk_fma_f32 v[6:7], v[98:99], v[98:99], v[6:7]
    v_pk_fma_f32 v[112:113], v[100:101], v[100:101], v[112:113]
    v_pk_fma_f32 v[6:7], v[102:103], v[102:103], v[6:7]
    v_pk_fma_f32 v[112:113], v[104:105], v[104:105], v[112:113]
    v_pk_fma_f32 v[6:7], v[106:107], v[106:107], v[6:7]
    v_pk_fma_f32 v[112:113], v[108:109], v[108:109], v[112:113]
    v_pk_fma_f32 v[6:7], v[110:111], v[110:111], v[6:7]
    v_pk_add_f32 v[6:7], v[112:113], v[6:7]
    v_add_f32 v6, v6, v7
    s_nop 1
    v_add_f32_dpp v6, v6, v6 row_ror:8 row_mask:0xf bank_mask:0xf
    s_nop 1
    v_add_f32_dpp v6, v6, v6 row_ror:4 row_mask:0xf bank_mask:0xf
    s_nop 1
    v_add_f32_dpp v6, v6, v6 row_ror:2 row_mask:0xf bank_mask:0xf
    s_nop 1
    v_add_f32_dpp v6, v6, v6 row_ror:1 row_mask:0xf bank_mask:0xf
    v_mov_b32 v7, 0x3727c5ac
    v_fmac_f32 v7, 0x3acccccd, v6
    v_rsq_f32 v7, v7
    s_nop 0
    v_mul_f32 v4, v4, v7
    s_mov_b64 exec, s[36:37]
    ds_write_b32 v2, v7 offset:0
    ds_write_b32 v2, v4 offset:256
    s_mov_b64 exec, -1
    s_waitcnt vmcnt(9)
    v_lshlrev_b32 v72, 16, v28
    v_and_b32 v73, s38, v28
    v_lshlrev_b32 v74, 16, v29
    v_and_b32 v75, s38, v29
    v_lshlrev_b32 v76, 16, v30
    v_and_b32 v77, s38, v30
    v_lshlrev_b32 v78, 16, v31
    v_and_b32 v79, s38, v31
    s_waitcnt vmcnt(8)
    v_lshlrev_b32 v80, 16, v32
    v_and_b32 v81, s38, v32
    v_lshlrev_b32 v82, 16, v33
    v_and_b32 v83, s38, v33
    v_lshlrev_b32 v84, 16, v34
    v_and_b32 v85, s38, v34
    v_lshlrev_b32 v86, 16, v35
    v_and_b32 v87, s38, v35
    s_waitcnt vmcnt(7)
    v_lshlrev_b32 v88, 16, v36
    v_and_b32 v89, s38, v36
    v_lshlrev_b32 v90, 16, v37
    v_and_b32 v91, s38, v37
    v_lshlrev_b32 v92, 16, v38
    v_and_b32 v93, s38, v38
    v_lshlrev_b32 v94, 16, v39
    v_and_b32 v95, s38, v39
    s_waitcnt vmcnt(6)
    v_lshlrev_b32 v96, 16, v40
    v_and_b32 v97, s38, v40
    v_lshlrev_b32 v98, 16, v41
    v_and_b32 v99, s38, v41
    v_lshlrev_b32 v100, 16, v42
    v_and_b32 v101, s38, v42
    v_lshlrev_b32 v102, 16, v43
    v_and_b32 v103, s38, v43
    s_waitcnt vmcnt(5)
    v_lshlrev_b32 v104, 16, v44
    v_and_b32 v105, s38, v44
    v_lshlrev_b32 v106, 16, v45
    v_and_b32 v107, s38, v45
    v_lshlrev_b32 v108, 16, v46
    v_and_b32 v109, s38, v46
    v_lshlrev_b32 v110, 16, v47
    v_and_b32 v111, s38, v47
    v_pk_add_f32 v[4:5], v[72:73], v[74:75]
    v_pk_add_f32 v[6:7], v[76:77], v[78:79]
    v_pk_add_f32 v[4:5], v[4:5], v[80:81]
    v_pk_add_f32 v[6:7], v[6:7], v[82:83]
    v_pk_add_f32 v[4:5], v[4:5], v[84:85]
    v_pk_add_f32 v[6:7], v[6:7], v[86:87]
    v_pk_add_f32 v[4:5], v[4:5], v[88:89]
    v_pk_add_f32 v[6:7], v[6:7], v[90:91]
    v_pk_add_f32 v[4:5], v[4:5], v[92:93]
    v_pk_add_f32 v[6:7], v[6:7], v[94:95]
    v_pk_add_f32 v[4:5], v[4:5], v[96:97]
    v_pk_add_f32 v[6:7], v[6:7], v[98:99]
    v_pk_add_f32 v[4:5], v[4:5], v[100:101]
    v_pk_add_f32 v[6:7], v[6:7], v[102:103]
    v_pk_add_f32 v[4:5], v[4:5], v[104:105]
    v_pk_add_f32 v[6:7], v[6:7], v[106:107]
    v_pk_add_f32 v[4:5], v[4:5], v[108:109]
    v_pk_add_f32 v[6:7], v[6:7], v[110:111]
    v_pk_add_f32 v[4:5], v[4:5], v[6:7]
    v_add_f32 v4, v4, v5
    s_nop 1
    v_add_f32_dpp v4, v4, v4 row_ror:8 row_mask:0xf bank_mask:0xf
    s_nop 1
    v_add_f32_dpp v4, v4, v4 row_ror:4 row_mask:0xf bank_mask:0xf
    s_nop 1
    v_add_f32_dpp v4, v4, v4 row_ror:2 row_mask:0xf bank_mask:0xf
    s_nop 1
    v_add_f32_dpp v4, v4, v4 row_ror:1 row_mask:0xf bank_mask:0xf
    v_mul_f32 v4, 0xbacccccd, v4
    v_mov_b32 v5, v4
    v_pk_add_f32 v[72:73], v[72:73], v[4:5]
    v_pk_add_f32 v[74:75], v[74:75], v[4:5]
    v_pk_add_f32 v[76:77], v[76:77], v[4:5]
    v_pk_add_f32 v[78:79], v[78:79], v[4:5]
    v_pk_add_f32 v[80:81], v[80:81], v[4:5]
    v_pk_add_f32 v[82:83], v[82:83], v[4:5]
    v_pk_add_f32 v[84:85], v[84:85], v[4:5]
    v_pk_add_f32 v[86:87], v[86:87], v[4:5]
    v_pk_add_f32 v[88:89], v[88:89], v[4:5]
    v_pk_add_f32 v[90:91], v[90:91], v[4:5]
    v_pk_add_f32 v[92:93], v[92:93], v[4:5]
    v_pk_add_f32 v[94:95], v[94:95], v[4:5]
    v_pk_add_f32 v[96:97], v[96:97], v[4:5]
    v_pk_add_f32 v[98:99], v[98:99], v[4:5]
    v_pk_add_f32 v[100:101], v[100:101], v[4:5]
    v_pk_add_f32 v[102:103], v[102:103], v[4:5]
    v_pk_add_f32 v[104:105], v[104:105], v[4:5]
    v_pk_add_f32 v[106:107], v[106:107], v[4:5]
    v_pk_add_f32 v[108:109], v[108:109], v[4:5]
    v_pk_add_f32 v[110:111], v[110:111], v[4:5]
    v_pk_mul_f32 v[112:113], v[72:73], v[72:73]
    v_pk_mul_f32 v[6:7], v[74:75], v[74:75]
    v_pk_fma_f32 v[112:113], v[76:77], v[76:77], v[112:113]
    v_pk_fma_f32 v[6:7], v[78:79], v[78:79], v[6:7]
    v_pk_fma_f32 v[112:113], v[80:81], v[80:81], v[112:113]
    v_pk_fma_f32 v[6:7], v[82:83], v[82:83], v[6:7]
    v_pk_fma_f32 v[112:113], v[84:85], v[84:85], v[112:113]
    v_pk_fma_f32 v[6:7], v[86:87], v[86:87], v[6:7]
    v_pk_fma_f32 v[112:113], v[88:89], v[88:89], v[112:113]
    v_pk_fma_f32 v[6:7], v[90:91], v[90:91], v[6:7]
    v_pk_fma_f32 v[112:113], v[92:93], v[92:93], v[112:113]
    v_pk_fma_f32 v[6:7], v[94:95], v[94:95], v[6:7]
    v_pk_fma_f32 v[112:113], v[96:97], v[96:97], v[112:113]
    v_pk_fma_f32 v[6:7], v[98:99], v[98:99], v[6:7]
    v_pk_fma_f32 v[112:113], v[100:101], v[100:101], v[112:113]
    v_pk_fma_f32 v[6:7], v[102:103], v[102:103], v[6:7]
    v_pk_fma_f32 v[112:113], v[104:105], v[104:105], v[112:113]
    v_pk_fma_f32 v[6:7], v[106:107], v[106:107], v[6:7]
    v_pk_fma_f32 v[112:113], v[108:109], v[108:109], v[112:113]
    v_pk_fma_f32 v[6:7], v[110:111], v[110:111], v[6:7]
    v_pk_add_f32 v[6:7], v[112:113], v[6:7]
    v_add_f32 v6, v6, v7
    s_nop 1
    v_add_f32_dpp v6, v6, v6 row_ror:8 row_mask:0xf bank_mask:0xf
    s_nop 1
    v_add_f32_dpp v6, v6, v6 row_ror:4 row_mask:0xf bank_mask:0xf
    s_nop 1
    v_add_f32_dpp v6, v6, v6 row_ror:2 row_mask:0xf bank_mask:0xf
    s_nop 1
    v_add_f32_dpp v6, v6, v6 row_ror:1 row_mask:0xf bank_mask:0xf
    v_mov_b32 v7, 0x3727c5ac
    v_fmac_f32 v7, 0x3acccccd, v6
    v_rsq_f32 v7, v7
    s_nop 0
    v_mul_f32 v4, v4, v7
    s_mov_b64 exec, s[36:37]
    ds_write_b32 v2, v7 offset:64
    ds_write_b32 v2, v4 offset:320
    s_mov_b64 exec, -1
    s_waitcnt vmcnt(4)
    v_lshlrev_b32 v72, 16, v48
    v_and_b32 v73, s38, v48
    v_lshlrev_b32 v74, 16, v49
    v_and_b32 v75, s38, v49
    v_lshlrev_b32 v76, 16, v50
    v_and_b32 v77, s38, v50
    v_lshlrev_b32 v78, 16, v51
    v_and_b32 v79, s38, v51
    s_waitcnt vmcnt(3)
    v_lshlrev_b32 v80, 16, v52
    v_and_b32 v81, s38, v52
    v_lshlrev_b32 v82, 16, v53
    v_and_b32 v83, s38, v53
    v_lshlrev_b32 v84, 16, v54
    v_and_b32 v85, s38, v54
    v_lshlrev_b32 v86, 16, v55
    v_and_b32 v87, s38, v55
    s_waitcnt vmcnt(2)
    v_lshlrev_b32 v88, 16, v56
    v_and_b32 v89, s38, v56
    v_lshlrev_b32 v90, 16, v57
    v_and_b32 v91, s38, v57
    v_lshlrev_b32 v92, 16, v58
    v_and_b32 v93, s38, v58
    v_lshlrev_b32 v94, 16, v59
    v_and_b32 v95, s38, v59
    s_waitcnt vmcnt(1)
    v_lshlrev_b32 v96, 16, v60
    v_and_b32 v97, s38, v60
    v_lshlrev_b32 v98, 16, v61
    v_and_b32 v99, s38, v61
    v_lshlrev_b32 v100, 16, v62
    v_and_b32 v101, s38, v62
    v_lshlrev_b32 v102, 16, v63
    v_and_b32 v103, s38, v63
    s_waitcnt vmcnt(0)
    v_lshlrev_b32 v104, 16, v64
    v_and_b32 v105, s38, v64
    v_lshlrev_b32 v106, 16, v65
    v_and_b32 v107, s38, v65
    v_lshlrev_b32 v108, 16, v66
    v_and_b32 v109, s38, v66
    v_lshlrev_b32 v110, 16, v67
    v_and_b32 v111, s38, v67
    v_pk_add_f32 v[4:5], v[72:73], v[74:75]
    v_pk_add_f32 v[6:7], v[76:77], v[78:79]
    v_pk_add_f32 v[4:5], v[4:5], v[80:81]
    v_pk_add_f32 v[6:7], v[6:7], v[82:83]
    v_pk_add_f32 v[4:5], v[4:5], v[84:85]
    v_pk_add_f32 v[6:7], v[6:7], v[86:87]
    v_pk_add_f32 v[4:5], v[4:5], v[88:89]
    v_pk_add_f32 v[6:7], v[6:7], v[90:91]
    v_pk_add_f32 v[4:5], v[4:5], v[92:93]
    v_pk_add_f32 v[6:7], v[6:7], v[94:95]
    v_pk_add_f32 v[4:5], v[4:5], v[96:97]
    v_pk_add_f32 v[6:7], v[6:7], v[98:99]
    v_pk_add_f32 v[4:5], v[4:5], v[100:101]
    v_pk_add_f32 v[6:7], v[6:7], v[102:103]
    v_pk_add_f32 v[4:5], v[4:5], v[104:105]
    v_pk_add_f32 v[6:7], v[6:7], v[106:107]
    v_pk_add_f32 v[4:5], v[4:5], v[108:109]
    v_pk_add_f32 v[6:7], v[6:7], v[110:111]
    v_pk_add_f32 v[4:5], v[4:5], v[6:7]
    v_add_f32 v4, v4, v5
    s_nop 1
    v_add_f32_dpp v4, v4, v4 row_ror:8 row_mask:0xf bank_mask:0xf
    s_nop 1
    v_add_f32_dpp v4, v4, v4 row_ror:4 row_mask:0xf bank_mask:0xf
    s_nop 1
    v_add_f32_dpp v4, v4, v4 row_ror:2 row_mask:0xf bank_mask:0xf
    s_nop 1
    v_add_f32_dpp v4, v4, v4 row_ror:1 row_mask:0xf bank_mask:0xf
    v_mul_f32 v4, 0xbacccccd, v4
    v_mov_b32 v5, v4
    v_pk_add_f32 v[72:73], v[72:73], v[4:5]
    v_pk_add_f32 v[74:75], v[74:75], v[4:5]
    v_pk_add_f32 v[76:77], v[76:77], v[4:5]
    v_pk_add_f32 v[78:79], v[78:79], v[4:5]
    v_pk_add_f32 v[80:81], v[80:81], v[4:5]
    v_pk_add_f32 v[82:83], v[82:83], v[4:5]
    v_pk_add_f32 v[84:85], v[84:85], v[4:5]
    v_pk_add_f32 v[86:87], v[86:87], v[4:5]
    v_pk_add_f32 v[88:89], v[88:89], v[4:5]
    v_pk_add_f32 v[90:91], v[90:91], v[4:5]
    v_pk_add_f32 v[92:93], v[92:93], v[4:5]
    v_pk_add_f32 v[94:95], v[94:95], v[4:5]
    v_pk_add_f32 v[96:97], v[96:97], v[4:5]
    v_pk_add_f32 v[98:99], v[98:99], v[4:5]
    v_pk_add_f32 v[100:101], v[100:101], v[4:5]
    v_pk_add_f32 v[102:103], v[102:103], v[4:5]
    v_pk_add_f32 v[104:105], v[104:105], v[4:5]
    v_pk_add_f32 v[106:107], v[106:107], v[4:5]
    v_pk_add_f32 v[108:109], v[108:109], v[4:5]
    v_pk_add_f32 v[110:111], v[110:111], v[4:5]
    v_pk_mul_f32 v[112:113], v[72:73], v[72:73]
    v_pk_mul_f32 v[6:7], v[74:75], v[74:75]
    v_pk_fma_f32 v[112:113], v[76:77], v[76:77], v[112:113]
    v_pk_fma_f32 v[6:7], v[78:79], v[78:79], v[6:7]
    v_pk_fma_f32 v[112:113], v[80:81], v[80:81], v[112:113]
    v_pk_fma_f32 v[6:7], v[82:83], v[82:83], v[6:7]
    v_pk_fma_f32 v[112:113], v[84:85], v[84:85], v[112:113]
    v_pk_fma_f32 v[6:7], v[86:87], v[86:87], v[6:7]
    v_pk_fma_f32 v[112:113], v[88:89], v[88:89], v[112:113]
    v_pk_fma_f32 v[6:7], v[90:91], v[90:91], v[6:7]
    v_pk_fma_f32 v[112:113], v[92:93], v[92:93], v[112:113]
    v_pk_fma_f32 v[6:7], v[94:95], v[94:95], v[6:7]
    v_pk_fma_f32 v[112:113], v[96:97], v[96:97], v[112:113]
    v_pk_fma_f32 v[6:7], v[98:99], v[98:99], v[6:7]
    v_pk_fma_f32 v[112:113], v[100:101], v[100:101], v[112:113]
    v_pk_fma_f32 v[6:7], v[102:103], v[102:103], v[6:7]
    v_pk_fma_f32 v[112:113], v[104:105], v[104:105], v[112:113]
    v_pk_fma_f32 v[6:7], v[106:107], v[106:107], v[6:7]
    v_pk_fma_f32 v[112:113], v[108:109], v[108:109], v[112:113]
    v_pk_fma_f32 v[6:7], v[110:111], v[110:111], v[6:7]
    v_pk_add_f32 v[6:7], v[112:113], v[6:7]
    v_add_f32 v6, v6, v7
    s_nop 1
    v_add_f32_dpp v6, v6, v6 row_ror:8 row_mask:0xf bank_mask:0xf
    s_nop 1
    v_add_f32_dpp v6, v6, v6 row_ror:4 row_mask:0xf bank_mask:0xf
    s_nop 1
    v_add_f32_dpp v6, v6, v6 row_ror:2 row_mask:0xf bank_mask:0xf
    s_nop 1
    v_add_f32_dpp v6, v6, v6 row_ror:1 row_mask:0xf bank_mask:0xf
    v_mov_b32 v7, 0x3727c5ac
    v_fmac_f32 v7, 0x3acccccd, v6
    v_rsq_f32 v7, v7
    s_nop 0
    v_mul_f32 v4, v4, v7
    s_mov_b64 exec, s[36:37]
    ds_write_b32 v2, v7 offset:128
    ds_write_b32 v2, v4 offset:384
    s_mov_b64 exec, -1
    s_mul_i32 s33, s32, 192
    v_lshlrev_b32 v3, 4, v1
    v_add_u32 v3, s33, v3
    v_cmp_gt_u32 vcc, 0x2000, v3
    v_cmp_gt_u32 s[34:35], 12, v1
    v_cmp_gt_u32 s[36:37], 32, v0
    v_lshrrev_b32 v4, 4, v0
    v_lshl_add_u32 v3, v4, 13, v3
    v_lshlrev_b32 v4, 4, v0
    s_and_b64 s[34:35], s[34:35], vcc
    s_and_b64 s[34:35], s[34:35], s[36:37]
    s_mov_b32 s33, 5242880
    s_waitcnt lgkmcnt(0)
    s_mul_i32 s60, s60, 1664525
    s_add_u32 s60, s60, 1013904223
    s_lshl_b32 s36, s2, 7
    s_add_u32 s36, s36, 24645632
    s_barrier
    s_cmp_eq_u32 s3, 0
    s_cbranch_scc0 L_sequen_st_12
    ds_read_b128 v[8:11], v4
    s_waitcnt lgkmcnt(0)
    s_mov_b64 exec, s[34:35]
    buffer_store_dwordx4 v[8:11], v3, s[56:59], s33 offen sc1
    s_mov_b64 exec, -1
    s_waitcnt vmcnt(0)
    v_mov_b32 v4, s60
    v_mov_b32 v5, 0
    s_mov_b64 exec, 1
    buffer_store_dword v4, v5, s[56:59], s36 offen sc1
    s_mov_b64 exec, -1
L_sequen_st_12:
    s_cmp_lt_u32 s32, 16
    s_cbranch_scc1 FZ_JOIN
    s_sub_u32 s32, s32, 16
    s_lshr_b32 s33, s32, 1
    s_and_b32 s34, s32, 1
    s_mul_i32 s35, s33, 96
    s_mul_i32 s36, s3, 24
    s_add_u32 s35, s35, s36
    s_mul_i32 s35, s35, 1280
    s_mul_i32 s36, s34, 640
    s_add_u32 s35, s35, s36
    s_mul_i32 s36, s3, 15360
    s_add_u32 s36, s36, 1024
    v_lshlrev_b32 v3, 4, v0
    s_mov_b32 s24, s44
    s_mov_b32 s25, s45
    s_mov_b32 s26, 1966080
    s_mov_b32 s27, 0x00020000
    v_add_u32 v4, 0, v0
    v_mul_u32_u24 v4, 205, v4
    v_lshrrev_b32 v4, 13, v4
    v_mul_u32_u24 v4, 640, v4
    v_add_u32 v8, v4, v3
    s_mov_b32 m0, s36
    s_add_u32 s36, s36, 4096
    buffer_load_dwordx4 v8, s[24:27], s35 offen offset:0 nt lds
    v_add_u32 v4, 64, v0
    v_mul_u32_u24 v4, 205, v4
    v_lshrrev_b32 v4, 13, v4
    v_mul_u32_u24 v4, 640, v4
    v_add_u32 v9, v4, v3
    buffer_load_dwordx4 v9, s[24:27], s35 offen offset:1024 nt lds
    v_add_u32 v4, 128, v0
    v_mul_u32_u24 v4, 205, v4
    v_lshrrev_b32 v4, 13, v4
    v_mul_u32_u24 v4, 640, v4
    v_add_u32 v10, v4, v3
    buffer_load_dwordx4 v10, s[24:27], s35 offen offset:2048 nt lds
    v_add_u32 v4, 192, v0
    v_mul_u32_u24 v4, 205, v4
    v_lshrrev_b32 v4, 13, v4
    v_mul_u32_u24 v4, 640, v4
    v_add_u32 v11, v4, v3
    buffer_load_dwordx4 v11, s[24:27], s35 offen offset:3072 nt lds
    v_add_u32 v4, 256, v0
    v_mul_u32_u24 v4, 205, v4
    v_lshrrev_b32 v4, 13, v4
    v_mul_u32_u24 v4, 640, v4
    v_add_u32 v12, v4, v3
    s_mov_b32 m0, s36
    s_add_u32 s36, s36, 4096
    s_add_u32 s35, s35, 4096
    buffer_load_dwordx4 v12, s[24:27], s35 offen offset:0 nt lds
    v_add_u32 v4, 320, v0
    v_mul_u32_u24 v4, 205, v4
    v_lshrrev_b32 v4, 13, v4
    v_mul_u32_u24 v4, 640, v4
    v_add_u32 v13, v4, v3
    buffer_load_dwordx4 v13, s[24:27], s35 offen offset:1024 nt lds
    v_add_u32 v4, 384, v0
    v_mul_u32_u24 v4, 205, v4
    v_lshrrev_b32 v4, 13, v4
    v_mul_u32_u24 v4, 640, v4
    v_add_u32 v14, v4, v3
    buffer_load_dwordx4 v14, s[24:27], s35 offen offset:2048 nt lds
    v_add_u32 v4, 448, v0
    v_mul_u32_u24 v4, 205, v4
    v_lshrrev_b32 v4, 13, v4
    v_mul_u32_u24 v4, 640, v4
    v_add_u32 v15, v4, v3
    buffer_load_dwordx4 v15, s[24:27], s35 offen offset:3072 nt lds
    v_add_u32 v4, 512, v0
    v_mul_u32_u24 v4, 205, v4
    v_lshrrev_b32 v4, 13, v4
    v_mul_u32_u24 v4, 640, v4
    v_add_u32 v16, v4, v3
    s_mov_b32 m0, s36
    s_add_u32 s36, s36, 4096
    s_add_u32 s35, s35, 4096
    buffer_load_dwordx4 v16, s[24:27], s35 offen offset:0 nt lds
    v_add_u32 v4, 576, v0
    v_mul_u32_u24 v4, 205, v4
    v_lshrrev_b32 v4, 13, v4
    v_mul_u32_u24 v4, 640, v4
    v_add_u32 v17, v4, v3
    buffer_load_dwordx4 v17, s[24:27], s35 offen offset:1024 nt lds
    v_add_u32 v4, 640, v0
    v_mul_u32_u24 v4, 205, v4
    v_lshrrev_b32 v4, 13, v4
    v_mul_u32_u24 v4, 640, v4
    v_add_u32 v18, v4, v3
    buffer_load_dwordx4 v18, s[24:27], s35 offen offset:2048 nt lds
    v_add_u32 v4, 704, v0
    v_mul_u32_u24 v4, 205, v4
    v_lshrrev_b32 v4, 13, v4
    v_mul_u32_u24 v4, 640, v4
    v_add_u32 v19, v4, v3
    buffer_load_dwordx4 v19, s[24:27], s35 offen offset:3072 nt lds
    v_add_u32 v4, 768, v0
    v_mul_u32_u24 v4, 205, v4
    v_lshrrev_b32 v4, 13, v4
    v_mul_u32_u24 v4, 640, v4
    v_add_u32 v20, v4, v3
    s_mov_b32 m0, s36
    s_add_u32 s36, s36, 4096
    s_add_u32 s35, s35, 4096
    buffer_load_dwordx4 v20, s[24:27], s35 offen offset:0 nt lds
    v_add_u32 v4, 832, v0
    v_mul_u32_u24 v4, 205, v4
    v_lshrrev_b32 v4, 13, v4
    v_mul_u32_u24 v4, 640, v4
    v_add_u32 v21, v4, v3
    buffer_load_dwordx4 v21, s[24:27], s35 offen offset:1024 nt lds
    v_add_u32 v4, 896, v0
    v_mul_u32_u24 v4, 205, v4
    v_lshrrev_b32 v4, 13, v4
    v_mul_u32_u24 v4, 640, v4
    v_add_u32 v22, v4, v3
    buffer_load_dwordx4 v22, s[24:27], s35 offen offset:2048 nt lds
    v_lshrrev_b32 v4, 4, v0
    v_bfe_u32 v5, v0, 2, 1
    v_bfe_u32 v6, v0, 3, 1
    v_lshl_add_u32 v5, v6, 2, v5
    v_and_b32 v6, 3, v0
    s_mul_i32 s35, s3, 160
    s_add_u32 s35, s35, 1024
    v_add_u32 v7, 0, v4
    v_mul_u32_u24 v40, 43, v7
    v_lshrrev_b32 v40, 7, v40
    v_mul_u32_u24 v41, 3, v40
    v_sub_u32 v7, v7, v41
    v_cmp_gt_u32 vcc, 2, v7
    v_lshlrev_b32 v7, 1, v7
    v_mul_u32_u24 v40, 24, v40
    v_cndmask_b32 v7, 16, v7, vcc
    v_add3_u32 v7, v7, v40, v5
    v_mov_b32 v41, 8
    v_cndmask_b32 v41, 2, v41, vcc
    v_add_u32 v41, v41, v7
    v_mul_u32_u24 v7, 640, v7
    v_mul_u32_u24 v41, 640, v41
    v_add_u32 v7, s35, v7
    v_add_u32 v41, s35, v41
    v_lshl_add_u32 v24, v6, 4, v7
    v_lshl_add_u32 v25, v6, 4, v41
    v_lshl_add_u32 v26, v6, 3, v7
    v_lshl_add_u32 v27, v6, 3, v41
    v_add_u32 v7, 4, v4
    v_mul_u32_u24 v40, 43, v7
    v_lshrrev_b32 v40, 7, v40
    v_mul_u32_u24 v41, 3, v40
    v_sub_u32 v7, v7, v41
    v_cmp_gt_u32 vcc, 2, v7
    v_lshlrev_b32 v7, 1, v7
    v_mul_u32_u24 v40, 24, v40
    v_cndmask_b32 v7, 16, v7, vcc
    v_add3_u32 v7, v7, v40, v5
    v_mov_b32 v41, 8
    v_cndmask_b32 v41, 2, v41, vcc
    v_add_u32 v41, v41, v7
    v_mul_u32_u24 v7, 640, v7
    v_mul_u32_u24 v41, 640, v41
    v_add_u32 v7, s35, v7
    v_add_u32 v41, s35, v41
    v_lshl_add_u32 v28, v6, 4, v7
    v_lshl_add_u32 v29, v6, 4, v41
    v_lshl_add_u32 v30, v6, 3, v7
    v_lshl_add_u32 v31, v6, 3, v41
    v_add_u32 v7, 8, v4
    v_mul_u32_u24 v40, 43, v7
    v_lshrrev_b32 v40, 7, v40
    v_mul_u32_u24 v41, 3, v40
    v_sub_u32 v7, v7, v41
    v_cmp_gt_u32 vcc, 2, v7
    v_lshlrev_b32 v7, 1, v7
    v_mul_u32_u24 v40, 24, v40
    v_cndmask_b32 v7, 16, v7, vcc
    v_add3_u32 v7, v7, v40, v5
    v_mov_b32 v41, 8
    v_cndmask_b32 v41, 2, v41, vcc
    v_add_u32 v41, v41, v7
    v_mul_u32_u24 v7, 640, v7
    v_mul_u32_u24 v41, 640, v41
    v_add_u32 v7, s35, v7
    v_add_u32 v41, s35, v41
    v_lshl_add_u32 v32, v6, 4, v7
    v_lshl_add_u32 v33, v6, 4, v41
    v_lshl_add_u32 v34, v6, 3, v7
    v_lshl_add_u32 v35, v6, 3, v41
    s_lshl_b32 s35, s34, 2
    s_add_u32 s35, s35, s3
    s_mul_i32 s35, s35, 245760
    s_mul_i32 s36, s33, 15360
    s_add_u32 s35, s35, s36
    s_add_u32 s35, s35, 13631488
    s_lshl_b32 s36, s32, 7
    s_add_u32 s36, s36, 24690688
    s_waitcnt vmcnt(0)
    s_barrier
    ds_read_b64_tr_b16 v[48:49], v24 offset:0
    ds_read_b64_tr_b16 v[50:51], v25 offset:0
    ds_read_b64_tr_b16 v[52:53], v24 offset:8
    ds_read_b64_tr_b16 v[54:55], v25 offset:8
    ds_read_b64_tr_b16 v[56:57], v24 offset:64
    ds_read_b64_tr_b16 v[58:59], v25 offset:64
    ds_read_b64_tr_b16 v[60:61], v24 offset:72
    ds_read_b64_tr_b16 v[62:63], v25 offset:72
    ds_read_b64_tr_b16 v[64:65], v26 offset:128
    ds_read_b64_tr_b16 v[66:67], v27 offset:128
    s_waitcnt lgkmcnt(0)
    buffer_store_dwordx4 v[48:51], v3, s[56:59], s35 offen offset:0 sc1
    buffer_store_dwordx4 v[52:55], v3, s[56:59], s35 offen offset:1024 sc1
    buffer_store_dwordx4 v[56:59], v3, s[56:59], s35 offen offset:2048 sc1
    buffer_store_dwordx4 v[60:63], v3, s[56:59], s35 offen offset:3072 sc1
    s_add_u32 s35, s35, 4096
    buffer_store_dwordx4 v[64:67], v3, s[56:59], s35 offen offset:0 sc1
    ds_read_b64_tr_b16 v[68:69], v28 offset:0
    ds_read_b64_tr_b16 v[70:71], v29 offset:0
    ds_read_b64_tr_b16 v[72:73], v28 offset:8
    ds_read_b64_tr_b16 v[74:75], v29 offset:8
    ds_read_b64_tr_b16 v[76:77], v28 offset:64
    ds_read_b64_tr_b16 v[78:79], v29 offset:64
    ds_read_b64_tr_b16 v[80:81], v28 offset:72
    ds_read_b64_tr_b16 v[82:83], v29 offset:72
    ds_read_b64_tr_b16 v[84:85], v30 offset:128
    ds_read_b64_tr_b16 v[86:87], v31 offset:128
    s_waitcnt lgkmcnt(0)
    buffer_store_dwordx4 v[68:71], v3, s[56:59], s35 offen offset:1024 sc1
    buffer_store_dwordx4 v[72:75], v3, s[56:59], s35 offen offset:2048 sc1
    buffer_store_dwordx4 v[76:79], v3, s[56:59], s35 offen offset:3072 sc1
    s_add_u32 s35, s35, 4096
    buffer_store_dwordx4 v[80:83], v3, s[56:59], s35 offen offset:0 sc1
    buffer_store_dwordx4 v[84:87], v3, s[56:59], s35 offen offset:1024 sc1
    ds_read_b64_tr_b16 v[88:89], v32 offset:0
    ds_read_b64_tr_b16 v[90:91], v33 offset:0
    ds_read_b64_tr_b16 v[92:93], v32 offset:8
    ds_read_b64_tr_b16 v[94:95], v33 offset:8
    ds_read_b64_tr_b16 v[96:97], v32 offset:64
    ds_read_b64_tr_b16 v[98:99], v33 offset:64
    ds_read_b64_tr_b16 v[100:101], v32 offset:72
    ds_read_b64_tr_b16 v[102:103], v33 offset:72
    ds_read_b64_tr_b16 v[104:105], v34 offset:128
    ds_read_b64_tr_b16 v[106:107], v35 offset:128
    s_waitcnt lgkmcnt(0)
    buffer_store_dwordx4 v[88:91], v3, s[56:59], s35 offen offset:2048 sc1
    buffer_store_dwordx4 v[92:95], v3, s[56:59], s35 offen offset:3072 sc1
    s_add_u32 s35, s35, 4096
    buffer_store_dwordx4 v[96:99], v3, s[56:59], s35 offen offset:0 sc1
    buffer_store_dwordx4 v[100:103], v3, s[56:59], s35 offen offset:1024 sc1
    buffer_store_dwordx4 v[104:107], v3, s[56:59], s35 offen offset:2048 sc1
    s_waitcnt vmcnt(0)
    s_barrier
    s_cmp_eq_u32 s3, 0
    s_cbranch_scc0 L_sequen_pf_14
    v_mov_b32 v4, s60
    v_mov_b32 v5, 0
    s_mov_b64 exec, 1
    buffer_store_dword v4, v5, s[56:59], s36 offen sc1
    s_mov_b64 exec, -1
L_sequen_pf_14:
    s_branch FZ_JOIN
FZ_JOIN:
    s_bfe_u32 s20, s2, 0x20001
    s_lshl_b32 s20, s20, 2
    s_bfe_u32 s21, s2, 0x20003
    s_add_u32 s20, s20, s21
    s_and_b32 s21, s2, 1
    s_lshl_b32 s21, s21, 3
    s_lshr_b32 s22, s2, 5
    s_add_u32 s21, s21, s22
    s_lshl_b32 s22, s21, 2
    s_add_u32 s22, s22, s3
    s_mul_i32 s24, s22, 30720
    s_add_u32 s24, s24, 9437184
    s_add_u32 s25, s24, 4096
    s_add_u32 s26, s24, 8192
    s_add_u32 s27, s24, 1966080
    s_add_u32 s28, s25, 1966080
    s_add_u32 s29, s26, 1966080
    s_mov_b32 s30, 24666112
    s_lshr_b32 s23, s2, 7
    s_lshl_b32 s31, s3, 3
    s_add_u32 s23, s23, s31
    s_lshl_b32 s23, s23, 7
    s_add_u32 s23, s23, 24690688
    s_lshr_b32 s53, s2, 5
    s_mul_i32 s53, s53, 245760
    s_mul_i32 s31, s3, 61440
    s_add_u32 s53, s53, s31
    s_add_u32 s53, s53, 13631488
    s_lshl_b32 s50, s3, 12
    s_mul_i32 s51, s20, 81920
    s_add_u32 s51, s51, s50
    s_add_u32 s51, s51, 6291456
    v_lshrrev_b32 v8, 4, v0
    v_and_b32 v9, 7, v0
    v_lshl_add_u32 v8, v8, 3, v9
    v_lshlrev_b32 v8, 4, v8
    v_bfe_u32 v9, v0, 3, 1
    v_mul_u32_u24 v6, 10240, v9
    v_add_u32 v6, v6, v8
    v_mul_u32_u24 v7, 1966080, v9
    v_add_u32 v8, 20480, v8
    v_add_u32 v7, v7, v8
    s_mul_i32 s31, s22, 3
    v_and_b32 v4, 1, v0
    v_lshl_add_u32 v4, v4, 1, s31
    v_lshrrev_b32 v4, 3, v4
    v_bfe_u32 v5, v0, 1, 1
    v_mul_u32_u24 v5, 24, v5
    v_add_lshl_u32 v4, v4, v5, 7
L_sequen_pl_15:
    buffer_load_dword v5, v4, s[56:59], s30 offen sc1
    s_waitcnt vmcnt(0)
    v_cmp_ne_u32 vcc, s60, v5
    s_cbranch_vccz L_sequen_pd_16
    s_sub_u32 s61, s61, 1
    s_cbranch_scc0 L_sequen_pl_15
    s_mov_b32 s61, 0
L_sequen_pd_16:
    buffer_load_dwordx4 v[208:211], v6, s[56:59], s24 offen offset:0 sc1
    buffer_load_dwordx4 v[212:215], v6, s[56:59], s27 offen offset:0 sc1
    buffer_load_dwordx4 v[216:219], v7, s[56:59], s24 offen offset:0 sc1
    buffer_load_dwordx4 v[220:223], v6, s[56:59], s24 offen offset:512 sc1
    buffer_load_dwordx4 v[224:227], v6, s[56:59], s27 offen offset:512 sc1
    buffer_load_dwordx4 v[228:231], v7, s[56:59], s24 offen offset:512 sc1
    buffer_load_dwordx4 v[232:235], v6, s[56:59], s24 offen offset:1024 sc1
    buffer_load_dwordx4 v[236:239], v6, s[56:59], s27 offen offset:1024 sc1
    buffer_load_dwordx4 v[240:243], v7, s[56:59], s24 offen offset:1024 sc1
    buffer_load_dwordx4 v[244:247], v6, s[56:59], s24 offen offset:1536 sc1
    buffer_load_dwordx4 v[248:251], v6, s[56:59], s27 offen offset:1536 sc1
    buffer_load_dwordx4 v[252:255], v7, s[56:59], s24 offen offset:1536 sc1
    buffer_load_dwordx4 v[112:115], v6, s[56:59], s24 offen offset:2048 sc1
    buffer_load_dwordx4 v[116:119], v6, s[56:59], s27 offen offset:2048 sc1
    buffer_load_dwordx4 v[120:123], v7, s[56:59], s24 offen offset:2048 sc1
    buffer_load_dwordx4 v[124:127], v6, s[56:59], s24 offen offset:2560 sc1
    buffer_load_dwordx4 v[128:131], v6, s[56:59], s27 offen offset:2560 sc1
    buffer_load_dwordx4 v[132:135], v7, s[56:59], s24 offen offset:2560 sc1
    buffer_load_dwordx4 v[136:139], v6, s[56:59], s24 offen offset:3072 sc1
    buffer_load_dwordx4 v[140:143], v6, s[56:59], s27 offen offset:3072 sc1
    buffer_load_dwordx4 v[144:147], v7, s[56:59], s24 offen offset:3072 sc1
    buffer_load_dwordx4 v[148:151], v6, s[56:59], s24 offen offset:3584 sc1
    buffer_load_dwordx4 v[152:155], v6, s[56:59], s27 offen offset:3584 sc1
    buffer_load_dwordx4 v[156:159], v7, s[56:59], s24 offen offset:3584 sc1
    buffer_load_dwordx4 v[160:163], v6, s[56:59], s25 offen offset:0 sc1
    buffer_load_dwordx4 v[164:167], v6, s[56:59], s28 offen offset:0 sc1
    buffer_load_dwordx4 v[168:171], v7, s[56:59], s25 offen offset:0 sc1
    buffer_load_dwordx4 v[172:175], v6, s[56:59], s25 offen offset:512 sc1
    buffer_load_dwordx4 a[224:227], v6, s[56:59], s28 offen offset:512 sc1
    buffer_load_dwordx4 a[228:231], v7, s[56:59], s25 offen offset:512 sc1
    buffer_load_dwordx4 a[232:235], v6, s[56:59], s25 offen offset:1024 sc1
    buffer_load_dwordx4 a[236:239], v6, s[56:59], s28 offen offset:1024 sc1
    buffer_load_dwordx4 a[240:243], v7, s[56:59], s25 offen offset:1024 sc1
    buffer_load_dwordx4 a[244:247], v6, s[56:59], s25 offen offset:1536 sc1
    buffer_load_dwordx4 a[248:251], v6, s[56:59], s28 offen offset:1536 sc1
    buffer_load_dwordx4 a[252:255], v7, s[56:59], s25 offen offset:1536 sc1
    buffer_load_dwordx4 a[64:67], v6, s[56:59], s25 offen offset:2048 sc1
    buffer_load_dwordx4 a[68:71], v6, s[56:59], s28 offen offset:2048 sc1
    buffer_load_dwordx4 a[72:75], v7, s[56:59], s25 offen offset:2048 sc1
    buffer_load_dwordx4 a[76:79], v6, s[56:59], s25 offen offset:2560 sc1
    buffer_load_dwordx4 a[80:83], v6, s[56:59], s28 offen offset:2560 sc1
    buffer_load_dwordx4 a[84:87], v7, s[56:59], s25 offen offset:2560 sc1
    buffer_load_dwordx4 a[88:91], v6, s[56:59], s25 offen offset:3072 sc1
    buffer_load_dwordx4 a[92:95], v6, s[56:59], s28 offen offset:3072 sc1
    buffer_load_dwordx4 a[192:195], v7, s[56:59], s25 offen offset:3072 sc1
    buffer_load_dwordx4 a[196:199], v6, s[56:59], s25 offen offset:3584 sc1
    buffer_load_dwordx4 a[200:203], v6, s[56:59], s28 offen offset:3584 sc1
    buffer_load_dwordx4 a[204:207], v7, s[56:59], s25 offen offset:3584 sc1
    buffer_load_dwordx4 a[208:211], v6, s[56:59], s26 offen offset:0 sc1
    buffer_load_dwordx4 a[212:215], v6, s[56:59], s29 offen offset:0 sc1
    buffer_load_dwordx4 a[216:219], v7, s[56:59], s26 offen offset:0 sc1
    buffer_load_dwordx4 a[220:223], v6, s[56:59], s26 offen offset:512 sc1
    buffer_load_dwordx4 a[32:35], v6, s[56:59], s29 offen offset:512 sc1
    buffer_load_dwordx4 a[36:39], v7, s[56:59], s26 offen offset:512 sc1
    buffer_load_dwordx4 a[40:43], v6, s[56:59], s26 offen offset:1024 sc1
    buffer_load_dwordx4 a[44:47], v6, s[56:59], s29 offen offset:1024 sc1
    buffer_load_dwordx4 a[48:51], v7, s[56:59], s26 offen offset:1024 sc1
    buffer_load_dwordx4 a[52:55], v6, s[56:59], s26 offen offset:1536 sc1
    buffer_load_dwordx4 a[56:59], v6, s[56:59], s29 offen offset:1536 sc1
    buffer_load_dwordx4 a[60:63], v7, s[56:59], s26 offen offset:1536 sc1
    v_and_b32 v178, 3, v0
    v_lshlrev_b32 v178, 8, v178
L_sequen_pl_17:
    buffer_load_dword v177, v178, s[56:59], s23 offen sc1
    s_waitcnt vmcnt(0)
    v_cmp_ne_u32 vcc, s60, v177
    s_cbranch_vccz L_sequen_pd_18
    s_sub_u32 s61, s61, 1
    s_cbranch_scc0 L_sequen_pl_17
    s_mov_b32 s61, 0
L_sequen_pd_18:
    v_min_u32 v8, 39, v0
    s_lshl_b32 s30, s3, 10
    v_and_b32 v9, 7, v8
    v_lshrrev_b32 v8, 3, v8
    s_add_u32 s30, s30, 24707072
    v_lshl_add_u32 v8, v8, 5, v9
    s_add_u32 s31, s30, 32768
    v_lshlrev_b32 v4, 7, v8
    v_lshrrev_b32 v8, 3, v0
    v_bfe_u32 v9, v0, 1, 2
    v_and_b32 v5, 3, v8
    v_xor_b32 v9, v9, v5
    v_lshlrev_b32 v5, 7, v8
    v_lshl_add_u32 v5, v9, 5, v5
    v_and_b32 v9, 1, v0
    v_lshl_add_u32 v5, v9, 4, v5
    v_xor_b32 v6, 32, v5
    v_mov_b32 v11, 0x80000000
    s_mov_b32 s49, 0
L_sequen_pl_19:
    buffer_load_dword v176, v4, s[56:59], s30 offen sc1
    s_waitcnt vmcnt(0)
    v_cmp_ne_u32 vcc, s60, v176
    s_cbranch_vccz L_sequen_pd_20
    s_sleep 2
    s_sub_u32 s61, s61, 1
    s_cbranch_scc0 L_sequen_pl_19
    s_mov_b32 s61, 0
L_sequen_pd_20:
FZ_G1:
    s_mov_b32 m0, s50
    s_add_u32 s50, s50, 16384
    buffer_load_dwordx4 v5, s[56:59], s51 offen offset:0 sc1 lds
    buffer_load_dwordx4 v6, s[56:59], s51 offen offset:1024 sc1 lds
    buffer_load_dwordx4 v5, s[56:59], s51 offen offset:2048 sc1 lds
    buffer_load_dwordx4 v6, s[56:59], s51 offen offset:3072 sc1 lds
    s_add_u32 s51, s51, 16384
    s_mov_b32 m0, s50
    s_add_u32 s50, s50, 16384
    buffer_load_dwordx4 v5, s[56:59], s51 offen offset:0 sc1 lds
    buffer_load_dwordx4 v6, s[56:59], s51 offen offset:1024 sc1 lds
    buffer_load_dwordx4 v5, s[56:59], s51 offen offset:2048 sc1 lds
    buffer_load_dwordx4 v6, s[56:59], s51 offen offset:3072 sc1 lds
    s_add_u32 s51, s51, 16384
    s_mov_b32 m0, s50
    s_add_u32 s50, s50, 16384
    buffer_load_dwordx4 v5, s[56:59], s51 offen offset:0 sc1 lds
    buffer_load_dwordx4 v6, s[56:59], s51 offen offset:1024 sc1 lds
    buffer_load_dwordx4 v5, s[56:59], s51 offen offset:2048 sc1 lds
    buffer_load_dwordx4 v6, s[56:59], s51 offen offset:3072 sc1 lds
    s_add_u32 s51, s51, 16384
    s_mov_b32 m0, s50
    s_add_u32 s50, s50, 16384
    buffer_load_dwordx4 v5, s[56:59], s51 offen offset:0 sc1 lds
    buffer_load_dwordx4 v6, s[56:59], s51 offen offset:1024 sc1 lds
    buffer_load_dwordx4 v5, s[56:59], s51 offen offset:2048 sc1 lds
    buffer_load_dwordx4 v6, s[56:59], s51 offen offset:3072 sc1 lds
    s_add_u32 s51, s51, 16384
    s_mov_b32 m0, s50
    s_add_u32 s50, s50, 16384
    buffer_load_dwordx4 v5, s[56:59], s51 offen offset:0 sc1 lds
    buffer_load_dwordx4 v6, s[56:59], s51 offen offset:1024 sc1 lds
    buffer_load_dwordx4 v5, s[56:59], s51 offen offset:2048 sc1 lds
    buffer_load_dwordx4 v6, s[56:59], s51 offen offset:3072 sc1 lds
    s_add_u32 s51, s51, 1245184
    s_load_dwordx2 s[44:45], s[0:1], 80
    v_mov_b32 v13, v4
    v_mov_b32 v12, s60
    v_lshrrev_b32 v16, 4, v0
    v_bfe_u32 v17, v0, 2, 2
    v_and_b32 v18, 3, v0
    v_and_b32 v19, 15, v0
    v_lshl_add_u32 v1, v16, 3, v17
    v_lshlrev_b32 v1, 7, v1
    v_and_b32 v20, 1, v16
    v_xor_b32 v20, v20, v17
    v_lshl_add_u32 v1, v20, 5, v1
    v_lshl_add_u32 v1, v18, 3, v1
    v_xor_b32 v2, 32, v1
    v_xor_b32 v3, 64, v1
    v_xor_b32 v4, 0x60, v1
    s_and_b32 s32, s21, 3
    s_lshl_b32 s33, s32, 5
    v_xor_b32 v7, s33, v1
    s_lshl_b32 s33, s3, 12
    v_add_u32 v7, s33, v7
    v_lshlrev_b32 v14, 4, v0
    v_cmp_gt_u32 vcc, 48, v0
    v_mov_b32 v21, 0x80000000
    s_lshr_b32 s33, s21, 2
    v_cmp_eq_u32 s[34:35], v16, v17
    v_cndmask_b32 v8, v21, v14, vcc
    v_cmp_eq_u32 vcc, s33, v17
    v_xor_b32 v20, s33, v16
    v_cmp_gt_u32 s[36:37], 2, v20
    s_lshl_b32 s32, s32, 9
    s_lshl_b32 s33, s3, 3
    s_add_u32 s32, s32, s33
    v_lshlrev_b32 v15, 5, v19
    v_add_u32 v15, s32, v15
    v_add_u32 v20, 4, v15
    s_and_b64 s[36:37], s[36:37], vcc
    v_cndmask_b32 v15, v15, v20, s[34:35]
    v_cndmask_b32 v15, v21, v15, s[36:37]
    v_cmp_eq_u32 s[36:37], 1, v18
    v_cmp_eq_u32 s[40:41], 2, v18
    v_cmp_eq_u32 s[42:43], 3, v18
    v_mov_b32 v108, 0x3f803f80
    v_mov_b32 v109, 0x3f803f80
    v_mov_b32 v110, 0x3f803f80
    v_mov_b32 v111, 0x3f803f80
    s_mov_b32 s38, 0xffff0000
    s_mul_i32 s52, s22, 768
    s_mul_i32 s32, s20, 196608
    s_add_u32 s52, s52, s32
    s_add_u32 s52, s52, 16777216
    s_lshl_b32 s62, s20, 11
    s_add_u32 s62, s62, 23068672
    s_and_b32 s32, s2, 7
    s_lshl_b32 s32, s32, 1
    s_bfe_u32 s33, s2, 0x10004
    s_add_u32 s32, s32, s33
    s_bfe_u32 s33, s2, 0x10003
    s_lshr_b32 s48, s2, 5
    s_lshl_b32 s54, s32, 2
    s_add_u32 s54, s54, s33
    s_mul_i32 s4, s54, 49152
    s_mul_i32 s5, s3, 12288
    s_add_u32 s4, s4, s5
    s_add_u32 s4, s4, 16777216
    s_add_u32 s5, s4, 4096
    s_add_u32 s6, s4, 8192
    s_add_u32 s7, s4, 98304
    s_add_u32 s8, s4, 102400
    s_add_u32 s9, s4, 106496
    s_add_u32 s10, s4, 3145728
    s_add_u32 s11, s4, 3149824
    s_add_u32 s12, s4, 3153920
    s_add_u32 s13, s4, 3244032
    s_add_u32 s14, s4, 3248128
    s_add_u32 s15, s4, 3252224
    s_mul_i32 s16, s54, 20480
    s_mul_i32 s17, s48, 160
    s_add_u32 s16, s16, s17
    s_lshl_b32 s24, s54, 9
    s_add_u32 s24, s24, 23068672
    s_add_u32 s17, s16, 40960
    s_add_u32 s25, s24, 1024
    s_add_u32 s18, s16, 1310720
    s_add_u32 s26, s24, 32768
    s_add_u32 s19, s16, 1351680
    s_add_u32 s27, s24, 33792
    s_lshr_b32 s28, s3, 1
    s_lshl_b32 s28, s28, 4
    s_add_u32 s28, s28, s32
    s_mul_i32 s28, s28, 81920
    s_mul_i32 s29, s48, 10240
    s_add_u32 s28, s28, s29
    s_and_b32 s29, s3, 1
    s_mul_i32 s29, s29, 5120
    s_add_u32 s28, s28, s29
    s_add_u32 s28, s28, 6291456
    s_mul_i32 s29, s3, 5120
    v_add_u32 v10, s29, v14
    s_mov_b32 s63, s29
    s_add_u32 s23, s53, 46080
    s_add_u32 s29, s29, 40960
    s_lshl_b32 s39, s3, 8
    v_lshlrev_b32 v9, 4, v19
    v_lshl_add_u32 v9, v16, 11, v9
    v_add_u32 v9, s39, v9
    s_lshl_b32 s39, s3, 3
    v_lshl_add_u32 v20, v16, 5, s39
    s_lshl_b32 s39, s3, 2
    s_add_u32 s39, s39, 64
    v_mov_b32 v22, s39
    v_cmp_gt_u32 vcc, 32, v0
    s_lshl_b32 s39, s33, 5
    s_add_u32 s39, s39, 40960
    v_cndmask_b32 v20, v22, v20, vcc
    v_add_u32 v20, v20, v17
    v_lshlrev_b32 v20, 7, v20
    v_lshl_add_u32 v20, v18, 3, v20
    s_mov_b32 s46, 2621440
    s_mov_b32 s47, 0x00020000
    s_lshl_b32 s21, s20, 10
    s_lshl_b32 s22, s22, 4
    s_add_u32 s21, s21, s22
    s_add_u32 s21, s21, 24772608
    s_lshl_b32 s22, s32, 10
    s_add_u32 s22, s22, 24772608
    s_add_u32 s20, s52, 98304
    s_add_u32 s48, s62, 32768
    v_mov_b32 v72, -1
    v_mov_b32 v73, -1
    v_mov_b32 v74, -1
    v_mov_b32 v75, -1
    s_waitcnt lgkmcnt(0)
    s_waitcnt vmcnt(22)
    s_barrier
    buffer_store_dword v12, v11, s[56:59], s49 offen sc1
    v_add_u32 v11, s39, v20
    buffer_load_dwordx4 a[160:163], v14, s[56:59], s53 offen offset:0 sc1
    buffer_load_dwordx4 a[164:167], v14, s[56:59], s53 offen offset:1024 sc1
    buffer_load_dwordx4 a[168:171], v14, s[56:59], s53 offen offset:2048 sc1
    buffer_load_dwordx4 a[172:175], v14, s[56:59], s53 offen offset:3072 sc1
    s_add_u32 s53, s53, 4096
    buffer_load_dwordx4 a[176:179], v14, s[56:59], s53 offen offset:0 sc1
    buffer_load_dwordx4 a[180:183], v14, s[56:59], s53 offen offset:1024 sc1
    buffer_load_dwordx4 a[184:187], v14, s[56:59], s53 offen offset:2048 sc1
    buffer_load_dwordx4 a[188:191], v14, s[56:59], s53 offen offset:3072 sc1
    s_add_u32 s53, s53, 4096
    s_waitcnt vmcnt(25)
    s_barrier
    ds_read_b64_tr_b16 v[16:17], v1 offset:0
    ds_read_b64_tr_b16 v[18:19], v1 offset:512
    ds_read_b64_tr_b16 v[20:21], v2 offset:0
    ds_read_b64_tr_b16 v[22:23], v2 offset:512
    ds_read_b64_tr_b16 v[24:25], v1 offset:4096
    ds_read_b64_tr_b16 v[26:27], v1 offset:4608
    ds_read_b64_tr_b16 v[28:29], v2 offset:4096
    ds_read_b64_tr_b16 v[30:31], v2 offset:4608
    ds_read_b64_tr_b16 v[32:33], v1 offset:8192
    ds_read_b64_tr_b16 v[34:35], v1 offset:8704
    s_waitcnt lgkmcnt(8)
    v_mfma_f32_16x16x32_bf16 v[48:51], v[208:211], v[16:19], 0
    ds_read_b64_tr_b16 v[36:37], v2 offset:8192
    ds_read_b64_tr_b16 v[38:39], v2 offset:8704
    v_mfma_f32_16x16x32_bf16 v[52:55], v[212:215], v[16:19], 0
    buffer_store_dword v72, v15, s[56:59], s48 offen sc1
    buffer_store_dwordx4 v[72:75], v8, s[56:59], s20 offen sc1
    v_mfma_f32_16x16x32_bf16 v[56:59], v[216:219], v[16:19], 0
    s_add_u32 s20, s20, 49152
    s_waitcnt lgkmcnt(8)
    v_mfma_f32_16x16x32_bf16 v[60:63], v[208:211], v[20:23], 0
    ds_read_b64_tr_b16 v[40:41], v1 offset:12288
    ds_read_b64_tr_b16 v[42:43], v1 offset:12800
    v_mfma_f32_16x16x32_bf16 v[64:67], v[212:215], v[20:23], 0
    buffer_store_dwordx4 v[72:75], v8, s[56:59], s20 offen sc1
    s_add_u32 s20, s20, 2998272
    v_mfma_f32_16x16x32_bf16 v[68:71], v[216:219], v[20:23], 0
    s_waitcnt lgkmcnt(8)
    v_mfma_f32_16x16x32_bf16 v[48:51], v[220:223], v[24:27], v[48:51]
    ds_read_b64_tr_b16 v[44:45], v2 offset:12288
    ds_read_b64_tr_b16 v[46:47], v2 offset:12800
    v_mfma_f32_16x16x32_bf16 v[52:55], v[224:227], v[24:27], v[52:55]
    v_mfma_f32_16x16x32_bf16 v[56:59], v[228:231], v[24:27], v[56:59]
    buffer_store_dwordx4 v[72:75], v8, s[56:59], s20 offen sc1
    s_add_u32 s20, s20, 49152
    s_waitcnt lgkmcnt(8)
    v_mfma_f32_16x16x32_bf16 v[60:63], v[220:223], v[28:31], v[60:63]
    s_waitcnt vmcnt(25)
    s_barrier
    ds_read_b64_tr_b16 v[16:17], v1 offset:16384
    ds_read_b64_tr_b16 v[18:19], v1 offset:16896
    v_mfma_f32_16x16x32_bf16 v[64:67], v[224:227], v[28:31], v[64:67]
    v_mfma_f32_16x16x32_bf16 v[68:71], v[228:231], v[28:31], v[68:71]
    s_waitcnt lgkmcnt(8)
    v_mfma_f32_16x16x32_bf16 v[48:51], v[232:235], v[32:35], v[48:51]
    ds_read_b64_tr_b16 v[20:21], v2 offset:16384
    ds_read_b64_tr_b16 v[22:23], v2 offset:16896
    v_mfma_f32_16x16x32_bf16 v[52:55], v[236:239], v[32:35], v[52:55]
    buffer_store_dwordx4 v[72:75], v8, s[56:59], s20 offen sc1
    s_add_u32 s20, s20, 49152
    v_mfma_f32_16x16x32_bf16 v[56:59], v[240:243], v[32:35], v[56:59]
    s_waitcnt lgkmcnt(8)
    v_mfma_f32_16x16x32_bf16 v[60:63], v[232:235], v[36:39], v[60:63]
    ds_read_b64_tr_b16 v[24:25], v1 offset:20480
    ds_read_b64_tr_b16 v[26:27], v1 offset:20992
    v_mfma_f32_16x16x32_bf16 v[64:67], v[236:239], v[36:39], v[64:67]
    buffer_store_dwordx4 v[72:75], v8, s[56:59], s20 offen sc1
    s_add_u32 s20, s20, 49152
    v_mfma_f32_16x16x32_bf16 v[68:71], v[240:243], v[36:39], v[68:71]
    s_waitcnt lgkmcnt(8)
    v_mfma_f32_16x16x32_bf16 v[48:51], v[244:247], v[40:43], v[48:51]
    ds_read_b64_tr_b16 v[28:29], v2 offset:20480
    ds_read_b64_tr_b16 v[30:31], v2 offset:20992
    v_mfma_f32_16x16x32_bf16 v[52:55], v[248:251], v[40:43], v[52:55]
    v_mfma_f32_16x16x32_bf16 v[56:59], v[252:255], v[40:43], v[56:59]
    buffer_store_dwordx4 v[72:75], v8, s[56:59], s20 offen sc1
    s_add_u32 s20, s20, 49152
    s_waitcnt lgkmcnt(8)
    v_mfma_f32_16x16x32_bf16 v[60:63], v[244:247], v[44:47], v[60:63]
    ds_read_b64_tr_b16 v[32:33], v1 offset:24576
    ds_read_b64_tr_b16 v[34:35], v1 offset:25088
    v_mfma_f32_16x16x32_bf16 v[64:67], v[248:251], v[44:47], v[64:67]
    v_mfma_f32_16x16x32_bf16 v[68:71], v[252:255], v[44:47], v[68:71]
    ds_read_b64_tr_b16 v[104:105], v7
    s_waitcnt lgkmcnt(9)
    v_mfma_f32_16x16x32_bf16 v[48:51], v[112:115], v[16:19], v[48:51]
    ds_read_b64_tr_b16 v[36:37], v2 offset:24576
    ds_read_b64_tr_b16 v[38:39], v2 offset:25088
    v_mfma_f32_16x16x32_bf16 v[52:55], v[116:119], v[16:19], v[52:55]
    buffer_load_dwordx4 a[0:3], v14, s[56:59], s53 offen offset:0 sc1
    v_mfma_f32_16x16x32_bf16 v[56:59], v[120:123], v[16:19], v[56:59]
    ds_read_b64_tr_b16 v[106:107], v7 offset:512
    v_add_u32 v7, 0x4000, v7
    s_waitcnt lgkmcnt(10)
    v_mfma_f32_16x16x32_bf16 v[60:63], v[112:115], v[20:23], v[60:63]
    ds_read_b64_tr_b16 v[40:41], v1 offset:28672
    ds_read_b64_tr_b16 v[42:43], v1 offset:29184
    v_mfma_f32_16x16x32_bf16 v[64:67], v[116:119], v[20:23], v[64:67]
    buffer_load_dwordx4 a[4:7], v14, s[56:59], s53 offen offset:1024 sc1
    s_waitcnt lgkmcnt(2)
    v_mfma_f32_16x16x32_bf16 v[96:99], v[108:111], v[104:107], 0
    v_mfma_f32_16x16x32_bf16 v[68:71], v[120:123], v[20:23], v[68:71]
    v_mfma_f32_16x16x32_bf16 v[100:103], v[104:107], v[104:107], 0
    ds_read_b64_tr_b16 v[104:105], v7
    v_mfma_f32_16x16x32_bf16 v[48:51], v[124:127], v[24:27], v[48:51]
    ds_read_b64_tr_b16 v[44:45], v2 offset:28672
    ds_read_b64_tr_b16 v[46:47], v2 offset:29184
    v_mfma_f32_16x16x32_bf16 v[52:55], v[128:131], v[24:27], v[52:55]
    v_mfma_f32_16x16x32_bf16 v[56:59], v[132:135], v[24:27], v[56:59]
    ds_read_b64_tr_b16 v[106:107], v7 offset:512
    buffer_load_dwordx4 a[8:11], v14, s[56:59], s53 offen offset:2048 sc1
    v_mfma_f32_16x16x32_bf16 v[60:63], v[124:127], v[28:31], v[60:63]
    s_waitcnt vmcnt(27)
    s_barrier
    ds_read_b64_tr_b16 v[16:17], v1 offset:32768
    ds_read_b64_tr_b16 v[18:19], v1 offset:33280
    v_mfma_f32_16x16x32_bf16 v[64:67], v[128:131], v[28:31], v[64:67]
    v_add_u32 v7, 0x4000, v7
    s_waitcnt lgkmcnt(2)
    v_mfma_f32_16x16x32_bf16 v[96:99], v[108:111], v[104:107], v[96:99]
    v_mfma_f32_16x16x32_bf16 v[68:71], v[132:135], v[28:31], v[68:71]
    v_mfma_f32_16x16x32_bf16 v[100:103], v[104:107], v[104:107], v[100:103]
    ds_read_b64_tr_b16 v[104:105], v7
    v_mfma_f32_16x16x32_bf16 v[48:51], v[136:139], v[32:35], v[48:51]
    ds_read_b64_tr_b16 v[20:21], v2 offset:32768
    ds_read_b64_tr_b16 v[22:23], v2 offset:33280
    v_mfma_f32_16x16x32_bf16 v[52:55], v[140:143], v[32:35], v[52:55]
    buffer_load_dwordx4 a[12:15], v14, s[56:59], s53 offen offset:3072 sc1
    s_add_u32 s53, s53, 4096
    v_mfma_f32_16x16x32_bf16 v[56:59], v[144:147], v[32:35], v[56:59]
    ds_read_b64_tr_b16 v[106:107], v7 offset:512
    v_add_u32 v7, 0x4000, v7
    v_mfma_f32_16x16x32_bf16 v[60:63], v[136:139], v[36:39], v[60:63]
    ds_read_b64_tr_b16 v[24:25], v1 offset:36864
    ds_read_b64_tr_b16 v[26:27], v1 offset:37376
    v_mfma_f32_16x16x32_bf16 v[64:67], v[140:143], v[36:39], v[64:67]
    buffer_load_dwordx4 a[16:19], v14, s[56:59], s53 offen offset:0 sc1
    v_mfma_f32_16x16x32_bf16 v[68:71], v[144:147], v[36:39], v[68:71]
    v_mfma_f32_16x16x32_bf16 v[48:51], v[148:151], v[40:43], v[48:51]
    ds_read_b64_tr_b16 v[28:29], v2 offset:36864
    ds_read_b64_tr_b16 v[30:31], v2 offset:37376
    v_mfma_f32_16x16x32_bf16 v[52:55], v[152:155], v[40:43], v[52:55]
    s_waitcnt lgkmcnt(4)
    v_mfma_f32_16x16x32_bf16 v[96:99], v[108:111], v[104:107], v[96:99]
    v_mfma_f32_16x16x32_bf16 v[100:103], v[104:107], v[104:107], v[100:103]
    v_mfma_f32_16x16x32_bf16 v[56:59], v[156:159], v[40:43], v[56:59]
    buffer_load_dwordx4 a[20:23], v14, s[56:59], s53 offen offset:1024 sc1
    v_mfma_f32_16x16x32_bf16 v[60:63], v[148:151], v[44:47], v[60:63]
    ds_read_b64_tr_b16 v[32:33], v1 offset:40960
    ds_read_b64_tr_b16 v[34:35], v1 offset:41472
    v_mfma_f32_16x16x32_bf16 v[64:67], v[152:155], v[44:47], v[64:67]
    v_mfma_f32_16x16x32_bf16 v[68:71], v[156:159], v[44:47], v[68:71]
    v_mfma_f32_16x16x32_bf16 v[48:51], v[160:163], v[16:19], v[48:51]
    ds_read_b64_tr_b16 v[36:37], v2 offset:40960
    ds_read_b64_tr_b16 v[38:39], v2 offset:41472
    v_mfma_f32_16x16x32_bf16 v[52:55], v[164:167], v[16:19], v[52:55]
    buffer_load_dword v12, v13, s[56:59], s31 offen sc1
    buffer_load_dwordx4 a[24:27], v14, s[56:59], s53 offen offset:2048 sc1
    v_mfma_f32_16x16x32_bf16 v[56:59], v[168:171], v[16:19], v[56:59]
    v_mfma_f32_16x16x32_bf16 v[60:63], v[160:163], v[20:23], v[60:63]
    ds_read_b64_tr_b16 v[40:41], v1 offset:45056
    ds_read_b64_tr_b16 v[42:43], v1 offset:45568
    v_mfma_f32_16x16x32_bf16 v[64:67], v[164:167], v[20:23], v[64:67]
    v_mfma_f32_16x16x32_bf16 v[68:71], v[168:171], v[20:23], v[68:71]
    buffer_load_dwordx4 a[28:31], v14, s[56:59], s53 offen offset:3072 sc1
    s_add_u32 s53, s53, 4096
    s_waitcnt lgkmcnt(8)
    v_mfma_f32_16x16x32_bf16 v[48:51], v[172:175], v[24:27], v[48:51]
    ds_read_b64_tr_b16 v[44:45], v2 offset:45056
    ds_read_b64_tr_b16 v[46:47], v2 offset:45568
    v_mfma_f32_16x16x32_bf16 v[52:55], a[224:227], v[24:27], v[52:55]
    v_mfma_f32_16x16x32_bf16 v[56:59], a[228:231], v[24:27], v[56:59]
    s_waitcnt lgkmcnt(8)
    v_mfma_f32_16x16x32_bf16 v[60:63], v[172:175], v[28:31], v[60:63]
    s_waitcnt vmcnt(29)
    s_barrier
    ds_read_b64_tr_b16 v[16:17], v1 offset:49152
    ds_read_b64_tr_b16 v[18:19], v1 offset:49664
    v_mfma_f32_16x16x32_bf16 v[64:67], a[224:227], v[28:31], v[64:67]
    ds_read_b64_tr_b16 v[104:105], v7
    buffer_load_dwordx4 a[96:99], v14, s[56:59], s53 offen offset:0 sc1
    v_mfma_f32_16x16x32_bf16 v[68:71], a[228:231], v[28:31], v[68:71]
    ds_read_b64_tr_b16 v[106:107], v7 offset:512
    v_add_u32 v7, 0x4000, v7
    s_waitcnt lgkmcnt(10)
    v_mfma_f32_16x16x32_bf16 v[48:51], a[232:235], v[32:35], v[48:51]
    ds_read_b64_tr_b16 v[20:21], v2 offset:49152
    ds_read_b64_tr_b16 v[22:23], v2 offset:49664
    v_mfma_f32_16x16x32_bf16 v[52:55], a[236:239], v[32:35], v[52:55]
    buffer_load_dwordx4 a[100:103], v14, s[56:59], s53 offen offset:1024 sc1
    v_mfma_f32_16x16x32_bf16 v[56:59], a[240:243], v[32:35], v[56:59]
    s_waitcnt lgkmcnt(10)
    v_mfma_f32_16x16x32_bf16 v[60:63], a[232:235], v[36:39], v[60:63]
    ds_read_b64_tr_b16 v[24:25], v1 offset:53248
    ds_read_b64_tr_b16 v[26:27], v1 offset:53760
    v_mfma_f32_16x16x32_bf16 v[64:67], a[236:239], v[36:39], v[64:67]
    v_mfma_f32_16x16x32_bf16 v[68:71], a[240:243], v[36:39], v[68:71]
    buffer_load_dwordx4 a[104:107], v14, s[56:59], s53 offen offset:2048 sc1
    s_waitcnt lgkmcnt(10)
    v_mfma_f32_16x16x32_bf16 v[48:51], a[244:247], v[40:43], v[48:51]
    ds_read_b64_tr_b16 v[28:29], v2 offset:53248
    ds_read_b64_tr_b16 v[30:31], v2 offset:53760
    v_mfma_f32_16x16x32_bf16 v[52:55], a[248:251], v[40:43], v[52:55]
    s_waitcnt lgkmcnt(6)
    v_mfma_f32_16x16x32_bf16 v[96:99], v[108:111], v[104:107], v[96:99]
    v_mfma_f32_16x16x32_bf16 v[100:103], v[104:107], v[104:107], v[100:103]
    v_mfma_f32_16x16x32_bf16 v[56:59], a[252:255], v[40:43], v[56:59]
    v_mfma_f32_16x16x32_bf16 v[60:63], a[244:247], v[44:47], v[60:63]
    ds_read_b64_tr_b16 v[32:33], v1 offset:57344
    ds_read_b64_tr_b16 v[34:35], v1 offset:57856
    v_mfma_f32_16x16x32_bf16 v[64:67], a[248:251], v[44:47], v[64:67]
    buffer_load_dwordx4 a[108:111], v14, s[56:59], s53 offen offset:3072 sc1
    s_add_u32 s53, s53, 4096
    v_mfma_f32_16x16x32_bf16 v[68:71], a[252:255], v[44:47], v[68:71]
    v_mfma_f32_16x16x32_bf16 v[48:51], a[64:67], v[16:19], v[48:51]
    ds_read_b64_tr_b16 v[36:37], v2 offset:57344
    ds_read_b64_tr_b16 v[38:39], v2 offset:57856
    v_mfma_f32_16x16x32_bf16 v[52:55], a[68:71], v[16:19], v[52:55]
    buffer_load_dwordx4 a[112:115], v14, s[56:59], s53 offen offset:0 sc1
    v_mfma_f32_16x16x32_bf16 v[56:59], a[72:75], v[16:19], v[56:59]
    s_waitcnt lgkmcnt(8)
    v_mfma_f32_16x16x32_bf16 v[60:63], a[64:67], v[20:23], v[60:63]
    ds_read_b64_tr_b16 v[40:41], v1 offset:61440
    ds_read_b64_tr_b16 v[42:43], v1 offset:61952
    v_mfma_f32_16x16x32_bf16 v[64:67], a[68:71], v[20:23], v[64:67]
    v_mfma_f32_16x16x32_bf16 v[68:71], a[72:75], v[20:23], v[68:71]
    buffer_load_dwordx4 a[116:119], v14, s[56:59], s53 offen offset:1024 sc1
    s_waitcnt lgkmcnt(8)
    v_mfma_f32_16x16x32_bf16 v[48:51], a[76:79], v[24:27], v[48:51]
    ds_read_b64_tr_b16 v[44:45], v2 offset:61440
    ds_read_b64_tr_b16 v[46:47], v2 offset:61952
    v_mfma_f32_16x16x32_bf16 v[52:55], a[80:83], v[24:27], v[52:55]
    v_mfma_f32_16x16x32_bf16 v[56:59], a[84:87], v[24:27], v[56:59]
    s_waitcnt lgkmcnt(8)
    v_mfma_f32_16x16x32_bf16 v[60:63], a[76:79], v[28:31], v[60:63]
    s_waitcnt vmcnt(31)
    s_barrier
    v_add_u32 v1, 0x10000, v1
    ds_read_b64_tr_b16 v[16:17], v1 offset:0
    ds_read_b64_tr_b16 v[18:19], v1 offset:512
    v_mfma_f32_16x16x32_bf16 v[64:67], a[80:83], v[28:31], v[64:67]
    ds_read_b64_tr_b16 v[104:105], v7
    buffer_load_dwordx4 a[120:123], v14, s[56:59], s53 offen offset:2048 sc1
    v_mfma_f32_16x16x32_bf16 v[68:71], a[84:87], v[28:31], v[68:71]
    ds_read_b64_tr_b16 v[106:107], v7 offset:512
    v_add_u32 v7, 0x4000, v7
    s_waitcnt lgkmcnt(10)
    v_mfma_f32_16x16x32_bf16 v[48:51], a[88:91], v[32:35], v[48:51]
    v_add_u32 v2, 0x10000, v2
    ds_read_b64_tr_b16 v[20:21], v2 offset:0
    ds_read_b64_tr_b16 v[22:23], v2 offset:512
    v_mfma_f32_16x16x32_bf16 v[52:55], a[92:95], v[32:35], v[52:55]
    buffer_load_dwordx4 a[124:127], v14, s[56:59], s53 offen offset:3072 sc1
    s_add_u32 s53, s53, 4096
    v_mfma_f32_16x16x32_bf16 v[56:59], a[192:195], v[32:35], v[56:59]
    s_waitcnt lgkmcnt(10)
    v_mfma_f32_16x16x32_bf16 v[60:63], a[88:91], v[36:39], v[60:63]
    ds_read_b64_tr_b16 v[24:25], v1 offset:4096
    ds_read_b64_tr_b16 v[26:27], v1 offset:4608
    v_mfma_f32_16x16x32_bf16 v[64:67], a[92:95], v[36:39], v[64:67]
    v_mfma_f32_16x16x32_bf16 v[68:71], a[192:195], v[36:39], v[68:71]
    buffer_load_dwordx4 a[128:131], v14, s[56:59], s53 offen offset:0 sc1
    s_waitcnt lgkmcnt(10)
    v_mfma_f32_16x16x32_bf16 v[48:51], a[196:199], v[40:43], v[48:51]
    ds_read_b64_tr_b16 v[28:29], v2 offset:4096
    ds_read_b64_tr_b16 v[30:31], v2 offset:4608
    v_mfma_f32_16x16x32_bf16 v[52:55], a[200:203], v[40:43], v[52:55]
    s_waitcnt lgkmcnt(6)
    v_mfma_f32_16x16x32_bf16 v[96:99], v[108:111], v[104:107], v[96:99]
    v_mfma_f32_16x16x32_bf16 v[100:103], v[104:107], v[104:107], v[100:103]
    v_mfma_f32_16x16x32_bf16 v[56:59], a[204:207], v[40:43], v[56:59]
    v_mfma_f32_16x16x32_bf16 v[60:63], a[196:199], v[44:47], v[60:63]
    ds_read_b64_tr_b16 v[32:33], v1 offset:8192
    ds_read_b64_tr_b16 v[34:35], v1 offset:8704
    v_mfma_f32_16x16x32_bf16 v[64:67], a[200:203], v[44:47], v[64:67]
    buffer_load_dwordx4 a[132:135], v14, s[56:59], s53 offen offset:1024 sc1
    v_mfma_f32_16x16x32_bf16 v[68:71], a[204:207], v[44:47], v[68:71]
    v_mfma_f32_16x16x32_bf16 v[48:51], a[208:211], v[16:19], v[48:51]
    ds_read_b64_tr_b16 v[36:37], v2 offset:8192
    ds_read_b64_tr_b16 v[38:39], v2 offset:8704
    v_mfma_f32_16x16x32_bf16 v[52:55], a[212:215], v[16:19], v[52:55]
    buffer_load_dwordx4 a[136:139], v14, s[56:59], s53 offen offset:2048 sc1
    v_mfma_f32_16x16x32_bf16 v[56:59], a[216:219], v[16:19], v[56:59]
    s_waitcnt lgkmcnt(8)
    v_mfma_f32_16x16x32_bf16 v[60:63], a[208:211], v[20:23], v[60:63]
    ds_read_b64_tr_b16 v[40:41], v1 offset:12288
    ds_read_b64_tr_b16 v[42:43], v1 offset:12800
    v_mfma_f32_16x16x32_bf16 v[64:67], a[212:215], v[20:23], v[64:67]
    v_mfma_f32_16x16x32_bf16 v[68:71], a[216:219], v[20:23], v[68:71]
    buffer_load_dwordx4 a[140:143], v14, s[56:59], s53 offen offset:3072 sc1
    s_add_u32 s53, s53, 4096
    s_waitcnt lgkmcnt(8)
    v_mfma_f32_16x16x32_bf16 v[48:51], a[220:223], v[24:27], v[48:51]
    ds_read_b64_tr_b16 v[44:45], v2 offset:12288
    ds_read_b64_tr_b16 v[46:47], v2 offset:12800
    v_mfma_f32_16x16x32_bf16 v[52:55], a[32:35], v[24:27], v[52:55]
    v_mfma_f32_16x16x32_bf16 v[56:59], a[36:39], v[24:27], v[56:59]
    s_waitcnt lgkmcnt(8)
    v_mfma_f32_16x16x32_bf16 v[60:63], a[220:223], v[28:31], v[60:63]
    ds_read_b64_tr_b16 v[16:17], v3 offset:0
    ds_read_b64_tr_b16 v[18:19], v3 offset:512
    v_mfma_f32_16x16x32_bf16 v[64:67], a[32:35], v[28:31], v[64:67]
    buffer_load_dwordx4 a[144:147], v14, s[56:59], s53 offen offset:0 sc1
    v_mfma_f32_16x16x32_bf16 v[68:71], a[36:39], v[28:31], v[68:71]
    s_waitcnt lgkmcnt(8)
    v_mfma_f32_16x16x32_bf16 v[48:51], a[40:43], v[32:35], v[48:51]
    ds_read_b64_tr_b16 v[20:21], v4 offset:0
    ds_read_b64_tr_b16 v[22:23], v4 offset:512
    v_mfma_f32_16x16x32_bf16 v[52:55], a[44:47], v[32:35], v[52:55]
    buffer_load_dwordx4 a[148:151], v14, s[56:59], s53 offen offset:1024 sc1
    v_mfma_f32_16x16x32_bf16 v[56:59], a[48:51], v[32:35], v[56:59]
    s_waitcnt lgkmcnt(8)
    v_mfma_f32_16x16x32_bf16 v[60:63], a[40:43], v[36:39], v[60:63]
    ds_read_b64_tr_b16 v[24:25], v3 offset:4096
    ds_read_b64_tr_b16 v[26:27], v3 offset:4608
    v_mfma_f32_16x16x32_bf16 v[64:67], a[44:47], v[36:39], v[64:67]
    v_mfma_f32_16x16x32_bf16 v[68:71], a[48:51], v[36:39], v[68:71]
    buffer_load_dwordx4 a[152:155], v14, s[56:59], s53 offen offset:2048 sc1
    s_waitcnt lgkmcnt(8)
    v_mfma_f32_16x16x32_bf16 v[48:51], a[52:55], v[40:43], v[48:51]
    ds_read_b64_tr_b16 v[28:29], v4 offset:4096
    ds_read_b64_tr_b16 v[30:31], v4 offset:4608
    v_mfma_f32_16x16x32_bf16 v[52:55], a[56:59], v[40:43], v[52:55]
    v_mfma_f32_16x16x32_bf16 v[56:59], a[60:63], v[40:43], v[56:59]
    s_waitcnt lgkmcnt(8)
    v_mfma_f32_16x16x32_bf16 v[60:63], a[52:55], v[44:47], v[60:63]
    ds_read_b64_tr_b16 v[32:33], v3 offset:8192
    ds_read_b64_tr_b16 v[34:35], v3 offset:8704
    v_mfma_f32_16x16x32_bf16 v[64:67], a[56:59], v[44:47], v[64:67]
    buffer_load_dwordx4 a[156:159], v14, s[56:59], s53 offen offset:3072 sc1
    s_add_u32 s53, s53, 4096
    v_mfma_f32_16x16x32_bf16 v[68:71], a[60:63], v[44:47], v[68:71]
    s_waitcnt lgkmcnt(8)
    v_mfma_f32_16x16x32_bf16 v[72:75], v[208:211], v[16:19], 0
    ds_read_b64_tr_b16 v[36:37], v4 offset:8192
    ds_read_b64_tr_b16 v[38:39], v4 offset:8704
    v_mfma_f32_16x16x32_bf16 v[76:79], v[212:215], v[16:19], 0
    buffer_load_dwordx4 v[176:179], v14, s[56:59], s53 offen offset:0 sc1
    v_mfma_f32_16x16x32_bf16 v[80:83], v[216:219], v[16:19], 0
    s_waitcnt lgkmcnt(8)
    v_mfma_f32_16x16x32_bf16 v[84:87], v[208:211], v[20:23], 0
    ds_read_b64_tr_b16 v[40:41], v3 offset:12288
    ds_read_b64_tr_b16 v[42:43], v3 offset:12800
    v_mfma_f32_16x16x32_bf16 v[88:91], v[212:215], v[20:23], 0
    v_cndmask_b32 v100, v100, v101, s[36:37]
    v_cndmask_b32 v100, v100, v102, s[40:41]
    v_mfma_f32_16x16x32_bf16 v[92:95], v[216:219], v[20:23], 0
    s_waitcnt vmcnt(19)
    v_cmp_ne_u32 vcc, s60, v12
    s_cbranch_vccz L_sequen_cd_21
L_sequen_pl_22:
    buffer_load_dword v12, v13, s[56:59], s31 offen sc1
    s_waitcnt vmcnt(0)
    v_cmp_ne_u32 vcc, s60, v12
    s_cbranch_vccz L_sequen_pd_23
    s_sub_u32 s61, s61, 1
    s_cbranch_scc0 L_sequen_pl_22
    s_mov_b32 s61, 0
L_sequen_pd_23:
L_sequen_cd_21:
    s_mov_b32 m0, s50
    s_waitcnt lgkmcnt(8)
    v_mfma_f32_16x16x32_bf16 v[72:75], v[220:223], v[24:27], v[72:75]
    ds_read_b64_tr_b16 v[44:45], v4 offset:12288
    ds_read_b64_tr_b16 v[46:47], v4 offset:12800
    v_mfma_f32_16x16x32_bf16 v[76:79], v[224:227], v[24:27], v[76:79]
    s_add_u32 s50, s50, 16384
    buffer_load_dwordx4 v5, s[56:59], s51 offen offset:0 sc1 lds
    v_cndmask_b32 v100, v100, v103, s[42:43]
    v_mfma_f32_16x16x32_bf16 v[80:83], v[228:231], v[24:27], v[80:83]
    v_cndmask_b32 v100, v96, v100, s[34:35]
    s_waitcnt lgkmcnt(8)
    v_mfma_f32_16x16x32_bf16 v[84:87], v[220:223], v[28:31], v[84:87]
    ds_read_b64_tr_b16 v[16:17], v3 offset:16384
    ds_read_b64_tr_b16 v[18:19], v3 offset:16896
    v_mfma_f32_16x16x32_bf16 v[88:91], v[224:227], v[28:31], v[88:91]
    buffer_store_dword v100, v15, s[56:59], s62 offen sc1
    buffer_load_dwordx4 v6, s[56:59], s51 offen offset:1024 sc1 lds
    v_mfma_f32_16x16x32_bf16 v[92:95], v[228:231], v[28:31], v[92:95]
    s_add_u32 s62, s62, 32768
    v_pk_mul_f32 v[48:49], v[48:49], v[52:53]
    v_pk_mul_f32 v[60:61], v[60:61], v[64:65]
    s_waitcnt lgkmcnt(8)
    v_mfma_f32_16x16x32_bf16 v[72:75], v[232:235], v[32:35], v[72:75]
    ds_read_b64_tr_b16 v[20:21], v4 offset:16384
    ds_read_b64_tr_b16 v[22:23], v4 offset:16896
    v_mfma_f32_16x16x32_bf16 v[76:79], v[236:239], v[32:35], v[76:79]
    v_pk_mul_f32 v[50:51], v[50:51], v[54:55]
    v_pk_mul_f32 v[62:63], v[62:63], v[66:67]
    v_mfma_f32_16x16x32_bf16 v[80:83], v[240:243], v[32:35], v[80:83]
    buffer_load_dwordx4 v5, s[56:59], s51 offen offset:2048 sc1 lds
    v_permlane32_swap_b32 v56, v58
    s_waitcnt lgkmcnt(8)
    v_mfma_f32_16x16x32_bf16 v[84:87], v[232:235], v[36:39], v[84:87]
    ds_read_b64_tr_b16 v[24:25], v3 offset:20480
    ds_read_b64_tr_b16 v[26:27], v3 offset:20992
    v_mfma_f32_16x16x32_bf16 v[88:91], v[236:239], v[36:39], v[88:91]
    v_permlane32_swap_b32 v68, v70
    v_permlane32_swap_b32 v57, v59
    v_mfma_f32_16x16x32_bf16 v[92:95], v[240:243], v[36:39], v[92:95]
    v_permlane32_swap_b32 v69, v71
    v_cvt_pk_bf16_f32 v52, v48, v49
    s_waitcnt lgkmcnt(8)
    v_mfma_f32_16x16x32_bf16 v[72:75], v[244:247], v[40:43], v[72:75]
    ds_read_b64_tr_b16 v[28:29], v4 offset:20480
    ds_read_b64_tr_b16 v[30:31], v4 offset:20992
    v_mfma_f32_16x16x32_bf16 v[76:79], v[248:251], v[40:43], v[76:79]
    buffer_load_dwordx4 v6, s[56:59], s51 offen offset:3072 sc1 lds
    s_add_u32 s51, s51, 16384
    s_mov_b32 m0, s50
    v_mfma_f32_16x16x32_bf16 v[80:83], v[252:255], v[40:43], v[80:83]
    s_add_u32 s50, s50, 16384
    v_cvt_pk_bf16_f32 v64, v60, v61
    v_cvt_pk_bf16_f32 v53, v50, v51
    s_waitcnt lgkmcnt(8)
    v_mfma_f32_16x16x32_bf16 v[84:87], v[244:247], v[44:47], v[84:87]
    ds_read_b64_tr_b16 v[32:33], v3 offset:24576
    ds_read_b64_tr_b16 v[34:35], v3 offset:25088
    v_mfma_f32_16x16x32_bf16 v[88:91], v[248:251], v[44:47], v[88:91]
    buffer_load_dwordx4 v5, s[56:59], s51 offen offset:0 sc1 lds
    v_cvt_pk_bf16_f32 v65, v62, v63
    v_mfma_f32_16x16x32_bf16 v[92:95], v[252:255], v[44:47], v[92:95]
    v_pk_mul_f32 v[56:57], v[56:57], v[58:59]
    v_pk_mul_f32 v[68:69], v[68:69], v[70:71]
    s_waitcnt lgkmcnt(8)
    v_mfma_f32_16x16x32_bf16 v[72:75], v[112:115], v[16:19], v[72:75]
    ds_read_b64_tr_b16 v[36:37], v4 offset:24576
    ds_read_b64_tr_b16 v[38:39], v4 offset:25088
    v_mfma_f32_16x16x32_bf16 v[76:79], v[116:119], v[16:19], v[76:79]
    v_cvt_pk_bf16_f32 v54, v56, v57
    v_cvt_pk_bf16_f32 v66, v68, v69
    v_mfma_f32_16x16x32_bf16 v[80:83], v[120:123], v[16:19], v[80:83]
    buffer_load_dwordx4 v6, s[56:59], s51 offen offset:1024 sc1 lds
    v_permlane16_swap_b32 v52, v53
    s_waitcnt lgkmcnt(8)
    v_mfma_f32_16x16x32_bf16 v[84:87], v[112:115], v[20:23], v[84:87]
    ds_read_b64_tr_b16 v[40:41], v3 offset:28672
    ds_read_b64_tr_b16 v[42:43], v3 offset:29184
    v_mfma_f32_16x16x32_bf16 v[88:91], v[116:119], v[20:23], v[88:91]
    v_permlane16_swap_b32 v64, v65
    v_permlane16_swap_b32 v54, v55
    v_mfma_f32_16x16x32_bf16 v[92:95], v[120:123], v[20:23], v[92:95]
    v_permlane16_swap_b32 v66, v67
    v_permlane32_swap_b32 v52, v54
    s_waitcnt lgkmcnt(8)
    v_mfma_f32_16x16x32_bf16 v[72:75], v[124:127], v[24:27], v[72:75]
    ds_read_b64_tr_b16 v[44:45], v4 offset:28672
    ds_read_b64_tr_b16 v[46:47], v4 offset:29184
    v_mfma_f32_16x16x32_bf16 v[76:79], v[128:131], v[24:27], v[76:79]
    buffer_load_dwordx4 v5, s[56:59], s51 offen offset:2048 sc1 lds
    v_permlane32_swap_b32 v64, v66
    v_mfma_f32_16x16x32_bf16 v[80:83], v[132:135], v[24:27], v[80:83]
    v_permlane32_swap_b32 v53, v55
    v_permlane32_swap_b32 v65, v67
    s_waitcnt lgkmcnt(8)
    v_mfma_f32_16x16x32_bf16 v[84:87], v[124:127], v[28:31], v[84:87]
    ds_read_b64_tr_b16 v[16:17], v3 offset:32768
    ds_read_b64_tr_b16 v[18:19], v3 offset:33280
    v_mfma_f32_16x16x32_bf16 v[88:91], v[128:131], v[28:31], v[88:91]
    buffer_store_dwordx4 v[52:55], v8, s[56:59], s52 offen sc1
    s_add_u32 s52, s52, 49152
    v_mfma_f32_16x16x32_bf16 v[92:95], v[132:135], v[28:31], v[92:95]
    s_waitcnt lgkmcnt(8)
    v_mfma_f32_16x16x32_bf16 v[72:75], v[136:139], v[32:35], v[72:75]
    ds_read_b64_tr_b16 v[20:21], v4 offset:32768
    ds_read_b64_tr_b16 v[22:23], v4 offset:33280
    v_mfma_f32_16x16x32_bf16 v[76:79], v[140:143], v[32:35], v[76:79]
    v_mfma_f32_16x16x32_bf16 v[80:83], v[144:147], v[32:35], v[80:83]
    buffer_store_dwordx4 v[64:67], v8, s[56:59], s52 offen sc1
    s_add_u32 s52, s52, 49152
    s_waitcnt lgkmcnt(8)
    v_mfma_f32_16x16x32_bf16 v[84:87], v[136:139], v[36:39], v[84:87]
    ds_read_b64_tr_b16 v[24:25], v3 offset:36864
    ds_read_b64_tr_b16 v[26:27], v3 offset:37376
    v_mfma_f32_16x16x32_bf16 v[88:91], v[140:143], v[36:39], v[88:91]
    v_mfma_f32_16x16x32_bf16 v[92:95], v[144:147], v[36:39], v[92:95]
    s_waitcnt lgkmcnt(8)
    v_mfma_f32_16x16x32_bf16 v[72:75], v[148:151], v[40:43], v[72:75]
    ds_read_b64_tr_b16 v[28:29], v4 offset:36864
    ds_read_b64_tr_b16 v[30:31], v4 offset:37376
    v_mfma_f32_16x16x32_bf16 v[76:79], v[152:155], v[40:43], v[76:79]
    buffer_load_dwordx4 v6, s[56:59], s51 offen offset:3072 sc1 lds
    s_add_u32 s51, s51, 16384
    s_mov_b32 m0, s50
    v_mfma_f32_16x16x32_bf16 v[80:83], v[156:159], v[40:43], v[80:83]
    s_add_u32 s50, s50, 16384
    s_waitcnt lgkmcnt(8)
    v_mfma_f32_16x16x32_bf16 v[84:87], v[148:151], v[44:47], v[84:87]
    ds_read_b64_tr_b16 v[32:33], v3 offset:40960
    ds_read_b64_tr_b16 v[34:35], v3 offset:41472
    v_mfma_f32_16x16x32_bf16 v[88:91], v[152:155], v[44:47], v[88:91]
    buffer_load_dwordx4 v5, s[56:59], s51 offen offset:0 sc1 lds
    v_mfma_f32_16x16x32_bf16 v[92:95], v[156:159], v[44:47], v[92:95]
    s_waitcnt lgkmcnt(8)
    v_mfma_f32_16x16x32_bf16 v[72:75], v[160:163], v[16:19], v[72:75]
    ds_read_b64_tr_b16 v[36:37], v4 offset:40960
    ds_read_b64_tr_b16 v[38:39], v4 offset:41472
    v_mfma_f32_16x16x32_bf16 v[76:79], v[164:167], v[16:19], v[76:79]
    v_mfma_f32_16x16x32_bf16 v[80:83], v[168:171], v[16:19], v[80:83]
    buffer_load_dwordx4 v6, s[56:59], s51 offen offset:1024 sc1 lds
    s_waitcnt lgkmcnt(8)
    v_mfma_f32_16x16x32_bf16 v[84:87], v[160:163], v[20:23], v[84:87]
    ds_read_b64_tr_b16 v[40:41], v3 offset:45056
    ds_read_b64_tr_b16 v[42:43], v3 offset:45568
    v_mfma_f32_16x16x32_bf16 v[88:91], v[164:167], v[20:23], v[88:91]
    v_mfma_f32_16x16x32_bf16 v[92:95], v[168:171], v[20:23], v[92:95]
    s_waitcnt lgkmcnt(8)
    v_mfma_f32_16x16x32_bf16 v[72:75], v[172:175], v[24:27], v[72:75]
    ds_read_b64_tr_b16 v[44:45], v4 offset:45056
    ds_read_b64_tr_b16 v[46:47], v4 offset:45568
    v_mfma_f32_16x16x32_bf16 v[76:79], a[224:227], v[24:27], v[76:79]
    buffer_load_dwordx4 v5, s[56:59], s51 offen offset:2048 sc1 lds
    v_mfma_f32_16x16x32_bf16 v[80:83], a[228:231], v[24:27], v[80:83]
    s_waitcnt lgkmcnt(8)
    v_mfma_f32_16x16x32_bf16 v[84:87], v[172:175], v[28:31], v[84:87]
    ds_read_b64_tr_b16 v[16:17], v3 offset:49152
    ds_read_b64_tr_b16 v[18:19], v3 offset:49664
    v_mfma_f32_16x16x32_bf16 v[88:91], a[224:227], v[28:31], v[88:91]
    buffer_load_dwordx4 v6, s[56:59], s51 offen offset:3072 sc1 lds
    s_add_u32 s51, s51, 16384
    s_mov_b32 m0, s50
    v_mfma_f32_16x16x32_bf16 v[92:95], a[228:231], v[28:31], v[92:95]
    s_add_u32 s50, s50, 16384
    s_waitcnt lgkmcnt(8)
    v_mfma_f32_16x16x32_bf16 v[72:75], a[232:235], v[32:35], v[72:75]
    ds_read_b64_tr_b16 v[20:21], v4 offset:49152
    ds_read_b64_tr_b16 v[22:23], v4 offset:49664
    v_mfma_f32_16x16x32_bf16 v[76:79], a[236:239], v[32:35], v[76:79]
    v_mfma_f32_16x16x32_bf16 v[80:83], a[240:243], v[32:35], v[80:83]
    buffer_load_dwordx4 v5, s[56:59], s51 offen offset:0 sc1 lds
    s_waitcnt lgkmcnt(8)
    v_mfma_f32_16x16x32_bf16 v[84:87], a[232:235], v[36:39], v[84:87]
    ds_read_b64_tr_b16 v[24:25], v3 offset:53248
    ds_read_b64_tr_b16 v[26:27], v3 offset:53760
    v_mfma_f32_16x16x32_bf16 v[88:91], a[236:239], v[36:39], v[88:91]
    v_mfma_f32_16x16x32_bf16 v[92:95], a[240:243], v[36:39], v[92:95]
    s_waitcnt lgkmcnt(8)
    v_mfma_f32_16x16x32_bf16 v[72:75], a[244:247], v[40:43], v[72:75]
    ds_read_b64_tr_b16 v[28:29], v4 offset:53248
    ds_read_b64_tr_b16 v[30:31], v4 offset:53760
    v_mfma_f32_16x16x32_bf16 v[76:79], a[248:251], v[40:43], v[76:79]
    buffer_load_dwordx4 v6, s[56:59], s51 offen offset:1024 sc1 lds
    v_mfma_f32_16x16x32_bf16 v[80:83], a[252:255], v[40:43], v[80:83]
    s_waitcnt lgkmcnt(8)
    v_mfma_f32_16x16x32_bf16 v[84:87], a[244:247], v[44:47], v[84:87]
    ds_read_b64_tr_b16 v[32:33], v3 offset:57344
    ds_read_b64_tr_b16 v[34:35], v3 offset:57856
    v_mfma_f32_16x16x32_bf16 v[88:91], a[248:251], v[44:47], v[88:91]
    buffer_load_dwordx4 v5, s[56:59], s51 offen offset:2048 sc1 lds
    v_mfma_f32_16x16x32_bf16 v[92:95], a[252:255], v[44:47], v[92:95]
    s_waitcnt lgkmcnt(8)
    v_mfma_f32_16x16x32_bf16 v[72:75], a[64:67], v[16:19], v[72:75]
    ds_read_b64_tr_b16 v[36:37], v4 offset:57344
    ds_read_b64_tr_b16 v[38:39], v4 offset:57856
    v_mfma_f32_16x16x32_bf16 v[76:79], a[68:71], v[16:19], v[76:79]
    v_mfma_f32_16x16x32_bf16 v[80:83], a[72:75], v[16:19], v[80:83]
    buffer_load_dwordx4 v6, s[56:59], s51 offen offset:3072 sc1 lds
    s_add_u32 s51, s51, 16384
    s_mov_b32 m0, s50
    s_waitcnt lgkmcnt(8)
    v_mfma_f32_16x16x32_bf16 v[84:87], a[64:67], v[20:23], v[84:87]
    ds_read_b64_tr_b16 v[40:41], v3 offset:61440
    ds_read_b64_tr_b16 v[42:43], v3 offset:61952
    v_mfma_f32_16x16x32_bf16 v[88:91], a[68:71], v[20:23], v[88:91]
    s_add_u32 s50, s50, 16384
    v_mfma_f32_16x16x32_bf16 v[92:95], a[72:75], v[20:23], v[92:95]
    s_waitcnt lgkmcnt(8)
    v_mfma_f32_16x16x32_bf16 v[72:75], a[76:79], v[24:27], v[72:75]
    ds_read_b64_tr_b16 v[44:45], v4 offset:61440
    ds_read_b64_tr_b16 v[46:47], v4 offset:61952
    v_mfma_f32_16x16x32_bf16 v[76:79], a[80:83], v[24:27], v[76:79]
    buffer_load_dwordx4 v5, s[56:59], s51 offen offset:0 sc1 lds
    v_mfma_f32_16x16x32_bf16 v[80:83], a[84:87], v[24:27], v[80:83]
    s_waitcnt lgkmcnt(8)
    v_mfma_f32_16x16x32_bf16 v[84:87], a[76:79], v[28:31], v[84:87]
    v_add_u32 v3, 0x10000, v3
    ds_read_b64_tr_b16 v[16:17], v3 offset:0
    ds_read_b64_tr_b16 v[18:19], v3 offset:512
    v_mfma_f32_16x16x32_bf16 v[88:91], a[80:83], v[28:31], v[88:91]
    buffer_load_dwordx4 v6, s[56:59], s51 offen offset:1024 sc1 lds
    v_mfma_f32_16x16x32_bf16 v[92:95], a[84:87], v[28:31], v[92:95]
    s_waitcnt lgkmcnt(8)
    v_mfma_f32_16x16x32_bf16 v[72:75], a[88:91], v[32:35], v[72:75]
    v_add_u32 v4, 0x10000, v4
    ds_read_b64_tr_b16 v[20:21], v4 offset:0
    ds_read_b64_tr_b16 v[22:23], v4 offset:512
    v_mfma_f32_16x16x32_bf16 v[76:79], a[92:95], v[32:35], v[76:79]
    v_mfma_f32_16x16x32_bf16 v[80:83], a[192:195], v[32:35], v[80:83]
    buffer_load_dwordx4 v5, s[56:59], s51 offen offset:2048 sc1 lds
    s_waitcnt lgkmcnt(8)
    v_mfma_f32_16x16x32_bf16 v[84:87], a[88:91], v[36:39], v[84:87]
    ds_read_b64_tr_b16 v[24:25], v3 offset:4096
    ds_read_b64_tr_b16 v[26:27], v3 offset:4608
    v_mfma_f32_16x16x32_bf16 v[88:91], a[92:95], v[36:39], v[88:91]
    v_mfma_f32_16x16x32_bf16 v[92:95], a[192:195], v[36:39], v[92:95]
    s_waitcnt lgkmcnt(8)
    v_mfma_f32_16x16x32_bf16 v[72:75], a[196:199], v[40:43], v[72:75]
    ds_read_b64_tr_b16 v[28:29], v4 offset:4096
    ds_read_b64_tr_b16 v[30:31], v4 offset:4608
    v_mfma_f32_16x16x32_bf16 v[76:79], a[200:203], v[40:43], v[76:79]
    buffer_load_dwordx4 v6, s[56:59], s51 offen offset:3072 sc1 lds
    s_add_u32 s51, s51, 1245184
    v_and_b32 v12, 15, v0
    v_mfma_f32_16x16x32_bf16 v[80:83], a[204:207], v[40:43], v[80:83]
    v_lshrrev_b32 v13, 4, v0
    v_mul_u32_u24 v6, 1280, v12
    s_waitcnt lgkmcnt(8)
    v_mfma_f32_16x16x32_bf16 v[84:87], a[196:199], v[44:47], v[84:87]
    ds_read_b64_tr_b16 v[32:33], v3 offset:8192
    ds_read_b64_tr_b16 v[34:35], v3 offset:8704
    v_mfma_f32_16x16x32_bf16 v[88:91], a[200:203], v[44:47], v[88:91]
    s_lshl_b32 s39, s3, 4
    v_lshl_add_u32 v5, v13, 6, v6
    v_mfma_f32_16x16x32_bf16 v[92:95], a[204:207], v[44:47], v[92:95]
    v_add_u32 v5, s39, v5
    s_lshl_b32 s39, s3, 3
    s_waitcnt lgkmcnt(8)
    v_mfma_f32_16x16x32_bf16 v[72:75], a[208:211], v[16:19], v[72:75]
    ds_read_b64_tr_b16 v[36:37], v4 offset:8192
    ds_read_b64_tr_b16 v[38:39], v4 offset:8704
    v_mfma_f32_16x16x32_bf16 v[76:79], a[212:215], v[16:19], v[76:79]
    s_add_u32 s39, s39, 128
    v_add_u32 v6, s39, v6
    v_mfma_f32_16x16x32_bf16 v[80:83], a[216:219], v[16:19], v[80:83]
    v_cmp_gt_u32 vcc, 2, v13
    v_cmp_eq_u32 s[54:55], 2, v13
    s_waitcnt lgkmcnt(8)
    v_mfma_f32_16x16x32_bf16 v[84:87], a[208:211], v[20:23], v[84:87]
    ds_read_b64_tr_b16 v[40:41], v3 offset:12288
    ds_read_b64_tr_b16 v[42:43], v3 offset:12800
    v_mfma_f32_16x16x32_bf16 v[88:91], a[212:215], v[20:23], v[88:91]
    v_lshlrev_b32 v13, 3, v13
    v_lshl_add_u32 v13, v12, 5, v13
    v_mfma_f32_16x16x32_bf16 v[92:95], a[216:219], v[20:23], v[92:95]
    v_mov_b32 v12, 0x80000000
    v_cndmask_b32 v5, v12, v5, vcc
    s_waitcnt lgkmcnt(8)
    v_mfma_f32_16x16x32_bf16 v[72:75], a[220:223], v[24:27], v[72:75]
    ds_read_b64_tr_b16 v[44:45], v4 offset:12288
    ds_read_b64_tr_b16 v[46:47], v4 offset:12800
    v_mfma_f32_16x16x32_bf16 v[76:79], a[32:35], v[24:27], v[76:79]
    v_cndmask_b32 v6, v12, v6, s[54:55]
    buffer_load_dwordx4 v[180:183], v14, s[56:59], s53 offen offset:1024 sc1
    v_mfma_f32_16x16x32_bf16 v[80:83], a[36:39], v[24:27], v[80:83]
    s_waitcnt lgkmcnt(8)
    v_mfma_f32_16x16x32_bf16 v[84:87], a[220:223], v[28:31], v[84:87]
    s_waitcnt vmcnt(19)
    s_barrier
    ds_read_b64_tr_b16 v[16:17], v1 offset:16384
    ds_read_b64_tr_b16 v[18:19], v1 offset:16896
    v_mfma_f32_16x16x32_bf16 v[88:91], a[32:35], v[28:31], v[88:91]
    ds_read_b64_tr_b16 v[104:105], v7
    buffer_load_dwordx4 v[184:187], v14, s[56:59], s53 offen offset:2048 sc1
    v_mfma_f32_16x16x32_bf16 v[92:95], a[36:39], v[28:31], v[92:95]
    ds_read_b64_tr_b16 v[106:107], v7 offset:512
    v_add_u32 v7, 0x4000, v7
    s_waitcnt lgkmcnt(10)
    v_mfma_f32_16x16x32_bf16 v[72:75], a[40:43], v[32:35], v[72:75]
    ds_read_b64_tr_b16 v[20:21], v2 offset:16384
    ds_read_b64_tr_b16 v[22:23], v2 offset:16896
    v_mfma_f32_16x16x32_bf16 v[76:79], a[44:47], v[32:35], v[76:79]
    buffer_load_dwordx4 v[188:191], v14, s[56:59], s53 offen offset:3072 sc1
    s_add_u32 s53, s53, 4096
    v_cmp_eq_u32 s[32:33], 0, v0
    v_mfma_f32_16x16x32_bf16 v[80:83], a[48:51], v[32:35], v[80:83]
    v_mov_b32 v48, 0x80000000
    v_mov_b32 v49, s60
    s_waitcnt lgkmcnt(10)
    v_mfma_f32_16x16x32_bf16 v[84:87], a[40:43], v[36:39], v[84:87]
    ds_read_b64_tr_b16 v[24:25], v1 offset:20480
    ds_read_b64_tr_b16 v[26:27], v1 offset:20992
    v_mfma_f32_16x16x32_bf16 v[88:91], a[44:47], v[36:39], v[88:91]
    v_cndmask_b32 v48, v48, v14, s[32:33]
    s_waitcnt vmcnt(16)
    v_mfma_f32_16x16x32_bf16 v[92:95], a[48:51], v[36:39], v[92:95]
    buffer_store_dword v49, v48, s[56:59], s21 offen sc1
    s_waitcnt lgkmcnt(10)
    v_mfma_f32_16x16x32_bf16 v[72:75], a[52:55], v[40:43], v[72:75]
    ds_read_b64_tr_b16 v[28:29], v2 offset:20480
    ds_read_b64_tr_b16 v[30:31], v2 offset:20992
    v_mfma_f32_16x16x32_bf16 v[76:79], a[56:59], v[40:43], v[76:79]
    buffer_load_dwordx4 v[192:195], v14, s[56:59], s53 offen offset:0 sc1
    s_waitcnt lgkmcnt(6)
    v_mfma_f32_16x16x32_bf16 v[96:99], v[108:111], v[104:107], 0
    v_mfma_f32_16x16x32_bf16 v[80:83], a[60:63], v[40:43], v[80:83]
    v_mfma_f32_16x16x32_bf16 v[100:103], v[104:107], v[104:107], 0
    v_mfma_f32_16x16x32_bf16 v[84:87], a[52:55], v[44:47], v[84:87]
    ds_read_b64_tr_b16 v[32:33], v1 offset:24576
    ds_read_b64_tr_b16 v[34:35], v1 offset:25088
    v_mfma_f32_16x16x32_bf16 v[88:91], a[56:59], v[44:47], v[88:91]
    buffer_load_dwordx4 v[196:199], v14, s[56:59], s53 offen offset:1024 sc1
    v_mfma_f32_16x16x32_bf16 v[92:95], a[60:63], v[44:47], v[92:95]
    v_mfma_f32_16x16x32_bf16 v[48:51], v[208:211], v[16:19], 0
    ds_read_b64_tr_b16 v[36:37], v2 offset:24576
    ds_read_b64_tr_b16 v[38:39], v2 offset:25088
    v_mfma_f32_16x16x32_bf16 v[52:55], v[212:215], v[16:19], 0
    v_mfma_f32_16x16x32_bf16 v[56:59], v[216:219], v[16:19], 0
    buffer_load_dwordx4 v[200:203], v14, s[56:59], s53 offen offset:2048 sc1
    s_waitcnt lgkmcnt(8)
    v_mfma_f32_16x16x32_bf16 v[60:63], v[208:211], v[20:23], 0
    ds_read_b64_tr_b16 v[40:41], v1 offset:28672
    ds_read_b64_tr_b16 v[42:43], v1 offset:29184
    v_mfma_f32_16x16x32_bf16 v[64:67], v[212:215], v[20:23], 0
    v_pk_mul_f32 v[72:73], v[72:73], v[76:77]
    v_pk_mul_f32 v[84:85], v[84:85], v[88:89]
    v_mfma_f32_16x16x32_bf16 v[68:71], v[216:219], v[20:23], 0
    v_pk_mul_f32 v[74:75], v[74:75], v[78:79]
    v_pk_mul_f32 v[86:87], v[86:87], v[90:91]
    s_waitcnt lgkmcnt(8)
    v_mfma_f32_16x16x32_bf16 v[48:51], v[220:223], v[24:27], v[48:51]
    ds_read_b64_tr_b16 v[44:45], v2 offset:28672
    ds_read_b64_tr_b16 v[46:47], v2 offset:29184
    v_mfma_f32_16x16x32_bf16 v[52:55], v[224:227], v[24:27], v[52:55]
    buffer_load_dwordx4 v[204:207], v14, s[56:59], s53 offen offset:3072 sc1
    s_add_u32 s53, s53, 4096
    v_permlane32_swap_b32 v80, v82
    v_mfma_f32_16x16x32_bf16 v[56:59], v[228:231], v[24:27], v[56:59]
    v_permlane32_swap_b32 v92, v94
    v_permlane32_swap_b32 v81, v83
    s_waitcnt lgkmcnt(8)
    v_mfma_f32_16x16x32_bf16 v[60:63], v[220:223], v[28:31], v[60:63]
    s_waitcnt vmcnt(20)
    s_barrier
    ds_read_b64_tr_b16 v[16:17], v1 offset:32768
    ds_read_b64_tr_b16 v[18:19], v1 offset:33280
    v_mfma_f32_16x16x32_bf16 v[64:67], v[224:227], v[28:31], v[64:67]
    v_permlane32_swap_b32 v93, v95
    v_cvt_pk_bf16_f32 v76, v72, v73
    v_mfma_f32_16x16x32_bf16 v[68:71], v[228:231], v[28:31], v[68:71]
    v_cvt_pk_bf16_f32 v88, v84, v85
    v_cvt_pk_bf16_f32 v77, v74, v75
    s_waitcnt lgkmcnt(8)
    v_mfma_f32_16x16x32_bf16 v[48:51], v[232:235], v[32:35], v[48:51]
    ds_read_b64_tr_b16 v[20:21], v2 offset:32768
    ds_read_b64_tr_b16 v[22:23], v2 offset:33280
    v_mfma_f32_16x16x32_bf16 v[52:55], v[236:239], v[32:35], v[52:55]
    s_mov_b32 m0, s63
    s_add_u32 s63, s63, 4096
    buffer_load_dwordx4 v14, s[56:59], s23 offen offset:0 sc1 lds
    v_mfma_f32_16x16x32_bf16 v[56:59], v[240:243], v[32:35], v[56:59]
    v_cvt_pk_bf16_f32 v89, v86, v87
    v_pk_mul_f32 v[80:81], v[80:81], v[82:83]
    s_waitcnt lgkmcnt(8)
    v_mfma_f32_16x16x32_bf16 v[60:63], v[232:235], v[36:39], v[60:63]
    ds_read_b64_tr_b16 v[24:25], v1 offset:36864
    ds_read_b64_tr_b16 v[26:27], v1 offset:37376
    v_mfma_f32_16x16x32_bf16 v[64:67], v[236:239], v[36:39], v[64:67]
    buffer_load_dwordx4 v14, s[56:59], s23 offen offset:1024 sc1 lds
    v_pk_mul_f32 v[92:93], v[92:93], v[94:95]
    v_mfma_f32_16x16x32_bf16 v[68:71], v[240:243], v[36:39], v[68:71]
    v_cvt_pk_bf16_f32 v78, v80, v81
    v_cvt_pk_bf16_f32 v90, v92, v93
    s_waitcnt lgkmcnt(8)
    v_mfma_f32_16x16x32_bf16 v[48:51], v[244:247], v[40:43], v[48:51]
    ds_read_b64_tr_b16 v[28:29], v2 offset:36864
    ds_read_b64_tr_b16 v[30:31], v2 offset:37376
    v_mfma_f32_16x16x32_bf16 v[52:55], v[248:251], v[40:43], v[52:55]
    buffer_load_dwordx4 v14, s[56:59], s23 offen offset:2048 sc1 lds
    v_permlane16_swap_b32 v76, v77
    v_mfma_f32_16x16x32_bf16 v[56:59], v[252:255], v[40:43], v[56:59]
    v_permlane16_swap_b32 v88, v89
    v_permlane16_swap_b32 v78, v79
    s_waitcnt lgkmcnt(8)
    v_mfma_f32_16x16x32_bf16 v[60:63], v[244:247], v[44:47], v[60:63]
    ds_read_b64_tr_b16 v[32:33], v1 offset:40960
    ds_read_b64_tr_b16 v[34:35], v1 offset:41472
    v_mfma_f32_16x16x32_bf16 v[64:67], v[248:251], v[44:47], v[64:67]
    v_permlane16_swap_b32 v90, v91
    v_permlane32_swap_b32 v76, v78
    v_mfma_f32_16x16x32_bf16 v[68:71], v[252:255], v[44:47], v[68:71]
    buffer_load_dwordx4 v14, s[56:59], s23 offen offset:3072 sc1 lds
    s_mov_b32 m0, s63
    s_waitcnt lgkmcnt(8)
    v_mfma_f32_16x16x32_bf16 v[48:51], v[112:115], v[16:19], v[48:51]
    ds_read_b64_tr_b16 v[36:37], v2 offset:40960
    ds_read_b64_tr_b16 v[38:39], v2 offset:41472
    v_mfma_f32_16x16x32_bf16 v[52:55], v[116:119], v[16:19], v[52:55]
    s_add_u32 s23, s23, 4096
    v_permlane32_swap_b32 v88, v90
    v_permlane32_swap_b32 v77, v79
    v_mfma_f32_16x16x32_bf16 v[56:59], v[120:123], v[16:19], v[56:59]
    v_permlane32_swap_b32 v89, v91
    s_waitcnt lgkmcnt(8)
    v_mfma_f32_16x16x32_bf16 v[60:63], v[112:115], v[20:23], v[60:63]
    ds_read_b64_tr_b16 v[40:41], v1 offset:45056
    ds_read_b64_tr_b16 v[42:43], v1 offset:45568
    v_mfma_f32_16x16x32_bf16 v[64:67], v[116:119], v[20:23], v[64:67]
    buffer_store_dwordx4 v[76:79], v8, s[56:59], s52 offen sc1
    s_add_u32 s52, s52, 49152
    v_mfma_f32_16x16x32_bf16 v[68:71], v[120:123], v[20:23], v[68:71]
    s_waitcnt lgkmcnt(8)
    v_mfma_f32_16x16x32_bf16 v[48:51], v[124:127], v[24:27], v[48:51]
    ds_read_b64_tr_b16 v[44:45], v2 offset:45056
    ds_read_b64_tr_b16 v[46:47], v2 offset:45568
    v_mfma_f32_16x16x32_bf16 v[52:55], v[128:131], v[24:27], v[52:55]
    buffer_store_dwordx4 v[88:91], v8, s[56:59], s52 offen sc1
    s_add_u32 s52, s52, 2998272
    ds_read_b64_tr_b16 v[104:105], v7
    v_mfma_f32_16x16x32_bf16 v[56:59], v[132:135], v[24:27], v[56:59]
    ds_read_b64_tr_b16 v[106:107], v7 offset:512
    v_add_u32 v7, 0x4000, v7
    s_waitcnt lgkmcnt(10)
    v_mfma_f32_16x16x32_bf16 v[60:63], v[124:127], v[28:31], v[60:63]
    s_waitcnt vmcnt(22)
    s_barrier
    ds_read_b64_tr_b16 v[16:17], v1 offset:49152
    ds_read_b64_tr_b16 v[18:19], v1 offset:49664
    v_mfma_f32_16x16x32_bf16 v[64:67], v[128:131], v[28:31], v[64:67]
    s_waitcnt lgkmcnt(2)
    v_mfma_f32_16x16x32_bf16 v[96:99], v[108:111], v[104:107], v[96:99]
    v_mfma_f32_16x16x32_bf16 v[100:103], v[104:107], v[104:107], v[100:103]
    v_mfma_f32_16x16x32_bf16 v[68:71], v[132:135], v[28:31], v[68:71]
    ds_read_b64_tr_b16 v[104:105], v7
    buffer_load_dwordx4 v14, s[56:59], s23 offen sc1 lds
    v_mfma_f32_16x16x32_bf16 v[48:51], v[136:139], v[32:35], v[48:51]
    ds_read_b64_tr_b16 v[20:21], v2 offset:49152
    ds_read_b64_tr_b16 v[22:23], v2 offset:49664
    v_mfma_f32_16x16x32_bf16 v[52:55], v[140:143], v[32:35], v[52:55]
    ds_read_b64_tr_b16 v[106:107], v7 offset:512
    s_add_u32 s23, s23, 1024
    s_add_u32 s63, s63, 16384
    s_mov_b32 m0, s63
    v_mfma_f32_16x16x32_bf16 v[56:59], v[144:147], v[32:35], v[56:59]
    s_add_u32 s63, s63, 4096
    v_add_u32 v7, 0x4000, v7
    v_mfma_f32_16x16x32_bf16 v[60:63], v[136:139], v[36:39], v[60:63]
    ds_read_b64_tr_b16 v[24:25], v1 offset:53248
    ds_read_b64_tr_b16 v[26:27], v1 offset:53760
    v_mfma_f32_16x16x32_bf16 v[64:67], v[140:143], v[36:39], v[64:67]
    buffer_load_dwordx4 v14, s[56:59], s23 offen offset:0 sc1 lds
    v_mfma_f32_16x16x32_bf16 v[68:71], v[144:147], v[36:39], v[68:71]
    v_mfma_f32_16x16x32_bf16 v[48:51], v[148:151], v[40:43], v[48:51]
    ds_read_b64_tr_b16 v[28:29], v2 offset:53248
    ds_read_b64_tr_b16 v[30:31], v2 offset:53760
    v_mfma_f32_16x16x32_bf16 v[52:55], v[152:155], v[40:43], v[52:55]
    buffer_load_dwordx4 v14, s[56:59], s23 offen offset:1024 sc1 lds
    s_waitcnt lgkmcnt(4)
    v_mfma_f32_16x16x32_bf16 v[96:99], v[108:111], v[104:107], v[96:99]
    v_mfma_f32_16x16x32_bf16 v[56:59], v[156:159], v[40:43], v[56:59]
    v_mfma_f32_16x16x32_bf16 v[100:103], v[104:107], v[104:107], v[100:103]
    v_mfma_f32_16x16x32_bf16 v[60:63], v[148:151], v[44:47], v[60:63]
    ds_read_b64_tr_b16 v[32:33], v1 offset:57344
    ds_read_b64_tr_b16 v[34:35], v1 offset:57856
    v_mfma_f32_16x16x32_bf16 v[64:67], v[152:155], v[44:47], v[64:67]
    v_mfma_f32_16x16x32_bf16 v[68:71], v[156:159], v[44:47], v[68:71]
    buffer_load_dwordx4 v14, s[56:59], s23 offen offset:2048 sc1 lds
    v_mfma_f32_16x16x32_bf16 v[48:51], v[160:163], v[16:19], v[48:51]
    ds_read_b64_tr_b16 v[36:37], v2 offset:57344
    ds_read_b64_tr_b16 v[38:39], v2 offset:57856
    v_mfma_f32_16x16x32_bf16 v[52:55], v[164:167], v[16:19], v[52:55]
    v_mfma_f32_16x16x32_bf16 v[56:59], v[168:171], v[16:19], v[56:59]
    v_mfma_f32_16x16x32_bf16 v[60:63], v[160:163], v[20:23], v[60:63]
    ds_read_b64_tr_b16 v[40:41], v1 offset:61440
    ds_read_b64_tr_b16 v[42:43], v1 offset:61952
    v_mfma_f32_16x16x32_bf16 v[64:67], v[164:167], v[20:23], v[64:67]
    buffer_load_dwordx4 v14, s[56:59], s23 offen offset:3072 sc1 lds
    s_mov_b32 m0, s63
    v_mfma_f32_16x16x32_bf16 v[68:71], v[168:171], v[20:23], v[68:71]
    s_add_u32 s23, s23, 4096
    s_waitcnt lgkmcnt(8)
    v_mfma_f32_16x16x32_bf16 v[48:51], v[172:175], v[24:27], v[48:51]
    ds_read_b64_tr_b16 v[44:45], v2 offset:61440
    ds_read_b64_tr_b16 v[46:47], v2 offset:61952
    v_mfma_f32_16x16x32_bf16 v[52:55], a[224:227], v[24:27], v[52:55]
    buffer_load_dwordx4 v14, s[56:59], s23 offen sc1 lds
    s_add_u32 s23, s23, 1024
    s_add_u32 s63, s63, 36864
    s_mov_b32 m0, s63
    v_mfma_f32_16x16x32_bf16 v[56:59], a[228:231], v[24:27], v[56:59]
    s_add_u32 s63, s63, 4096
    s_waitcnt lgkmcnt(8)
    v_mfma_f32_16x16x32_bf16 v[60:63], v[172:175], v[28:31], v[60:63]
    s_waitcnt vmcnt(24)
    s_barrier
    v_add_u32 v1, 0x10000, v1
    ds_read_b64_tr_b16 v[16:17], v1 offset:0
    ds_read_b64_tr_b16 v[18:19], v1 offset:512
    v_mfma_f32_16x16x32_bf16 v[64:67], a[224:227], v[28:31], v[64:67]
    ds_read_b64_tr_b16 v[104:105], v7
    ds_read_b64_tr_b16 v[106:107], v7 offset:512
    v_mfma_f32_16x16x32_bf16 v[68:71], a[228:231], v[28:31], v[68:71]
    buffer_load_dwordx4 v14, s[56:59], s23 offen offset:0 sc1 lds
    v_add_u32 v7, 0x4000, v7
    s_waitcnt lgkmcnt(10)
    v_mfma_f32_16x16x32_bf16 v[48:51], a[232:235], v[32:35], v[48:51]
    v_add_u32 v2, 0x10000, v2
    ds_read_b64_tr_b16 v[20:21], v2 offset:0
    ds_read_b64_tr_b16 v[22:23], v2 offset:512
    v_mfma_f32_16x16x32_bf16 v[52:55], a[236:239], v[32:35], v[52:55]
    v_mfma_f32_16x16x32_bf16 v[56:59], a[240:243], v[32:35], v[56:59]
    s_waitcnt lgkmcnt(10)
    v_mfma_f32_16x16x32_bf16 v[60:63], a[232:235], v[36:39], v[60:63]
    ds_read_b64_tr_b16 v[24:25], v1 offset:4096
    ds_read_b64_tr_b16 v[26:27], v1 offset:4608
    v_mfma_f32_16x16x32_bf16 v[64:67], a[236:239], v[36:39], v[64:67]
    buffer_load_dwordx4 v14, s[56:59], s23 offen offset:1024 sc1 lds
    v_mfma_f32_16x16x32_bf16 v[68:71], a[240:243], v[36:39], v[68:71]
    s_waitcnt lgkmcnt(10)
    v_mfma_f32_16x16x32_bf16 v[48:51], a[244:247], v[40:43], v[48:51]
    ds_read_b64_tr_b16 v[28:29], v2 offset:4096
    ds_read_b64_tr_b16 v[30:31], v2 offset:4608
    v_mfma_f32_16x16x32_bf16 v[52:55], a[248:251], v[40:43], v[52:55]
    buffer_load_dwordx4 v14, s[56:59], s23 offen offset:2048 sc1 lds
    s_waitcnt lgkmcnt(6)
    v_mfma_f32_16x16x32_bf16 v[96:99], v[108:111], v[104:107], v[96:99]
    v_mfma_f32_16x16x32_bf16 v[56:59], a[252:255], v[40:43], v[56:59]
    v_mfma_f32_16x16x32_bf16 v[100:103], v[104:107], v[104:107], v[100:103]
    v_mfma_f32_16x16x32_bf16 v[60:63], a[244:247], v[44:47], v[60:63]
    ds_read_b64_tr_b16 v[32:33], v1 offset:8192
    ds_read_b64_tr_b16 v[34:35], v1 offset:8704
    v_mfma_f32_16x16x32_bf16 v[64:67], a[248:251], v[44:47], v[64:67]
    v_mfma_f32_16x16x32_bf16 v[68:71], a[252:255], v[44:47], v[68:71]
    buffer_load_dwordx4 v14, s[56:59], s23 offen offset:3072 sc1 lds
    s_mov_b32 m0, s63
    v_mfma_f32_16x16x32_bf16 v[48:51], a[64:67], v[16:19], v[48:51]
    ds_read_b64_tr_b16 v[36:37], v2 offset:8192
    ds_read_b64_tr_b16 v[38:39], v2 offset:8704
    v_mfma_f32_16x16x32_bf16 v[52:55], a[68:71], v[16:19], v[52:55]
    s_add_u32 s23, s23, 4096
    v_mfma_f32_16x16x32_bf16 v[56:59], a[72:75], v[16:19], v[56:59]
    s_waitcnt lgkmcnt(8)
    v_mfma_f32_16x16x32_bf16 v[60:63], a[64:67], v[20:23], v[60:63]
    ds_read_b64_tr_b16 v[40:41], v1 offset:12288
    ds_read_b64_tr_b16 v[42:43], v1 offset:12800
    v_mfma_f32_16x16x32_bf16 v[64:67], a[68:71], v[20:23], v[64:67]
    buffer_load_dwordx4 v14, s[56:59], s23 offen sc1 lds
    s_add_u32 s23, s23, 1024
    s_add_u32 s63, s63, 0
    s_mov_b32 m0, s29
    v_mfma_f32_16x16x32_bf16 v[68:71], a[72:75], v[20:23], v[68:71]
    s_add_u32 s29, s29, 4096
    s_waitcnt lgkmcnt(8)
    v_mfma_f32_16x16x32_bf16 v[48:51], a[76:79], v[24:27], v[48:51]
    ds_read_b64_tr_b16 v[44:45], v2 offset:12288
    ds_read_b64_tr_b16 v[46:47], v2 offset:12800
    v_mfma_f32_16x16x32_bf16 v[52:55], a[80:83], v[24:27], v[52:55]
    buffer_load_dwordx4 v14, s[56:59], s28 offen offset:0 sc1 lds
    v_mfma_f32_16x16x32_bf16 v[56:59], a[84:87], v[24:27], v[56:59]
    s_waitcnt lgkmcnt(8)
    v_mfma_f32_16x16x32_bf16 v[60:63], a[76:79], v[28:31], v[60:63]
    s_waitcnt vmcnt(26)
    s_barrier
    ds_read_b64_tr_b16 v[16:17], v1 offset:16384
    ds_read_b64_tr_b16 v[18:19], v1 offset:16896
    v_mfma_f32_16x16x32_bf16 v[64:67], a[80:83], v[28:31], v[64:67]
    ds_read_b64_tr_b16 v[104:105], v7
    ds_read_b64_tr_b16 v[106:107], v7 offset:512
    v_mfma_f32_16x16x32_bf16 v[68:71], a[84:87], v[28:31], v[68:71]
    buffer_load_dwordx4 v14, s[56:59], s28 offen offset:1024 sc1 lds
    v_add_u32 v7, 0x4000, v7
    s_waitcnt lgkmcnt(10)
    v_mfma_f32_16x16x32_bf16 v[48:51], a[88:91], v[32:35], v[48:51]
    ds_read_b64_tr_b16 v[20:21], v2 offset:16384
    ds_read_b64_tr_b16 v[22:23], v2 offset:16896
    v_mfma_f32_16x16x32_bf16 v[52:55], a[92:95], v[32:35], v[52:55]
    v_mfma_f32_16x16x32_bf16 v[56:59], a[192:195], v[32:35], v[56:59]
    s_waitcnt lgkmcnt(10)
    v_mfma_f32_16x16x32_bf16 v[60:63], a[88:91], v[36:39], v[60:63]
    ds_read_b64_tr_b16 v[24:25], v1 offset:20480
    ds_read_b64_tr_b16 v[26:27], v1 offset:20992
    v_mfma_f32_16x16x32_bf16 v[64:67], a[92:95], v[36:39], v[64:67]
    buffer_load_dwordx4 v14, s[56:59], s28 offen offset:2048 sc1 lds
    v_mfma_f32_16x16x32_bf16 v[68:71], a[192:195], v[36:39], v[68:71]
    s_waitcnt lgkmcnt(10)
    v_mfma_f32_16x16x32_bf16 v[48:51], a[196:199], v[40:43], v[48:51]
    ds_read_b64_tr_b16 v[28:29], v2 offset:20480
    ds_read_b64_tr_b16 v[30:31], v2 offset:20992
    v_mfma_f32_16x16x32_bf16 v[52:55], a[200:203], v[40:43], v[52:55]
    buffer_load_dwordx4 v14, s[56:59], s28 offen offset:3072 sc1 lds
    s_mov_b32 m0, s29
    v_mfma_f32_16x16x32_bf16 v[56:59], a[204:207], v[40:43], v[56:59]
    s_add_u32 s28, s28, 4096
    s_waitcnt lgkmcnt(6)
    v_mfma_f32_16x16x32_bf16 v[96:99], v[108:111], v[104:107], v[96:99]
    v_mfma_f32_16x16x32_bf16 v[100:103], v[104:107], v[104:107], v[100:103]
    v_mfma_f32_16x16x32_bf16 v[60:63], a[196:199], v[44:47], v[60:63]
    ds_read_b64_tr_b16 v[32:33], v1 offset:24576
    ds_read_b64_tr_b16 v[34:35], v1 offset:25088
    v_mfma_f32_16x16x32_bf16 v[64:67], a[200:203], v[44:47], v[64:67]
    v_mfma_f32_16x16x32_bf16 v[68:71], a[204:207], v[44:47], v[68:71]
    buffer_load_dwordx4 v14, s[56:59], s28 offen sc1 lds
    v_mfma_f32_16x16x32_bf16 v[48:51], a[208:211], v[16:19], v[48:51]
    ds_read_b64_tr_b16 v[36:37], v2 offset:24576
    ds_read_b64_tr_b16 v[38:39], v2 offset:25088
    v_mfma_f32_16x16x32_bf16 v[52:55], a[212:215], v[16:19], v[52:55]
    v_mfma_f32_16x16x32_bf16 v[56:59], a[216:219], v[16:19], v[56:59]
    s_waitcnt lgkmcnt(8)
    v_mfma_f32_16x16x32_bf16 v[60:63], a[208:211], v[20:23], v[60:63]
    ds_read_b64_tr_b16 v[40:41], v1 offset:28672
    ds_read_b64_tr_b16 v[42:43], v1 offset:29184
    v_mfma_f32_16x16x32_bf16 v[64:67], a[212:215], v[20:23], v[64:67]
    v_mfma_f32_16x16x32_bf16 v[68:71], a[216:219], v[20:23], v[68:71]
    s_waitcnt lgkmcnt(8)
    v_mfma_f32_16x16x32_bf16 v[48:51], a[220:223], v[24:27], v[48:51]
    ds_read_b64_tr_b16 v[44:45], v2 offset:28672
    ds_read_b64_tr_b16 v[46:47], v2 offset:29184
    v_mfma_f32_16x16x32_bf16 v[52:55], a[32:35], v[24:27], v[52:55]
    v_cndmask_b32 v100, v100, v101, s[36:37]
    v_cndmask_b32 v100, v100, v102, s[40:41]
    v_mfma_f32_16x16x32_bf16 v[56:59], a[36:39], v[24:27], v[56:59]
    v_cndmask_b32 v100, v100, v103, s[42:43]
    v_cndmask_b32 v100, v96, v100, s[34:35]
    s_waitcnt lgkmcnt(8)
    v_mfma_f32_16x16x32_bf16 v[60:63], a[220:223], v[28:31], v[60:63]
    ds_read_b64_tr_b16 v[16:17], v3 offset:16384
    ds_read_b64_tr_b16 v[18:19], v3 offset:16896
    v_mfma_f32_16x16x32_bf16 v[64:67], a[32:35], v[28:31], v[64:67]
    buffer_store_dword v100, v15, s[56:59], s62 offen sc1
    s_add_u32 s62, s62, 32768
    v_mfma_f32_16x16x32_bf16 v[68:71], a[36:39], v[28:31], v[68:71]
    s_waitcnt lgkmcnt(8)
    v_mfma_f32_16x16x32_bf16 v[48:51], a[40:43], v[32:35], v[48:51]
    ds_read_b64_tr_b16 v[20:21], v4 offset:16384
    ds_read_b64_tr_b16 v[22:23], v4 offset:16896
    v_mfma_f32_16x16x32_bf16 v[52:55], a[44:47], v[32:35], v[52:55]
    buffer_load_dword v12, v14, s[56:59], s22 offen sc1
    v_mfma_f32_16x16x32_bf16 v[56:59], a[48:51], v[32:35], v[56:59]
    s_waitcnt lgkmcnt(8)
    v_mfma_f32_16x16x32_bf16 v[60:63], a[40:43], v[36:39], v[60:63]
    ds_read_b64_tr_b16 v[24:25], v3 offset:20480
    ds_read_b64_tr_b16 v[26:27], v3 offset:20992
    v_mfma_f32_16x16x32_bf16 v[64:67], a[44:47], v[36:39], v[64:67]
    v_mfma_f32_16x16x32_bf16 v[68:71], a[48:51], v[36:39], v[68:71]
    s_waitcnt lgkmcnt(8)
    v_mfma_f32_16x16x32_bf16 v[48:51], a[52:55], v[40:43], v[48:51]
    ds_read_b64_tr_b16 v[28:29], v4 offset:20480
    ds_read_b64_tr_b16 v[30:31], v4 offset:20992
    v_mfma_f32_16x16x32_bf16 v[52:55], a[56:59], v[40:43], v[52:55]
    v_mfma_f32_16x16x32_bf16 v[56:59], a[60:63], v[40:43], v[56:59]
    s_waitcnt lgkmcnt(8)
    v_mfma_f32_16x16x32_bf16 v[60:63], a[52:55], v[44:47], v[60:63]
    ds_read_b64_tr_b16 v[32:33], v3 offset:24576
    ds_read_b64_tr_b16 v[34:35], v3 offset:25088
    v_mfma_f32_16x16x32_bf16 v[64:67], a[56:59], v[44:47], v[64:67]
    v_mfma_f32_16x16x32_bf16 v[68:71], a[60:63], v[44:47], v[68:71]
    s_waitcnt lgkmcnt(8)
    v_mfma_f32_16x16x32_bf16 v[72:75], v[208:211], v[16:19], 0
    ds_read_b64_tr_b16 v[36:37], v4 offset:24576
    ds_read_b64_tr_b16 v[38:39], v4 offset:25088
    v_mfma_f32_16x16x32_bf16 v[76:79], v[212:215], v[16:19], 0
    v_mfma_f32_16x16x32_bf16 v[80:83], v[216:219], v[16:19], 0
    s_waitcnt lgkmcnt(8)
    v_mfma_f32_16x16x32_bf16 v[84:87], v[208:211], v[20:23], 0
    ds_read_b64_tr_b16 v[40:41], v3 offset:28672
    ds_read_b64_tr_b16 v[42:43], v3 offset:29184
    v_mfma_f32_16x16x32_bf16 v[88:91], v[212:215], v[20:23], 0
    s_waitcnt vmcnt(0)
    v_cmp_ne_u32 vcc, s60, v12
    s_cbranch_vccz L_sequen_cd_24
L_sequen_pl_25:
    buffer_load_dword v12, v14, s[56:59], s22 offen sc1
    s_waitcnt vmcnt(0)
    v_cmp_ne_u32 vcc, s60, v12
    s_cbranch_vccz L_sequen_pd_26
    s_sub_u32 s61, s61, 1
    s_cbranch_scc0 L_sequen_pl_25
    s_mov_b32 s61, 0
L_sequen_pd_26:
L_sequen_cd_24:
    v_pk_mul_f32 v[48:49], v[48:49], v[52:53]
    v_mfma_f32_16x16x32_bf16 v[92:95], v[216:219], v[20:23], 0
    buffer_load_dwordx4 v[208:211], v14, s[56:59], s4 offen offset:0 sc1
    v_pk_mul_f32 v[60:61], v[60:61], v[64:65]
    s_waitcnt lgkmcnt(8)
    v_mfma_f32_16x16x32_bf16 v[72:75], v[220:223], v[24:27], v[72:75]
    ds_read_b64_tr_b16 v[44:45], v4 offset:28672
    ds_read_b64_tr_b16 v[46:47], v4 offset:29184
    v_mfma_f32_16x16x32_bf16 v[76:79], v[224:227], v[24:27], v[76:79]
    buffer_load_dwordx4 v[212:215], v14, s[56:59], s4 offen offset:1024 sc1
    v_pk_mul_f32 v[50:51], v[50:51], v[54:55]
    v_mfma_f32_16x16x32_bf16 v[80:83], v[228:231], v[24:27], v[80:83]
    v_pk_mul_f32 v[62:63], v[62:63], v[66:67]
    v_permlane32_swap_b32 v56, v58
    s_waitcnt lgkmcnt(8)
    v_mfma_f32_16x16x32_bf16 v[84:87], v[220:223], v[28:31], v[84:87]
    ds_read_b64_tr_b16 v[16:17], v3 offset:32768
    ds_read_b64_tr_b16 v[18:19], v3 offset:33280
    v_mfma_f32_16x16x32_bf16 v[88:91], v[224:227], v[28:31], v[88:91]
    v_permlane32_swap_b32 v68, v70
    v_permlane32_swap_b32 v57, v59
    v_mfma_f32_16x16x32_bf16 v[92:95], v[228:231], v[28:31], v[92:95]
    buffer_load_dwordx4 v[216:219], v14, s[56:59], s4 offen offset:2048 sc1
    v_permlane32_swap_b32 v69, v71
    s_waitcnt lgkmcnt(8)
    v_mfma_f32_16x16x32_bf16 v[72:75], v[232:235], v[32:35], v[72:75]
    ds_read_b64_tr_b16 v[20:21], v4 offset:32768
    ds_read_b64_tr_b16 v[22:23], v4 offset:33280
    v_mfma_f32_16x16x32_bf16 v[76:79], v[236:239], v[32:35], v[76:79]
    v_cvt_pk_bf16_f32 v52, v48, v49
    v_cvt_pk_bf16_f32 v64, v60, v61
    v_mfma_f32_16x16x32_bf16 v[80:83], v[240:243], v[32:35], v[80:83]
    v_cvt_pk_bf16_f32 v53, v50, v51
    v_cvt_pk_bf16_f32 v65, v62, v63
    s_waitcnt lgkmcnt(8)
    v_mfma_f32_16x16x32_bf16 v[84:87], v[232:235], v[36:39], v[84:87]
    ds_read_b64_tr_b16 v[24:25], v3 offset:36864
    ds_read_b64_tr_b16 v[26:27], v3 offset:37376
    v_mfma_f32_16x16x32_bf16 v[88:91], v[236:239], v[36:39], v[88:91]
    buffer_load_dwordx4 v[220:223], v14, s[56:59], s4 offen offset:3072 sc1
    v_pk_mul_f32 v[56:57], v[56:57], v[58:59]
    v_mfma_f32_16x16x32_bf16 v[92:95], v[240:243], v[36:39], v[92:95]
    v_pk_mul_f32 v[68:69], v[68:69], v[70:71]
    v_cvt_pk_bf16_f32 v54, v56, v57
    s_waitcnt lgkmcnt(8)
    v_mfma_f32_16x16x32_bf16 v[72:75], v[244:247], v[40:43], v[72:75]
    ds_read_b64_tr_b16 v[28:29], v4 offset:36864
    ds_read_b64_tr_b16 v[30:31], v4 offset:37376
    v_mfma_f32_16x16x32_bf16 v[76:79], v[248:251], v[40:43], v[76:79]
    buffer_load_dwordx4 v[224:227], v14, s[56:59], s5 offen offset:0 sc1
    v_cvt_pk_bf16_f32 v66, v68, v69
    v_mfma_f32_16x16x32_bf16 v[80:83], v[252:255], v[40:43], v[80:83]
    v_permlane16_swap_b32 v52, v53
    v_permlane16_swap_b32 v64, v65
    s_waitcnt lgkmcnt(8)
    v_mfma_f32_16x16x32_bf16 v[84:87], v[244:247], v[44:47], v[84:87]
    ds_read_b64_tr_b16 v[32:33], v3 offset:40960
    ds_read_b64_tr_b16 v[34:35], v3 offset:41472
    v_mfma_f32_16x16x32_bf16 v[88:91], v[248:251], v[44:47], v[88:91]
    v_permlane16_swap_b32 v54, v55
    v_permlane16_swap_b32 v66, v67
    v_mfma_f32_16x16x32_bf16 v[92:95], v[252:255], v[44:47], v[92:95]
    buffer_load_dwordx4 v[228:231], v14, s[56:59], s5 offen offset:1024 sc1
    v_permlane32_swap_b32 v52, v54
    s_waitcnt lgkmcnt(8)
    v_mfma_f32_16x16x32_bf16 v[72:75], v[112:115], v[16:19], v[72:75]
    ds_read_b64_tr_b16 v[36:37], v4 offset:40960
    ds_read_b64_tr_b16 v[38:39], v4 offset:41472
    v_mfma_f32_16x16x32_bf16 v[76:79], v[116:119], v[16:19], v[76:79]
    v_permlane32_swap_b32 v64, v66
    v_permlane32_swap_b32 v53, v55
    v_mfma_f32_16x16x32_bf16 v[80:83], v[120:123], v[16:19], v[80:83]
    v_permlane32_swap_b32 v65, v67
    s_waitcnt lgkmcnt(8)
    v_mfma_f32_16x16x32_bf16 v[84:87], v[112:115], v[20:23], v[84:87]
    ds_read_b64_tr_b16 v[40:41], v3 offset:45056
    ds_read_b64_tr_b16 v[42:43], v3 offset:45568
    v_mfma_f32_16x16x32_bf16 v[88:91], v[116:119], v[20:23], v[88:91]
    buffer_store_dwordx4 v[52:55], v8, s[56:59], s52 offen sc1
    s_add_u32 s52, s52, 49152
    v_mfma_f32_16x16x32_bf16 v[92:95], v[120:123], v[20:23], v[92:95]
    s_waitcnt lgkmcnt(8)
    v_mfma_f32_16x16x32_bf16 v[72:75], v[124:127], v[24:27], v[72:75]
    ds_read_b64_tr_b16 v[44:45], v4 offset:45056
    ds_read_b64_tr_b16 v[46:47], v4 offset:45568
    v_mfma_f32_16x16x32_bf16 v[76:79], v[128:131], v[24:27], v[76:79]
    buffer_store_dwordx4 v[64:67], v8, s[56:59], s52 offen sc1
    s_add_u32 s52, s52, 49152
    v_mfma_f32_16x16x32_bf16 v[80:83], v[132:135], v[24:27], v[80:83]
    s_waitcnt lgkmcnt(8)
    v_mfma_f32_16x16x32_bf16 v[84:87], v[124:127], v[28:31], v[84:87]
    ds_read_b64_tr_b16 v[16:17], v3 offset:49152
    ds_read_b64_tr_b16 v[18:19], v3 offset:49664
    v_mfma_f32_16x16x32_bf16 v[88:91], v[128:131], v[28:31], v[88:91]
    v_mfma_f32_16x16x32_bf16 v[92:95], v[132:135], v[28:31], v[92:95]
    buffer_load_dwordx2 v[68:69], v13, s[56:59], s24 offen sc1
    s_waitcnt lgkmcnt(8)
    v_mfma_f32_16x16x32_bf16 v[72:75], v[136:139], v[32:35], v[72:75]
    ds_read_b64_tr_b16 v[20:21], v4 offset:49152
    ds_read_b64_tr_b16 v[22:23], v4 offset:49664
    v_mfma_f32_16x16x32_bf16 v[76:79], v[140:143], v[32:35], v[76:79]
    buffer_load_dwordx2 v[70:71], v13, s[56:59], s25 offen sc1
    v_mfma_f32_16x16x32_bf16 v[80:83], v[144:147], v[32:35], v[80:83]
    s_waitcnt lgkmcnt(8)
    v_mfma_f32_16x16x32_bf16 v[84:87], v[136:139], v[36:39], v[84:87]
    ds_read_b64_tr_b16 v[24:25], v3 offset:53248
    ds_read_b64_tr_b16 v[26:27], v3 offset:53760
    v_mfma_f32_16x16x32_bf16 v[88:91], v[140:143], v[36:39], v[88:91]
    buffer_load_dwordx4 v[232:235], v14, s[56:59], s5 offen offset:2048 sc1
    v_mfma_f32_16x16x32_bf16 v[92:95], v[144:147], v[36:39], v[92:95]
    s_waitcnt lgkmcnt(8)
    v_mfma_f32_16x16x32_bf16 v[72:75], v[148:151], v[40:43], v[72:75]
    ds_read_b64_tr_b16 v[28:29], v4 offset:53248
    ds_read_b64_tr_b16 v[30:31], v4 offset:53760
    v_mfma_f32_16x16x32_bf16 v[76:79], v[152:155], v[40:43], v[76:79]
    buffer_load_dwordx4 v[236:239], v14, s[56:59], s5 offen offset:3072 sc1
    v_mfma_f32_16x16x32_bf16 v[80:83], v[156:159], v[40:43], v[80:83]
    s_waitcnt lgkmcnt(8)
    v_mfma_f32_16x16x32_bf16 v[84:87], v[148:151], v[44:47], v[84:87]
    ds_read_b64_tr_b16 v[32:33], v3 offset:57344
    ds_read_b64_tr_b16 v[34:35], v3 offset:57856
    v_mfma_f32_16x16x32_bf16 v[88:91], v[152:155], v[44:47], v[88:91]
    v_mfma_f32_16x16x32_bf16 v[92:95], v[156:159], v[44:47], v[92:95]
    buffer_load_dwordx4 v[240:243], v14, s[56:59], s6 offen offset:0 sc1
    s_waitcnt lgkmcnt(8)
    v_mfma_f32_16x16x32_bf16 v[72:75], v[160:163], v[16:19], v[72:75]
    ds_read_b64_tr_b16 v[36:37], v4 offset:57344
    ds_read_b64_tr_b16 v[38:39], v4 offset:57856
    v_mfma_f32_16x16x32_bf16 v[76:79], v[164:167], v[16:19], v[76:79]
    v_mfma_f32_16x16x32_bf16 v[80:83], v[168:171], v[16:19], v[80:83]
    s_waitcnt lgkmcnt(8)
    v_mfma_f32_16x16x32_bf16 v[84:87], v[160:163], v[20:23], v[84:87]
    ds_read_b64_tr_b16 v[40:41], v3 offset:61440
    ds_read_b64_tr_b16 v[42:43], v3 offset:61952
    v_mfma_f32_16x16x32_bf16 v[88:91], v[164:167], v[20:23], v[88:91]
    buffer_load_dwordx4 v[244:247], v14, s[56:59], s6 offen offset:1024 sc1
    v_mfma_f32_16x16x32_bf16 v[92:95], v[168:171], v[20:23], v[92:95]
    s_waitcnt lgkmcnt(8)
    v_mfma_f32_16x16x32_bf16 v[72:75], v[172:175], v[24:27], v[72:75]
    ds_read_b64_tr_b16 v[44:45], v4 offset:61440
    ds_read_b64_tr_b16 v[46:47], v4 offset:61952
    v_mfma_f32_16x16x32_bf16 v[76:79], a[224:227], v[24:27], v[76:79]
    buffer_load_dwordx4 v[248:251], v14, s[56:59], s6 offen offset:2048 sc1
    v_mfma_f32_16x16x32_bf16 v[80:83], a[228:231], v[24:27], v[80:83]
    s_waitcnt lgkmcnt(8)
    v_mfma_f32_16x16x32_bf16 v[84:87], v[172:175], v[28:31], v[84:87]
    v_add_u32 v3, 0x10000, v3
    ds_read_b64_tr_b16 v[16:17], v3 offset:0
    ds_read_b64_tr_b16 v[18:19], v3 offset:512
    v_mfma_f32_16x16x32_bf16 v[88:91], a[224:227], v[28:31], v[88:91]
    v_mfma_f32_16x16x32_bf16 v[92:95], a[228:231], v[28:31], v[92:95]
    buffer_load_dwordx4 v[252:255], v14, s[56:59], s6 offen offset:3072 sc1
    s_waitcnt lgkmcnt(8)
    v_mfma_f32_16x16x32_bf16 v[72:75], a[232:235], v[32:35], v[72:75]
    v_add_u32 v4, 0x10000, v4
    ds_read_b64_tr_b16 v[20:21], v4 offset:0
    ds_read_b64_tr_b16 v[22:23], v4 offset:512
    v_mfma_f32_16x16x32_bf16 v[76:79], a[236:239], v[32:35], v[76:79]
    v_mfma_f32_16x16x32_bf16 v[80:83], a[240:243], v[32:35], v[80:83]
    s_waitcnt lgkmcnt(8)
    v_mfma_f32_16x16x32_bf16 v[84:87], a[232:235], v[36:39], v[84:87]
    ds_read_b64_tr_b16 v[24:25], v3 offset:4096
    ds_read_b64_tr_b16 v[26:27], v3 offset:4608
    v_mfma_f32_16x16x32_bf16 v[88:91], a[236:239], v[36:39], v[88:91]
    buffer_load_dwordx4 v[112:115], v14, s[56:59], s53 offen offset:0 sc1
    v_mfma_f32_16x16x32_bf16 v[92:95], a[240:243], v[36:39], v[92:95]
    s_waitcnt lgkmcnt(8)
    v_mfma_f32_16x16x32_bf16 v[72:75], a[244:247], v[40:43], v[72:75]
    ds_read_b64_tr_b16 v[28:29], v4 offset:4096
    ds_read_b64_tr_b16 v[30:31], v4 offset:4608
    v_mfma_f32_16x16x32_bf16 v[76:79], a[248:251], v[40:43], v[76:79]
    buffer_load_dwordx4 v[116:119], v14, s[56:59], s53 offen offset:1024 sc1
    v_mfma_f32_16x16x32_bf16 v[80:83], a[252:255], v[40:43], v[80:83]
    s_waitcnt lgkmcnt(8)
    v_mfma_f32_16x16x32_bf16 v[84:87], a[244:247], v[44:47], v[84:87]
    ds_read_b64_tr_b16 v[32:33], v3 offset:8192
    ds_read_b64_tr_b16 v[34:35], v3 offset:8704
    v_mfma_f32_16x16x32_bf16 v[88:91], a[248:251], v[44:47], v[88:91]
    v_mfma_f32_16x16x32_bf16 v[92:95], a[252:255], v[44:47], v[92:95]
    buffer_load_dwordx4 v[120:123], v14, s[56:59], s53 offen offset:2048 sc1
    s_waitcnt lgkmcnt(8)
    v_mfma_f32_16x16x32_bf16 v[72:75], a[64:67], v[16:19], v[72:75]
    ds_read_b64_tr_b16 v[36:37], v4 offset:8192
    ds_read_b64_tr_b16 v[38:39], v4 offset:8704
    v_mfma_f32_16x16x32_bf16 v[76:79], a[68:71], v[16:19], v[76:79]
    v_mfma_f32_16x16x32_bf16 v[80:83], a[72:75], v[16:19], v[80:83]
    s_waitcnt lgkmcnt(8)
    v_mfma_f32_16x16x32_bf16 v[84:87], a[64:67], v[20:23], v[84:87]
    ds_read_b64_tr_b16 v[40:41], v3 offset:12288
    ds_read_b64_tr_b16 v[42:43], v3 offset:12800
    v_mfma_f32_16x16x32_bf16 v[88:91], a[68:71], v[20:23], v[88:91]
    buffer_load_dwordx4 v[124:127], v14, s[56:59], s53 offen offset:3072 sc1
    s_add_u32 s53, s53, 4096
    v_mfma_f32_16x16x32_bf16 v[92:95], a[72:75], v[20:23], v[92:95]
    s_waitcnt lgkmcnt(8)
    v_mfma_f32_16x16x32_bf16 v[72:75], a[76:79], v[24:27], v[72:75]
    ds_read_b64_tr_b16 v[44:45], v4 offset:12288
    ds_read_b64_tr_b16 v[46:47], v4 offset:12800
    v_mfma_f32_16x16x32_bf16 v[76:79], a[80:83], v[24:27], v[76:79]
    buffer_load_dwordx4 v[128:131], v14, s[56:59], s53 offen offset:0 sc1
    v_mfma_f32_16x16x32_bf16 v[80:83], a[84:87], v[24:27], v[80:83]
    s_waitcnt lgkmcnt(8)
    v_mfma_f32_16x16x32_bf16 v[84:87], a[76:79], v[28:31], v[84:87]
    ds_read_b64_tr_b16 v[16:17], v3 offset:16384
    ds_read_b64_tr_b16 v[18:19], v3 offset:16896
    v_mfma_f32_16x16x32_bf16 v[88:91], a[80:83], v[28:31], v[88:91]
    v_mfma_f32_16x16x32_bf16 v[92:95], a[84:87], v[28:31], v[92:95]
    buffer_load_dwordx4 a[240:243], v14, s[56:59], s7 offen offset:0 sc1
    s_waitcnt lgkmcnt(8)
    v_mfma_f32_16x16x32_bf16 v[72:75], a[88:91], v[32:35], v[72:75]
    ds_read_b64_tr_b16 v[20:21], v4 offset:16384
    ds_read_b64_tr_b16 v[22:23], v4 offset:16896
    v_mfma_f32_16x16x32_bf16 v[76:79], a[92:95], v[32:35], v[76:79]
    v_mfma_f32_16x16x32_bf16 v[80:83], a[192:195], v[32:35], v[80:83]
    s_waitcnt lgkmcnt(8)
    v_mfma_f32_16x16x32_bf16 v[84:87], a[88:91], v[36:39], v[84:87]
    ds_read_b64_tr_b16 v[24:25], v3 offset:20480
    ds_read_b64_tr_b16 v[26:27], v3 offset:20992
    v_mfma_f32_16x16x32_bf16 v[88:91], a[92:95], v[36:39], v[88:91]
    buffer_load_dwordx4 a[244:247], v14, s[56:59], s7 offen offset:1024 sc1
    v_mfma_f32_16x16x32_bf16 v[92:95], a[192:195], v[36:39], v[92:95]
    s_waitcnt lgkmcnt(8)
    v_mfma_f32_16x16x32_bf16 v[72:75], a[196:199], v[40:43], v[72:75]
    ds_read_b64_tr_b16 v[28:29], v4 offset:20480
    ds_read_b64_tr_b16 v[30:31], v4 offset:20992
    v_mfma_f32_16x16x32_bf16 v[76:79], a[200:203], v[40:43], v[76:79]
    buffer_load_dwordx4 a[248:251], v14, s[56:59], s7 offen offset:2048 sc1
    v_mfma_f32_16x16x32_bf16 v[80:83], a[204:207], v[40:43], v[80:83]
    s_waitcnt lgkmcnt(8)
    v_mfma_f32_16x16x32_bf16 v[84:87], a[196:199], v[44:47], v[84:87]
    ds_read_b64_tr_b16 v[32:33], v3 offset:24576
    ds_read_b64_tr_b16 v[34:35], v3 offset:25088
    v_mfma_f32_16x16x32_bf16 v[88:91], a[200:203], v[44:47], v[88:91]
    v_mfma_f32_16x16x32_bf16 v[92:95], a[204:207], v[44:47], v[92:95]
    buffer_load_dwordx4 a[252:255], v14, s[56:59], s7 offen offset:3072 sc1
    s_waitcnt lgkmcnt(8)
    v_mfma_f32_16x16x32_bf16 v[72:75], a[208:211], v[16:19], v[72:75]
    ds_read_b64_tr_b16 v[36:37], v4 offset:24576
    ds_read_b64_tr_b16 v[38:39], v4 offset:25088
    v_mfma_f32_16x16x32_bf16 v[76:79], a[212:215], v[16:19], v[76:79]
    v_mfma_f32_16x16x32_bf16 v[80:83], a[216:219], v[16:19], v[80:83]
    s_waitcnt lgkmcnt(8)
    v_mfma_f32_16x16x32_bf16 v[84:87], a[208:211], v[20:23], v[84:87]
    ds_read_b64_tr_b16 v[40:41], v3 offset:28672
    ds_read_b64_tr_b16 v[42:43], v3 offset:29184
    v_mfma_f32_16x16x32_bf16 v[88:91], a[212:215], v[20:23], v[88:91]
    buffer_load_dwordx4 a[64:67], v14, s[56:59], s8 offen offset:0 sc1
    v_mfma_f32_16x16x32_bf16 v[92:95], a[216:219], v[20:23], v[92:95]
    s_waitcnt lgkmcnt(8)
    v_mfma_f32_16x16x32_bf16 v[72:75], a[220:223], v[24:27], v[72:75]
    ds_read_b64_tr_b16 v[44:45], v4 offset:28672
    ds_read_b64_tr_b16 v[46:47], v4 offset:29184
    v_mfma_f32_16x16x32_bf16 v[76:79], a[32:35], v[24:27], v[76:79]
    buffer_load_dwordx4 a[68:71], v14, s[56:59], s8 offen offset:1024 sc1
    v_mfma_f32_16x16x32_bf16 v[80:83], a[36:39], v[24:27], v[80:83]
    s_waitcnt lgkmcnt(8)
    v_mfma_f32_16x16x32_bf16 v[84:87], a[220:223], v[28:31], v[84:87]
    v_mfma_f32_16x16x32_bf16 v[88:91], a[32:35], v[28:31], v[88:91]
    v_mfma_f32_16x16x32_bf16 v[92:95], a[36:39], v[28:31], v[92:95]
    buffer_load_dwordx4 a[72:75], v14, s[56:59], s8 offen offset:2048 sc1
    s_waitcnt lgkmcnt(6)
    v_mfma_f32_16x16x32_bf16 v[72:75], a[40:43], v[32:35], v[72:75]
    v_mfma_f32_16x16x32_bf16 v[76:79], a[44:47], v[32:35], v[76:79]
    v_mfma_f32_16x16x32_bf16 v[80:83], a[48:51], v[32:35], v[80:83]
    s_waitcnt lgkmcnt(4)
    v_mfma_f32_16x16x32_bf16 v[84:87], a[40:43], v[36:39], v[84:87]
    buffer_load_dwordx4 a[76:79], v14, s[56:59], s8 offen offset:3072 sc1
    v_mfma_f32_16x16x32_bf16 v[88:91], a[44:47], v[36:39], v[88:91]
    v_mfma_f32_16x16x32_bf16 v[92:95], a[48:51], v[36:39], v[92:95]
    s_waitcnt lgkmcnt(2)
    v_mfma_f32_16x16x32_bf16 v[72:75], a[52:55], v[40:43], v[72:75]
    v_mfma_f32_16x16x32_bf16 v[76:79], a[56:59], v[40:43], v[76:79]
    buffer_load_dwordx4 a[80:83], v14, s[56:59], s9 offen offset:0 sc1
    v_mfma_f32_16x16x32_bf16 v[80:83], a[60:63], v[40:43], v[80:83]
    s_waitcnt lgkmcnt(0)
    v_mfma_f32_16x16x32_bf16 v[84:87], a[52:55], v[44:47], v[84:87]
    v_mfma_f32_16x16x32_bf16 v[88:91], a[56:59], v[44:47], v[88:91]
    v_mfma_f32_16x16x32_bf16 v[92:95], a[60:63], v[44:47], v[92:95]
    buffer_load_dwordx4 a[84:87], v14, s[56:59], s9 offen offset:1024 sc1
    s_nop 7
    v_pk_mul_f32 v[72:73], v[72:73], v[76:77]
    v_pk_mul_f32 v[84:85], v[84:85], v[88:89]
    v_pk_mul_f32 v[74:75], v[74:75], v[78:79]
    v_pk_mul_f32 v[86:87], v[86:87], v[90:91]
    v_permlane32_swap_b32 v80, v82
    v_permlane32_swap_b32 v92, v94
    v_permlane32_swap_b32 v81, v83
    v_permlane32_swap_b32 v93, v95
    v_cvt_pk_bf16_f32 v76, v72, v73
    v_cvt_pk_bf16_f32 v88, v84, v85
    v_cvt_pk_bf16_f32 v77, v74, v75
    v_cvt_pk_bf16_f32 v89, v86, v87
    v_pk_mul_f32 v[80:81], v[80:81], v[82:83]
    v_pk_mul_f32 v[92:93], v[92:93], v[94:95]
    v_cvt_pk_bf16_f32 v78, v80, v81
    v_cvt_pk_bf16_f32 v90, v92, v93
    v_permlane16_swap_b32 v76, v77
    v_permlane16_swap_b32 v88, v89
    v_permlane16_swap_b32 v78, v79
    v_permlane16_swap_b32 v90, v91
    s_nop 0
    v_permlane32_swap_b32 v76, v78
    v_permlane32_swap_b32 v88, v90
    v_permlane32_swap_b32 v77, v79
    v_permlane32_swap_b32 v89, v91
    buffer_store_dwordx4 v[76:79], v8, s[56:59], s52 offen sc1
    s_add_u32 s52, s52, 49152
    buffer_store_dwordx4 v[88:91], v8, s[56:59], s52 offen sc1
    s_add_u32 s52, s52, 49152
    v_add_u32 v7, 61440, v10
    s_waitcnt vmcnt(32)
    v_mfma_f32_16x16x32_bf16 v[48:51], a[160:163], v[208:211], 0
    ds_read_b128 v[132:135], v10 offset:0
    ds_read_b128 v[136:139], v10 offset:1024
    v_mfma_f32_16x16x32_bf16 v[52:55], a[164:167], v[208:211], 0
    v_mfma_f32_16x16x32_bf16 v[56:59], a[168:171], v[208:211], 0
    ds_read_b128 v[140:143], v10 offset:2048
    s_waitcnt vmcnt(24)
    v_cmp_u_f32 vcc, v68, v69
    s_cbranch_vccnz FZ_RL0
FZ_RB0:
    v_mfma_f32_16x16x32_bf16 v[60:63], a[172:175], v[208:211], 0
    v_permlane16_swap_b32 v68, v69
    v_add_f32 v68, v68, v69
    v_mfma_f32_16x16x32_bf16 v[64:67], a[176:179], v[208:211], 0
    ds_read_b128 v[144:147], v10 offset:3072
    v_mov_b32 v69, v68
    v_mfma_f32_16x16x32_bf16 v[48:51], a[180:183], v[212:215], v[48:51]
    s_nop 1
    v_permlane32_swap_b32 v68, v69
    v_mfma_f32_16x16x32_bf16 v[52:55], a[184:187], v[212:215], v[52:55]
    ds_read_b128 v[148:151], v10 offset:4096
    v_add_f32 v68, v68, v69
    v_mfma_f32_16x16x32_bf16 v[56:59], a[188:191], v[212:215], v[56:59]
    v_mov_b32 v69, v68
    s_nop 1
    v_mfma_f32_16x16x32_bf16 v[60:63], a[0:3], v[212:215], v[60:63]
    ds_read_b128 v[152:155], v10 offset:20480
    v_permlane16_swap_b32 v68, v69
    v_mfma_f32_16x16x32_bf16 v[64:67], a[4:7], v[212:215], v[64:67]
    v_mul_f32 v68, 0x3acccccd, v68
    v_mul_f32 v69, 0x3acccccd, v69
    v_mfma_f32_16x16x32_bf16 v[48:51], a[8:11], v[216:219], v[48:51]
    ds_read_b128 v[156:159], v10 offset:21504
    v_fma_f32 v69, -v68, v68, v69
    v_mfma_f32_16x16x32_bf16 v[52:55], a[12:15], v[216:219], v[52:55]
    buffer_load_dwordx4 a[88:91], v14, s[56:59], s9 offen offset:2048 sc1
    v_max_f32 v69, 0, v69
    v_mfma_f32_16x16x32_bf16 v[56:59], a[16:19], v[216:219], v[56:59]
    ds_read_b128 v[160:163], v10 offset:22528
    v_add_f32 v69, 0x3727c5ac, v69
    v_mfma_f32_16x16x32_bf16 v[60:63], a[20:23], v[216:219], v[60:63]
    v_rcp_f32 v68, v69
    s_nop 0
    v_mfma_f32_16x16x32_bf16 v[64:67], a[24:27], v[216:219], v[64:67]
    ds_read_b128 v[164:167], v10 offset:23552
    v_mov_b32 v69, v68
    v_mfma_f32_16x16x32_bf16 v[48:51], a[28:31], v[220:223], v[48:51]
    buffer_load_dwordx4 a[92:95], v14, s[56:59], s9 offen offset:3072 sc1
    v_mfma_f32_16x16x32_bf16 v[52:55], a[96:99], v[220:223], v[52:55]
    ds_read_b128 v[168:171], v10 offset:24576
    v_mfma_f32_16x16x32_bf16 v[56:59], a[100:103], v[220:223], v[56:59]
    v_mfma_f32_16x16x32_bf16 v[60:63], a[104:107], v[220:223], v[60:63]
    ds_read_b128 v[172:175], v7 offset:0
    v_mfma_f32_16x16x32_bf16 v[64:67], a[108:111], v[220:223], v[64:67]
    buffer_load_dwordx2 v[92:93], v13, s[56:59], s26 offen sc1
    v_mfma_f32_16x16x32_bf16 v[48:51], a[112:115], v[224:227], v[48:51]
    ds_read_b128 a[224:227], v7 offset:1024
    v_mfma_f32_16x16x32_bf16 v[52:55], a[116:119], v[224:227], v[52:55]
    buffer_load_dwordx2 v[94:95], v13, s[56:59], s27 offen sc1
    v_mfma_f32_16x16x32_bf16 v[56:59], a[120:123], v[224:227], v[56:59]
    ds_read_b128 a[228:231], v7 offset:2048
    v_mfma_f32_16x16x32_bf16 v[60:63], a[124:127], v[224:227], v[60:63]
    buffer_load_dwordx4 a[192:195], v14, s[56:59], s10 offen offset:0 sc1
    v_mfma_f32_16x16x32_bf16 v[64:67], a[128:131], v[224:227], v[64:67]
    ds_read_b128 a[232:235], v7 offset:3072
    v_mfma_f32_16x16x32_bf16 v[48:51], a[132:135], v[228:231], v[48:51]
    v_mfma_f32_16x16x32_bf16 v[52:55], a[136:139], v[228:231], v[52:55]
    ds_read_b128 a[236:239], v7 offset:4096
    v_mfma_f32_16x16x32_bf16 v[56:59], a[140:143], v[228:231], v[56:59]
    buffer_load_dwordx4 a[196:199], v14, s[56:59], s10 offen offset:1024 sc1
    v_mfma_f32_16x16x32_bf16 v[60:63], a[144:147], v[228:231], v[60:63]
    v_mfma_f32_16x16x32_bf16 v[64:67], a[148:151], v[228:231], v[64:67]
    s_waitcnt vmcnt(28)
    v_mfma_f32_16x16x32_bf16 v[48:51], a[152:155], v[232:235], v[48:51]
    v_mfma_f32_16x16x32_bf16 v[52:55], a[156:159], v[232:235], v[52:55]
    buffer_load_dwordx4 a[200:203], v14, s[56:59], s10 offen offset:2048 sc1
    v_mfma_f32_16x16x32_bf16 v[56:59], v[176:179], v[232:235], v[56:59]
    v_mfma_f32_16x16x32_bf16 v[60:63], v[180:183], v[232:235], v[60:63]
    v_mfma_f32_16x16x32_bf16 v[64:67], v[184:187], v[232:235], v[64:67]
    s_waitcnt vmcnt(28)
    v_mfma_f32_16x16x32_bf16 v[48:51], v[188:191], v[236:239], v[48:51]
    buffer_load_dwordx4 a[204:207], v14, s[56:59], s10 offen offset:3072 sc1
    v_mfma_f32_16x16x32_bf16 v[52:55], v[192:195], v[236:239], v[52:55]
    v_mfma_f32_16x16x32_bf16 v[56:59], v[196:199], v[236:239], v[56:59]
    v_mfma_f32_16x16x32_bf16 v[60:63], v[200:203], v[236:239], v[60:63]
    v_mfma_f32_16x16x32_bf16 v[64:67], v[204:207], v[236:239], v[64:67]
    buffer_load_dwordx4 a[208:211], v14, s[56:59], s11 offen offset:0 sc1
    s_waitcnt vmcnt(29)
    s_waitcnt vmcnt(25)
    v_mfma_f32_16x16x32_bf16 v[48:51], v[112:115], v[240:243], v[48:51]
    s_waitcnt vmcnt(24)
    v_mfma_f32_16x16x32_bf16 v[52:55], v[116:119], v[240:243], v[52:55]
    s_waitcnt vmcnt(23)
    v_mfma_f32_16x16x32_bf16 v[56:59], v[120:123], v[240:243], v[56:59]
    s_waitcnt vmcnt(22)
    v_mfma_f32_16x16x32_bf16 v[60:63], v[124:127], v[240:243], v[60:63]
    buffer_load_dwordx4 a[212:215], v14, s[56:59], s11 offen offset:1024 sc1
    s_waitcnt vmcnt(22)
    v_mfma_f32_16x16x32_bf16 v[64:67], v[128:131], v[240:243], v[64:67]
    s_waitcnt lgkmcnt(14)
    v_mfma_f32_16x16x32_bf16 v[48:51], v[132:135], v[244:247], v[48:51]
    s_waitcnt lgkmcnt(13)
    v_mfma_f32_16x16x32_bf16 v[52:55], v[136:139], v[244:247], v[52:55]
    s_waitcnt lgkmcnt(12)
    v_mfma_f32_16x16x32_bf16 v[56:59], v[140:143], v[244:247], v[56:59]
    buffer_load_dwordx4 a[216:219], v14, s[56:59], s11 offen offset:2048 sc1
    s_waitcnt lgkmcnt(11)
    v_mfma_f32_16x16x32_bf16 v[60:63], v[144:147], v[244:247], v[60:63]
    s_waitcnt lgkmcnt(10)
    v_mfma_f32_16x16x32_bf16 v[64:67], v[148:151], v[244:247], v[64:67]
    s_waitcnt lgkmcnt(9)
    v_mfma_f32_16x16x32_bf16 v[48:51], v[152:155], v[248:251], v[48:51]
    s_waitcnt lgkmcnt(8)
    v_mfma_f32_16x16x32_bf16 v[52:55], v[156:159], v[248:251], v[52:55]
    buffer_load_dwordx4 a[220:223], v14, s[56:59], s11 offen offset:3072 sc1
    s_waitcnt lgkmcnt(7)
    v_mfma_f32_16x16x32_bf16 v[56:59], v[160:163], v[248:251], v[56:59]
    s_waitcnt lgkmcnt(6)
    v_mfma_f32_16x16x32_bf16 v[60:63], v[164:167], v[248:251], v[60:63]
    s_waitcnt lgkmcnt(5)
    v_mfma_f32_16x16x32_bf16 v[64:67], v[168:171], v[248:251], v[64:67]
    s_waitcnt lgkmcnt(4)
    v_mfma_f32_16x16x32_bf16 v[48:51], v[172:175], v[252:255], v[48:51]
    buffer_load_dwordx4 a[32:35], v14, s[56:59], s12 offen offset:0 sc1
    s_waitcnt lgkmcnt(3)
    v_mfma_f32_16x16x32_bf16 v[52:55], a[224:227], v[252:255], v[52:55]
    s_waitcnt lgkmcnt(2)
    v_mfma_f32_16x16x32_bf16 v[56:59], a[228:231], v[252:255], v[56:59]
    s_waitcnt lgkmcnt(1)
    v_mfma_f32_16x16x32_bf16 v[60:63], a[232:235], v[252:255], v[60:63]
    s_waitcnt lgkmcnt(0)
    v_mfma_f32_16x16x32_bf16 v[64:67], a[236:239], v[252:255], v[64:67]
    buffer_load_dwordx4 a[36:39], v14, s[56:59], s12 offen offset:1024 sc1
    s_waitcnt vmcnt(25)
    v_mfma_f32_16x16x32_bf16 v[72:75], a[160:163], a[240:243], 0
    v_mfma_f32_16x16x32_bf16 v[76:79], a[164:167], a[240:243], 0
    v_mfma_f32_16x16x32_bf16 v[80:83], a[168:171], a[240:243], 0
    v_mfma_f32_16x16x32_bf16 v[84:87], a[172:175], a[240:243], 0
    buffer_load_dwordx4 a[40:43], v14, s[56:59], s12 offen offset:2048 sc1
    v_cmp_u_f32 vcc, v48, v48
    s_cbranch_vccnz FZ_SL0
FZ_SB0:
    v_mfma_f32_16x16x32_bf16 v[88:91], a[176:179], a[240:243], 0
    ds_write_b128 v10, v[48:51] offset:0
    ds_write_b128 v10, v[52:55] offset:1024
    s_waitcnt vmcnt(25)
    v_mfma_f32_16x16x32_bf16 v[72:75], a[180:183], a[244:247], v[72:75]
    v_mfma_f32_16x16x32_bf16 v[76:79], a[184:187], a[244:247], v[76:79]
    ds_write_b128 v10, v[56:59] offset:2048
    v_mfma_f32_16x16x32_bf16 v[80:83], a[188:191], a[244:247], v[80:83]
    buffer_load_dwordx4 a[44:47], v14, s[56:59], s12 offen offset:3072 sc1
    v_mfma_f32_16x16x32_bf16 v[84:87], a[0:3], a[244:247], v[84:87]
    ds_write_b128 v10, v[60:63] offset:3072
    v_mfma_f32_16x16x32_bf16 v[88:91], a[4:7], a[244:247], v[88:91]
    s_waitcnt vmcnt(25)
    v_mfma_f32_16x16x32_bf16 v[72:75], a[8:11], a[248:251], v[72:75]
    ds_write_b128 v10, v[64:67] offset:4096
    v_cmp_u_f32 vcc, v70, v71
    s_cbranch_vccnz FZ_RL1
FZ_RB1:
    v_mfma_f32_16x16x32_bf16 v[76:79], a[12:15], a[248:251], v[76:79]
    buffer_load_dwordx4 v[208:211], v14, s[56:59], s13 offen offset:0 sc1
    v_permlane16_swap_b32 v70, v71
    v_mfma_f32_16x16x32_bf16 v[80:83], a[16:19], a[248:251], v[80:83]
    v_add_f32 v70, v70, v71
    v_mov_b32 v71, v70
    v_mfma_f32_16x16x32_bf16 v[84:87], a[20:23], a[248:251], v[84:87]
    s_nop 1
    v_permlane32_swap_b32 v70, v71
    v_mfma_f32_16x16x32_bf16 v[88:91], a[24:27], a[248:251], v[88:91]
    s_waitcnt lgkmcnt(0)
    s_barrier
    ds_read_b64_tr_b16 v[96:97], v11 offset:0
    s_waitcnt vmcnt(25)
    v_mfma_f32_16x16x32_bf16 v[72:75], a[28:31], a[252:255], v[72:75]
    ds_read_b64_tr_b16 v[98:99], v11 offset:512
    buffer_load_dwordx4 v[212:215], v14, s[56:59], s13 offen offset:1024 sc1
    v_mfma_f32_16x16x32_bf16 v[76:79], a[96:99], a[252:255], v[76:79]
    ds_read_b128 v[16:19], v9 offset:0
    ds_read_b128 v[20:23], v9 offset:1024
    v_mfma_f32_16x16x32_bf16 v[80:83], a[100:103], a[252:255], v[80:83]
    v_mfma_f32_16x16x32_bf16 v[84:87], a[104:107], a[252:255], v[84:87]
    ds_read_b128 v[24:27], v9 offset:5120
    v_mfma_f32_16x16x32_bf16 v[88:91], a[108:111], a[252:255], v[88:91]
    buffer_load_dwordx4 v[216:219], v14, s[56:59], s13 offen offset:2048 sc1
    s_waitcnt vmcnt(26)
    v_mfma_f32_16x16x32_bf16 v[72:75], a[112:115], a[64:67], v[72:75]
    ds_read_b128 v[28:31], v9 offset:6144
    v_mfma_f32_16x16x32_bf16 v[76:79], a[116:119], a[64:67], v[76:79]
    v_mfma_f32_16x16x32_bf16 v[80:83], a[120:123], a[64:67], v[80:83]
    ds_read_b128 v[32:35], v9 offset:10240
    v_mfma_f32_16x16x32_bf16 v[84:87], a[124:127], a[64:67], v[84:87]
    buffer_load_dwordx4 v[220:223], v14, s[56:59], s13 offen offset:3072 sc1
    v_mfma_f32_16x16x32_bf16 v[88:91], a[128:131], a[64:67], v[88:91]
    ds_read_b128 v[36:39], v9 offset:11264
    s_waitcnt vmcnt(26)
    v_mfma_f32_16x16x32_bf16 v[72:75], a[132:135], a[68:71], v[72:75]
    v_mfma_f32_16x16x32_bf16 v[76:79], a[136:139], a[68:71], v[76:79]
    ds_read_b128 v[40:43], v9 offset:15360
    v_mfma_f32_16x16x32_bf16 v[80:83], a[140:143], a[68:71], v[80:83]
    buffer_load_dwordx4 v[224:227], v14, s[56:59], s14 offen offset:0 sc1
    v_mfma_f32_16x16x32_bf16 v[84:87], a[144:147], a[68:71], v[84:87]
    ds_read_b128 v[44:47], v9 offset:16384
    v_add_f32 v70, v70, v71
    v_mfma_f32_16x16x32_bf16 v[88:91], a[148:151], a[68:71], v[88:91]
    v_mov_b32 v71, v70
    s_nop 1
    s_waitcnt vmcnt(26)
    v_mfma_f32_16x16x32_bf16 v[72:75], a[152:155], a[72:75], v[72:75]
    v_permlane16_swap_b32 v70, v71
    v_mul_f32 v70, 0x3acccccd, v70
    v_mfma_f32_16x16x32_bf16 v[76:79], a[156:159], a[72:75], v[76:79]
    buffer_load_dwordx4 v[228:231], v14, s[56:59], s14 offen offset:1024 sc1
    v_mul_f32 v71, 0x3acccccd, v71
    v_mfma_f32_16x16x32_bf16 v[80:83], v[176:179], a[72:75], v[80:83]
    s_waitcnt lgkmcnt(8)
    v_lshlrev_b32 v100, 16, v96
    v_and_b32 v101, s38, v96
    v_mfma_f32_16x16x32_bf16 v[84:87], v[180:183], a[72:75], v[84:87]
    v_lshlrev_b32 v102, 16, v97
    v_and_b32 v103, s38, v97
    v_mfma_f32_16x16x32_bf16 v[88:91], v[184:187], a[72:75], v[88:91]
    v_lshlrev_b32 v104, 16, v98
    v_and_b32 v105, s38, v98
    s_waitcnt vmcnt(26)
    v_mfma_f32_16x16x32_bf16 v[72:75], v[188:191], a[76:79], v[72:75]
    buffer_load_dwordx4 v[232:235], v14, s[56:59], s14 offen offset:2048 sc1
    v_lshlrev_b32 v106, 16, v99
    v_mfma_f32_16x16x32_bf16 v[76:79], v[192:195], a[76:79], v[76:79]
    v_and_b32 v107, s38, v99
    s_waitcnt lgkmcnt(4)
    v_pk_add_f32 v[16:17], v[16:17], v[24:25]
    v_mfma_f32_16x16x32_bf16 v[80:83], v[196:199], a[76:79], v[80:83]
    v_pk_add_f32 v[18:19], v[18:19], v[26:27]
    v_pk_add_f32 v[20:21], v[20:21], v[28:29]
    v_mfma_f32_16x16x32_bf16 v[84:87], v[200:203], a[76:79], v[84:87]
    v_pk_add_f32 v[22:23], v[22:23], v[30:31]
    s_waitcnt lgkmcnt(0)
    v_pk_add_f32 v[32:33], v[32:33], v[40:41]
    v_mfma_f32_16x16x32_bf16 v[88:91], v[204:207], a[76:79], v[88:91]
    buffer_load_dwordx4 v[236:239], v14, s[56:59], s14 offen offset:3072 sc1
    v_pk_add_f32 v[34:35], v[34:35], v[42:43]
    s_waitcnt vmcnt(27)
    v_mfma_f32_16x16x32_bf16 v[72:75], v[112:115], a[80:83], v[72:75]
    v_pk_add_f32 v[36:37], v[36:37], v[44:45]
    v_pk_add_f32 v[38:39], v[38:39], v[46:47]
    v_mfma_f32_16x16x32_bf16 v[76:79], v[116:119], a[80:83], v[76:79]
    v_pk_add_f32 v[16:17], v[16:17], v[32:33]
    v_pk_add_f32 v[18:19], v[18:19], v[34:35]
    v_mfma_f32_16x16x32_bf16 v[80:83], v[120:123], a[80:83], v[80:83]
    v_pk_add_f32 v[20:21], v[20:21], v[36:37]
    v_pk_add_f32 v[22:23], v[22:23], v[38:39]
    v_mfma_f32_16x16x32_bf16 v[84:87], v[124:127], a[80:83], v[84:87]
    buffer_load_dwordx4 v[240:243], v14, s[56:59], s15 offen offset:0 sc1
    v_pk_fma_f32 v[16:17], v[16:17], v[68:69], v[100:101]
    v_mfma_f32_16x16x32_bf16 v[88:91], v[128:131], a[80:83], v[88:91]
    v_pk_fma_f32 v[18:19], v[18:19], v[68:69], v[102:103]
    v_pk_fma_f32 v[20:21], v[20:21], v[68:69], v[104:105]
    s_waitcnt vmcnt(27)
    v_mfma_f32_16x16x32_bf16 v[72:75], v[132:135], a[84:87], v[72:75]
    v_pk_fma_f32 v[22:23], v[22:23], v[68:69], v[106:107]
    v_cvt_pk_bf16_f32 v96, v16, v17
    v_mfma_f32_16x16x32_bf16 v[76:79], v[136:139], a[84:87], v[76:79]
    v_cvt_pk_bf16_f32 v97, v18, v19
    v_cvt_pk_bf16_f32 v98, v20, v21
    v_mfma_f32_16x16x32_bf16 v[80:83], v[140:143], a[84:87], v[80:83]
    buffer_load_dwordx4 v[244:247], v14, s[56:59], s15 offen offset:1024 sc1
    v_cvt_pk_bf16_f32 v99, v22, v23
    v_mfma_f32_16x16x32_bf16 v[84:87], v[144:147], a[84:87], v[84:87]
    v_mfma_f32_16x16x32_bf16 v[88:91], v[148:151], a[84:87], v[88:91]
    s_waitcnt vmcnt(25)
    v_mfma_f32_16x16x32_bf16 v[72:75], v[152:155], a[88:91], v[72:75]
    v_mfma_f32_16x16x32_bf16 v[76:79], v[156:159], a[88:91], v[76:79]
    buffer_store_dwordx4 v[96:99], v5, s[44:47], s16 offen
    v_mfma_f32_16x16x32_bf16 v[80:83], v[160:163], a[88:91], v[80:83]
    v_mfma_f32_16x16x32_bf16 v[84:87], v[164:167], a[88:91], v[84:87]
    v_mfma_f32_16x16x32_bf16 v[88:91], v[168:171], a[88:91], v[88:91]
    s_waitcnt vmcnt(25)
    v_mfma_f32_16x16x32_bf16 v[72:75], v[172:175], a[92:95], v[72:75]
    buffer_store_dwordx2 v[96:97], v6, s[44:47], s16 offen
    v_fma_f32 v71, -v70, v70, v71
    v_mfma_f32_16x16x32_bf16 v[76:79], a[224:227], a[92:95], v[76:79]
    v_max_f32 v71, 0, v71
    v_add_f32 v71, 0x3727c5ac, v71
    v_mfma_f32_16x16x32_bf16 v[80:83], a[228:231], a[92:95], v[80:83]
    buffer_load_dwordx4 v[248:251], v14, s[56:59], s15 offen offset:2048 sc1
    v_rcp_f32 v70, v71
    v_mfma_f32_16x16x32_bf16 v[84:87], a[232:235], a[92:95], v[84:87]
    s_nop 0
    v_mov_b32 v71, v70
    v_mfma_f32_16x16x32_bf16 v[88:91], a[236:239], a[92:95], v[88:91]
    s_waitcnt vmcnt(24)
    v_mfma_f32_16x16x32_bf16 v[48:51], a[160:163], a[192:195], 0
    v_mfma_f32_16x16x32_bf16 v[52:55], a[164:167], a[192:195], 0
    buffer_load_dwordx4 v[252:255], v14, s[56:59], s15 offen offset:3072 sc1
    v_mfma_f32_16x16x32_bf16 v[56:59], a[168:171], a[192:195], 0
    v_mfma_f32_16x16x32_bf16 v[60:63], a[172:175], a[192:195], 0
    v_cmp_u_f32 vcc, v72, v72
    s_cbranch_vccnz FZ_SL1
FZ_SB1:
    ds_write_b128 v10, v[72:75] offset:20480
    v_mfma_f32_16x16x32_bf16 v[64:67], a[176:179], a[192:195], 0
    ds_write_b128 v10, v[76:79] offset:21504
    s_waitcnt vmcnt(24)
    v_mfma_f32_16x16x32_bf16 v[48:51], a[180:183], a[196:199], v[48:51]
    ds_write_b128 v10, v[80:83] offset:22528
    v_mfma_f32_16x16x32_bf16 v[52:55], a[184:187], a[196:199], v[52:55]
    v_mfma_f32_16x16x32_bf16 v[56:59], a[188:191], a[196:199], v[56:59]
    ds_write_b128 v10, v[84:87] offset:23552
    v_mfma_f32_16x16x32_bf16 v[60:63], a[0:3], a[196:199], v[60:63]
    v_mfma_f32_16x16x32_bf16 v[64:67], a[4:7], a[196:199], v[64:67]
    ds_write_b128 v10, v[88:91] offset:24576
    v_cmp_u_f32 vcc, v92, v93
    s_cbranch_vccnz FZ_RL2
FZ_RB2:
    s_waitcnt vmcnt(23)
    v_mfma_f32_16x16x32_bf16 v[48:51], a[8:11], a[200:203], v[48:51]
    v_permlane16_swap_b32 v92, v93
    v_add_f32 v92, v92, v93
    v_mfma_f32_16x16x32_bf16 v[52:55], a[12:15], a[200:203], v[52:55]
    v_mov_b32 v93, v92
    s_nop 1
    v_mfma_f32_16x16x32_bf16 v[56:59], a[16:19], a[200:203], v[56:59]
    v_permlane32_swap_b32 v92, v93
    s_waitcnt lgkmcnt(0)
    s_barrier
    v_mfma_f32_16x16x32_bf16 v[60:63], a[20:23], a[200:203], v[60:63]
    ds_read_b64_tr_b16 v[96:97], v11 offset:64
    ds_read_b64_tr_b16 v[98:99], v11 offset:576
    v_mfma_f32_16x16x32_bf16 v[64:67], a[24:27], a[200:203], v[64:67]
    ds_read_b128 v[16:19], v9 offset:20480
    s_waitcnt vmcnt(22)
    v_mfma_f32_16x16x32_bf16 v[48:51], a[28:31], a[204:207], v[48:51]
    ds_read_b128 v[20:23], v9 offset:21504
    v_mfma_f32_16x16x32_bf16 v[52:55], a[96:99], a[204:207], v[52:55]
    v_mfma_f32_16x16x32_bf16 v[56:59], a[100:103], a[204:207], v[56:59]
    ds_read_b128 v[24:27], v9 offset:25600
    v_mfma_f32_16x16x32_bf16 v[60:63], a[104:107], a[204:207], v[60:63]
    v_mfma_f32_16x16x32_bf16 v[64:67], a[108:111], a[204:207], v[64:67]
    ds_read_b128 v[28:31], v9 offset:26624
    s_waitcnt vmcnt(21)
    v_mfma_f32_16x16x32_bf16 v[48:51], a[112:115], a[208:211], v[48:51]
    v_mfma_f32_16x16x32_bf16 v[52:55], a[116:119], a[208:211], v[52:55]
    ds_read_b128 v[32:35], v9 offset:30720
    v_mfma_f32_16x16x32_bf16 v[56:59], a[120:123], a[208:211], v[56:59]
    v_mfma_f32_16x16x32_bf16 v[60:63], a[124:127], a[208:211], v[60:63]
    ds_read_b128 v[36:39], v9 offset:31744
    v_mfma_f32_16x16x32_bf16 v[64:67], a[128:131], a[208:211], v[64:67]
    s_waitcnt vmcnt(20)
    v_mfma_f32_16x16x32_bf16 v[48:51], a[132:135], a[212:215], v[48:51]
    ds_read_b128 v[40:43], v9 offset:35840
    v_mfma_f32_16x16x32_bf16 v[52:55], a[136:139], a[212:215], v[52:55]
    v_mfma_f32_16x16x32_bf16 v[56:59], a[140:143], a[212:215], v[56:59]
    ds_read_b128 v[44:47], v9 offset:36864
    v_add_f32 v92, v92, v93
    v_mfma_f32_16x16x32_bf16 v[60:63], a[144:147], a[212:215], v[60:63]
    v_mov_b32 v93, v92
    s_nop 1
    v_mfma_f32_16x16x32_bf16 v[64:67], a[148:151], a[212:215], v[64:67]
    v_permlane16_swap_b32 v92, v93
    v_mul_f32 v92, 0x3acccccd, v92
    s_waitcnt vmcnt(19)
    v_mfma_f32_16x16x32_bf16 v[48:51], a[152:155], a[216:219], v[48:51]
    v_mul_f32 v93, 0x3acccccd, v93
    s_waitcnt lgkmcnt(8)
    v_lshlrev_b32 v100, 16, v96
    v_mfma_f32_16x16x32_bf16 v[52:55], a[156:159], a[216:219], v[52:55]
    v_and_b32 v101, s38, v96
    v_lshlrev_b32 v102, 16, v97
    v_mfma_f32_16x16x32_bf16 v[56:59], v[176:179], a[216:219], v[56:59]
    v_and_b32 v103, s38, v97
    v_lshlrev_b32 v104, 16, v98
    v_mfma_f32_16x16x32_bf16 v[60:63], v[180:183], a[216:219], v[60:63]
    v_and_b32 v105, s38, v98
    v_lshlrev_b32 v106, 16, v99
    v_mfma_f32_16x16x32_bf16 v[64:67], v[184:187], a[216:219], v[64:67]
    v_and_b32 v107, s38, v99
    s_waitcnt lgkmcnt(4)
    v_pk_add_f32 v[16:17], v[16:17], v[24:25]
    s_waitcnt vmcnt(18)
    v_mfma_f32_16x16x32_bf16 v[48:51], v[188:191], a[220:223], v[48:51]
    v_pk_add_f32 v[18:19], v[18:19], v[26:27]
    v_pk_add_f32 v[20:21], v[20:21], v[28:29]
    v_mfma_f32_16x16x32_bf16 v[52:55], v[192:195], a[220:223], v[52:55]
    v_pk_add_f32 v[22:23], v[22:23], v[30:31]
    s_waitcnt lgkmcnt(0)
    v_pk_add_f32 v[32:33], v[32:33], v[40:41]
    v_mfma_f32_16x16x32_bf16 v[56:59], v[196:199], a[220:223], v[56:59]
    v_pk_add_f32 v[34:35], v[34:35], v[42:43]
    v_pk_add_f32 v[36:37], v[36:37], v[44:45]
    v_mfma_f32_16x16x32_bf16 v[60:63], v[200:203], a[220:223], v[60:63]
    v_pk_add_f32 v[38:39], v[38:39], v[46:47]
    v_pk_add_f32 v[16:17], v[16:17], v[32:33]
    v_mfma_f32_16x16x32_bf16 v[64:67], v[204:207], a[220:223], v[64:67]
    v_pk_add_f32 v[18:19], v[18:19], v[34:35]
    v_pk_add_f32 v[20:21], v[20:21], v[36:37]
    s_waitcnt vmcnt(17)
    v_mfma_f32_16x16x32_bf16 v[48:51], v[112:115], a[32:35], v[48:51]
    v_pk_add_f32 v[22:23], v[22:23], v[38:39]
    v_pk_fma_f32 v[16:17], v[16:17], v[70:71], v[100:101]
    v_mfma_f32_16x16x32_bf16 v[52:55], v[116:119], a[32:35], v[52:55]
    v_pk_fma_f32 v[18:19], v[18:19], v[70:71], v[102:103]
    v_pk_fma_f32 v[20:21], v[20:21], v[70:71], v[104:105]
    v_mfma_f32_16x16x32_bf16 v[56:59], v[120:123], a[32:35], v[56:59]
    v_pk_fma_f32 v[22:23], v[22:23], v[70:71], v[106:107]
    v_cvt_pk_bf16_f32 v96, v16, v17
    v_mfma_f32_16x16x32_bf16 v[60:63], v[124:127], a[32:35], v[60:63]
    v_cvt_pk_bf16_f32 v97, v18, v19
    v_cvt_pk_bf16_f32 v98, v20, v21
    v_mfma_f32_16x16x32_bf16 v[64:67], v[128:131], a[32:35], v[64:67]
    v_cvt_pk_bf16_f32 v99, v22, v23
    buffer_store_dwordx4 v[96:99], v5, s[44:47], s17 offen
    s_waitcnt vmcnt(17)
    v_mfma_f32_16x16x32_bf16 v[48:51], v[132:135], a[36:39], v[48:51]
    v_mfma_f32_16x16x32_bf16 v[52:55], v[136:139], a[36:39], v[52:55]
    buffer_store_dwordx2 v[96:97], v6, s[44:47], s17 offen
    v_fma_f32 v93, -v92, v92, v93
    v_mfma_f32_16x16x32_bf16 v[56:59], v[140:143], a[36:39], v[56:59]
    v_max_f32 v93, 0, v93
    v_add_f32 v93, 0x3727c5ac, v93
    v_mfma_f32_16x16x32_bf16 v[60:63], v[144:147], a[36:39], v[60:63]
    v_rcp_f32 v92, v93
    s_nop 0
    v_mfma_f32_16x16x32_bf16 v[64:67], v[148:151], a[36:39], v[64:67]
    v_mov_b32 v93, v92
    s_waitcnt vmcnt(17)
    v_mfma_f32_16x16x32_bf16 v[48:51], v[152:155], a[40:43], v[48:51]
    v_mfma_f32_16x16x32_bf16 v[52:55], v[156:159], a[40:43], v[52:55]
    v_mfma_f32_16x16x32_bf16 v[56:59], v[160:163], a[40:43], v[56:59]
    v_mfma_f32_16x16x32_bf16 v[60:63], v[164:167], a[40:43], v[60:63]
    v_mfma_f32_16x16x32_bf16 v[64:67], v[168:171], a[40:43], v[64:67]
    s_waitcnt vmcnt(16)
    v_mfma_f32_16x16x32_bf16 v[48:51], v[172:175], a[44:47], v[48:51]
    v_mfma_f32_16x16x32_bf16 v[52:55], a[224:227], a[44:47], v[52:55]
    v_mfma_f32_16x16x32_bf16 v[56:59], a[228:231], a[44:47], v[56:59]
    v_mfma_f32_16x16x32_bf16 v[60:63], a[232:235], a[44:47], v[60:63]
    v_mfma_f32_16x16x32_bf16 v[64:67], a[236:239], a[44:47], v[64:67]
    s_waitcnt vmcnt(15)
    v_mfma_f32_16x16x32_bf16 v[72:75], a[160:163], v[208:211], 0
    v_mfma_f32_16x16x32_bf16 v[76:79], a[164:167], v[208:211], 0
    v_mfma_f32_16x16x32_bf16 v[80:83], a[168:171], v[208:211], 0
    v_mfma_f32_16x16x32_bf16 v[84:87], a[172:175], v[208:211], 0
    v_cmp_u_f32 vcc, v48, v48
    s_cbranch_vccnz FZ_SL2
FZ_SB2:
    ds_write_b128 v10, v[48:51] offset:0
    v_mfma_f32_16x16x32_bf16 v[88:91], a[176:179], v[208:211], 0
    ds_write_b128 v10, v[52:55] offset:1024
    s_waitcnt vmcnt(14)
    v_mfma_f32_16x16x32_bf16 v[72:75], a[180:183], v[212:215], v[72:75]
    ds_write_b128 v10, v[56:59] offset:2048
    v_mfma_f32_16x16x32_bf16 v[76:79], a[184:187], v[212:215], v[76:79]
    v_mfma_f32_16x16x32_bf16 v[80:83], a[188:191], v[212:215], v[80:83]
    ds_write_b128 v10, v[60:63] offset:3072
    v_mfma_f32_16x16x32_bf16 v[84:87], a[0:3], v[212:215], v[84:87]
    v_mfma_f32_16x16x32_bf16 v[88:91], a[4:7], v[212:215], v[88:91]
    ds_write_b128 v10, v[64:67] offset:4096
    v_cmp_u_f32 vcc, v94, v95
    s_cbranch_vccnz FZ_RL3
FZ_RB3:
    s_waitcnt vmcnt(13)
    v_mfma_f32_16x16x32_bf16 v[72:75], a[8:11], v[216:219], v[72:75]
    v_permlane16_swap_b32 v94, v95
    v_add_f32 v94, v94, v95
    v_mfma_f32_16x16x32_bf16 v[76:79], a[12:15], v[216:219], v[76:79]
    v_mov_b32 v95, v94
    s_nop 1
    v_mfma_f32_16x16x32_bf16 v[80:83], a[16:19], v[216:219], v[80:83]
    v_permlane32_swap_b32 v94, v95
    s_waitcnt lgkmcnt(0)
    s_barrier
    v_mfma_f32_16x16x32_bf16 v[84:87], a[20:23], v[216:219], v[84:87]
    ds_read_b64_tr_b16 v[96:97], v11 offset:10240
    ds_read_b64_tr_b16 v[98:99], v11 offset:10752
    v_mfma_f32_16x16x32_bf16 v[88:91], a[24:27], v[216:219], v[88:91]
    ds_read_b128 v[16:19], v9 offset:0
    s_waitcnt vmcnt(12)
    v_mfma_f32_16x16x32_bf16 v[72:75], a[28:31], v[220:223], v[72:75]
    ds_read_b128 v[20:23], v9 offset:1024
    v_mfma_f32_16x16x32_bf16 v[76:79], a[96:99], v[220:223], v[76:79]
    v_mfma_f32_16x16x32_bf16 v[80:83], a[100:103], v[220:223], v[80:83]
    ds_read_b128 v[24:27], v9 offset:5120
    v_mfma_f32_16x16x32_bf16 v[84:87], a[104:107], v[220:223], v[84:87]
    v_mfma_f32_16x16x32_bf16 v[88:91], a[108:111], v[220:223], v[88:91]
    ds_read_b128 v[28:31], v9 offset:6144
    s_waitcnt vmcnt(11)
    v_mfma_f32_16x16x32_bf16 v[72:75], a[112:115], v[224:227], v[72:75]
    v_mfma_f32_16x16x32_bf16 v[76:79], a[116:119], v[224:227], v[76:79]
    ds_read_b128 v[32:35], v9 offset:10240
    v_mfma_f32_16x16x32_bf16 v[80:83], a[120:123], v[224:227], v[80:83]
    v_mfma_f32_16x16x32_bf16 v[84:87], a[124:127], v[224:227], v[84:87]
    ds_read_b128 v[36:39], v9 offset:11264
    v_mfma_f32_16x16x32_bf16 v[88:91], a[128:131], v[224:227], v[88:91]
    s_waitcnt vmcnt(10)
    v_mfma_f32_16x16x32_bf16 v[72:75], a[132:135], v[228:231], v[72:75]
    ds_read_b128 v[40:43], v9 offset:15360
    v_mfma_f32_16x16x32_bf16 v[76:79], a[136:139], v[228:231], v[76:79]
    v_mfma_f32_16x16x32_bf16 v[80:83], a[140:143], v[228:231], v[80:83]
    ds_read_b128 v[44:47], v9 offset:16384
    v_add_f32 v94, v94, v95
    v_mfma_f32_16x16x32_bf16 v[84:87], a[144:147], v[228:231], v[84:87]
    v_mov_b32 v95, v94
    s_nop 1
    v_mfma_f32_16x16x32_bf16 v[88:91], a[148:151], v[228:231], v[88:91]
    v_permlane16_swap_b32 v94, v95
    v_mul_f32 v94, 0x3acccccd, v94
    s_waitcnt vmcnt(9)
    v_mfma_f32_16x16x32_bf16 v[72:75], a[152:155], v[232:235], v[72:75]
    v_mul_f32 v95, 0x3acccccd, v95
    s_waitcnt lgkmcnt(8)
    v_lshlrev_b32 v100, 16, v96
    v_mfma_f32_16x16x32_bf16 v[76:79], a[156:159], v[232:235], v[76:79]
    v_and_b32 v101, s38, v96
    v_lshlrev_b32 v102, 16, v97
    v_mfma_f32_16x16x32_bf16 v[80:83], v[176:179], v[232:235], v[80:83]
    v_and_b32 v103, s38, v97
    v_lshlrev_b32 v104, 16, v98
    v_mfma_f32_16x16x32_bf16 v[84:87], v[180:183], v[232:235], v[84:87]
    v_and_b32 v105, s38, v98
    v_lshlrev_b32 v106, 16, v99
    v_mfma_f32_16x16x32_bf16 v[88:91], v[184:187], v[232:235], v[88:91]
    v_and_b32 v107, s38, v99
    s_waitcnt lgkmcnt(4)
    v_pk_add_f32 v[16:17], v[16:17], v[24:25]
    s_waitcnt vmcnt(8)
    v_mfma_f32_16x16x32_bf16 v[72:75], v[188:191], v[236:239], v[72:75]
    v_pk_add_f32 v[18:19], v[18:19], v[26:27]
    v_pk_add_f32 v[20:21], v[20:21], v[28:29]
    v_mfma_f32_16x16x32_bf16 v[76:79], v[192:195], v[236:239], v[76:79]
    v_pk_add_f32 v[22:23], v[22:23], v[30:31]
    s_waitcnt lgkmcnt(0)
    v_pk_add_f32 v[32:33], v[32:33], v[40:41]
    v_mfma_f32_16x16x32_bf16 v[80:83], v[196:199], v[236:239], v[80:83]
    v_pk_add_f32 v[34:35], v[34:35], v[42:43]
    v_pk_add_f32 v[36:37], v[36:37], v[44:45]
    v_mfma_f32_16x16x32_bf16 v[84:87], v[200:203], v[236:239], v[84:87]
    v_pk_add_f32 v[38:39], v[38:39], v[46:47]
    v_pk_add_f32 v[16:17], v[16:17], v[32:33]
    v_mfma_f32_16x16x32_bf16 v[88:91], v[204:207], v[236:239], v[88:91]
    v_pk_add_f32 v[18:19], v[18:19], v[34:35]
    v_pk_add_f32 v[20:21], v[20:21], v[36:37]
    s_waitcnt vmcnt(7)
    v_mfma_f32_16x16x32_bf16 v[72:75], v[112:115], v[240:243], v[72:75]
    v_pk_add_f32 v[22:23], v[22:23], v[38:39]
    v_pk_fma_f32 v[16:17], v[16:17], v[92:93], v[100:101]
    v_mfma_f32_16x16x32_bf16 v[76:79], v[116:119], v[240:243], v[76:79]
    v_pk_fma_f32 v[18:19], v[18:19], v[92:93], v[102:103]
    v_pk_fma_f32 v[20:21], v[20:21], v[92:93], v[104:105]
    v_mfma_f32_16x16x32_bf16 v[80:83], v[120:123], v[240:243], v[80:83]
    v_pk_fma_f32 v[22:23], v[22:23], v[92:93], v[106:107]
    v_cvt_pk_bf16_f32 v96, v16, v17
    v_mfma_f32_16x16x32_bf16 v[84:87], v[124:127], v[240:243], v[84:87]
    v_cvt_pk_bf16_f32 v97, v18, v19
    v_cvt_pk_bf16_f32 v98, v20, v21
    v_mfma_f32_16x16x32_bf16 v[88:91], v[128:131], v[240:243], v[88:91]
    v_cvt_pk_bf16_f32 v99, v22, v23
    buffer_store_dwordx4 v[96:99], v5, s[44:47], s18 offen
    s_waitcnt vmcnt(7)
    v_mfma_f32_16x16x32_bf16 v[72:75], v[132:135], v[244:247], v[72:75]
    v_mfma_f32_16x16x32_bf16 v[76:79], v[136:139], v[244:247], v[76:79]
    buffer_store_dwordx2 v[96:97], v6, s[44:47], s18 offen
    v_fma_f32 v95, -v94, v94, v95
    v_mfma_f32_16x16x32_bf16 v[80:83], v[140:143], v[244:247], v[80:83]
    v_max_f32 v95, 0, v95
    v_add_f32 v95, 0x3727c5ac, v95
    v_mfma_f32_16x16x32_bf16 v[84:87], v[144:147], v[244:247], v[84:87]
    v_rcp_f32 v94, v95
    s_nop 0
    v_mfma_f32_16x16x32_bf16 v[88:91], v[148:151], v[244:247], v[88:91]
    v_mov_b32 v95, v94
    s_waitcnt vmcnt(5)
    v_mfma_f32_16x16x32_bf16 v[72:75], v[152:155], v[248:251], v[72:75]
    v_mfma_f32_16x16x32_bf16 v[76:79], v[156:159], v[248:251], v[76:79]
    v_mfma_f32_16x16x32_bf16 v[80:83], v[160:163], v[248:251], v[80:83]
    v_mfma_f32_16x16x32_bf16 v[84:87], v[164:167], v[248:251], v[84:87]
    v_mfma_f32_16x16x32_bf16 v[88:91], v[168:171], v[248:251], v[88:91]
    s_waitcnt vmcnt(4)
    v_mfma_f32_16x16x32_bf16 v[72:75], v[172:175], v[252:255], v[72:75]
    v_mfma_f32_16x16x32_bf16 v[76:79], a[224:227], v[252:255], v[76:79]
    v_mfma_f32_16x16x32_bf16 v[80:83], a[228:231], v[252:255], v[80:83]
    v_mfma_f32_16x16x32_bf16 v[84:87], a[232:235], v[252:255], v[84:87]
    v_mfma_f32_16x16x32_bf16 v[88:91], a[236:239], v[252:255], v[88:91]
    s_nop 3
    v_cmp_u_f32 vcc, v72, v72
    s_cbranch_vccnz FZ_SL3
FZ_SB3:
    ds_write_b128 v10, v[72:75] offset:20480
    ds_write_b128 v10, v[76:79] offset:21504
    ds_write_b128 v10, v[80:83] offset:22528
    ds_write_b128 v10, v[84:87] offset:23552
    ds_write_b128 v10, v[88:91] offset:24576
    s_waitcnt lgkmcnt(0)
    s_barrier
    ds_read_b64_tr_b16 v[96:97], v11 offset:10304
    ds_read_b64_tr_b16 v[98:99], v11 offset:10816
    ds_read_b128 v[16:19], v9 offset:20480
    ds_read_b128 v[20:23], v9 offset:21504
    ds_read_b128 v[24:27], v9 offset:25600
    ds_read_b128 v[28:31], v9 offset:26624
    ds_read_b128 v[32:35], v9 offset:30720
    ds_read_b128 v[36:39], v9 offset:31744
    ds_read_b128 v[40:43], v9 offset:35840
    ds_read_b128 v[44:47], v9 offset:36864
    s_waitcnt lgkmcnt(8)
    v_lshlrev_b32 v100, 16, v96
    v_and_b32 v101, s38, v96
    v_lshlrev_b32 v102, 16, v97
    v_and_b32 v103, s38, v97
    v_lshlrev_b32 v104, 16, v98
    v_and_b32 v105, s38, v98
    v_lshlrev_b32 v106, 16, v99
    v_and_b32 v107, s38, v99
    s_waitcnt lgkmcnt(4)
    v_pk_add_f32 v[16:17], v[16:17], v[24:25]
    v_pk_add_f32 v[18:19], v[18:19], v[26:27]
    v_pk_add_f32 v[20:21], v[20:21], v[28:29]
    v_pk_add_f32 v[22:23], v[22:23], v[30:31]
    s_waitcnt lgkmcnt(0)
    v_pk_add_f32 v[32:33], v[32:33], v[40:41]
    v_pk_add_f32 v[34:35], v[34:35], v[42:43]
    v_pk_add_f32 v[36:37], v[36:37], v[44:45]
    v_pk_add_f32 v[38:39], v[38:39], v[46:47]
    v_pk_add_f32 v[16:17], v[16:17], v[32:33]
    v_pk_add_f32 v[18:19], v[18:19], v[34:35]
    v_pk_add_f32 v[20:21], v[20:21], v[36:37]
    v_pk_add_f32 v[22:23], v[22:23], v[38:39]
    v_pk_fma_f32 v[16:17], v[16:17], v[94:95], v[100:101]
    v_pk_fma_f32 v[18:19], v[18:19], v[94:95], v[102:103]
    v_pk_fma_f32 v[20:21], v[20:21], v[94:95], v[104:105]
    v_pk_fma_f32 v[22:23], v[22:23], v[94:95], v[106:107]
    v_cvt_pk_bf16_f32 v96, v16, v17
    v_cvt_pk_bf16_f32 v97, v18, v19
    v_cvt_pk_bf16_f32 v98, v20, v21
    v_cvt_pk_bf16_f32 v99, v22, v23
    buffer_store_dwordx4 v[96:99], v5, s[44:47], s19 offen
    buffer_store_dwordx2 v[96:97], v6, s[44:47], s19 offen
    s_cmp_eq_u32 s2, 255
    s_cbranch_scc0 FZ_FIN
    s_mov_b32 s32, 24641536
    s_cmp_eq_u32 s3, 0
    s_cbranch_scc0 L_sequen_pf_27
    v_mov_b32 v4, s60
    v_mov_b32 v3, 0
    s_mov_b64 exec, 1
    buffer_store_dword v4, v3, s[56:59], s32 offen sc1
    s_mov_b64 exec, -1
L_sequen_pf_27:
    s_branch FZ_FIN
FZ_RL0:
    buffer_load_dwordx2 v[68:69], v13, s[56:59], s24 offen sc1
    s_waitcnt vmcnt(0)
    v_cmp_u_f32 vcc, v68, v69
    s_cbranch_vccz FZ_RB0
    s_sub_u32 s61, s61, 1
    s_cbranch_scc0 FZ_RL0
    s_mov_b32 s61, 0
    s_branch FZ_RB0
FZ_SL0:
    buffer_load_dwordx4 v[208:211], v14, s[56:59], s4 offen offset:0 sc1
    buffer_load_dwordx4 v[212:215], v14, s[56:59], s4 offen offset:1024 sc1
    buffer_load_dwordx4 v[216:219], v14, s[56:59], s4 offen offset:2048 sc1
    buffer_load_dwordx4 v[220:223], v14, s[56:59], s4 offen offset:3072 sc1
    buffer_load_dwordx4 v[224:227], v14, s[56:59], s5 offen offset:0 sc1
    buffer_load_dwordx4 v[228:231], v14, s[56:59], s5 offen offset:1024 sc1
    buffer_load_dwordx4 v[232:235], v14, s[56:59], s5 offen offset:2048 sc1
    buffer_load_dwordx4 v[236:239], v14, s[56:59], s5 offen offset:3072 sc1
    buffer_load_dwordx4 v[240:243], v14, s[56:59], s6 offen offset:0 sc1
    buffer_load_dwordx4 v[244:247], v14, s[56:59], s6 offen offset:1024 sc1
    buffer_load_dwordx4 v[248:251], v14, s[56:59], s6 offen offset:2048 sc1
    buffer_load_dwordx4 v[252:255], v14, s[56:59], s6 offen offset:3072 sc1
    s_waitcnt vmcnt(0)
    v_mfma_f32_16x16x32_bf16 v[48:51], a[160:163], v[208:211], 0
    v_mfma_f32_16x16x32_bf16 v[48:51], a[180:183], v[212:215], v[48:51]
    v_mfma_f32_16x16x32_bf16 v[48:51], a[8:11], v[216:219], v[48:51]
    v_mfma_f32_16x16x32_bf16 v[48:51], a[28:31], v[220:223], v[48:51]
    v_mfma_f32_16x16x32_bf16 v[48:51], a[112:115], v[224:227], v[48:51]
    v_mfma_f32_16x16x32_bf16 v[48:51], a[132:135], v[228:231], v[48:51]
    v_mfma_f32_16x16x32_bf16 v[48:51], a[152:155], v[232:235], v[48:51]
    v_mfma_f32_16x16x32_bf16 v[48:51], v[188:191], v[236:239], v[48:51]
    v_mfma_f32_16x16x32_bf16 v[48:51], v[112:115], v[240:243], v[48:51]
    v_mfma_f32_16x16x32_bf16 v[48:51], v[132:135], v[244:247], v[48:51]
    v_mfma_f32_16x16x32_bf16 v[48:51], v[152:155], v[248:251], v[48:51]
    v_mfma_f32_16x16x32_bf16 v[48:51], v[172:175], v[252:255], v[48:51]
    s_nop 7
    s_nop 1
    v_cmp_u_f32 vcc, v48, v48
    s_cbranch_vccz FZ_SO0
    s_sub_u32 s61, s61, 1
    s_cbranch_scc0 FZ_SL0
    s_mov_b32 s61, 0
FZ_SO0:
    v_mfma_f32_16x16x32_bf16 v[52:55], a[164:167], v[208:211], 0
    v_mfma_f32_16x16x32_bf16 v[56:59], a[168:171], v[208:211], 0
    v_mfma_f32_16x16x32_bf16 v[60:63], a[172:175], v[208:211], 0
    v_mfma_f32_16x16x32_bf16 v[64:67], a[176:179], v[208:211], 0
    v_mfma_f32_16x16x32_bf16 v[52:55], a[184:187], v[212:215], v[52:55]
    v_mfma_f32_16x16x32_bf16 v[56:59], a[188:191], v[212:215], v[56:59]
    v_mfma_f32_16x16x32_bf16 v[60:63], a[0:3], v[212:215], v[60:63]
    v_mfma_f32_16x16x32_bf16 v[64:67], a[4:7], v[212:215], v[64:67]
    v_mfma_f32_16x16x32_bf16 v[52:55], a[12:15], v[216:219], v[52:55]
    v_mfma_f32_16x16x32_bf16 v[56:59], a[16:19], v[216:219], v[56:59]
    v_mfma_f32_16x16x32_bf16 v[60:63], a[20:23], v[216:219], v[60:63]
    v_mfma_f32_16x16x32_bf16 v[64:67], a[24:27], v[216:219], v[64:67]
    v_mfma_f32_16x16x32_bf16 v[52:55], a[96:99], v[220:223], v[52:55]
    v_mfma_f32_16x16x32_bf16 v[56:59], a[100:103], v[220:223], v[56:59]
    v_mfma_f32_16x16x32_bf16 v[60:63], a[104:107], v[220:223], v[60:63]
    v_mfma_f32_16x16x32_bf16 v[64:67], a[108:111], v[220:223], v[64:67]
    v_mfma_f32_16x16x32_bf16 v[52:55], a[116:119], v[224:227], v[52:55]
    v_mfma_f32_16x16x32_bf16 v[56:59], a[120:123], v[224:227], v[56:59]
    v_mfma_f32_16x16x32_bf16 v[60:63], a[124:127], v[224:227], v[60:63]
    v_mfma_f32_16x16x32_bf16 v[64:67], a[128:131], v[224:227], v[64:67]
    v_mfma_f32_16x16x32_bf16 v[52:55], a[136:139], v[228:231], v[52:55]
    v_mfma_f32_16x16x32_bf16 v[56:59], a[140:143], v[228:231], v[56:59]
    v_mfma_f32_16x16x32_bf16 v[60:63], a[144:147], v[228:231], v[60:63]
    v_mfma_f32_16x16x32_bf16 v[64:67], a[148:151], v[228:231], v[64:67]
    v_mfma_f32_16x16x32_bf16 v[52:55], a[156:159], v[232:235], v[52:55]
    v_mfma_f32_16x16x32_bf16 v[56:59], v[176:179], v[232:235], v[56:59]
    v_mfma_f32_16x16x32_bf16 v[60:63], v[180:183], v[232:235], v[60:63]
    v_mfma_f32_16x16x32_bf16 v[64:67], v[184:187], v[232:235], v[64:67]
    v_mfma_f32_16x16x32_bf16 v[52:55], v[192:195], v[236:239], v[52:55]
    v_mfma_f32_16x16x32_bf16 v[56:59], v[196:199], v[236:239], v[56:59]
    v_mfma_f32_16x16x32_bf16 v[60:63], v[200:203], v[236:239], v[60:63]
    v_mfma_f32_16x16x32_bf16 v[64:67], v[204:207], v[236:239], v[64:67]
    v_mfma_f32_16x16x32_bf16 v[52:55], v[116:119], v[240:243], v[52:55]
    v_mfma_f32_16x16x32_bf16 v[56:59], v[120:123], v[240:243], v[56:59]
    v_mfma_f32_16x16x32_bf16 v[60:63], v[124:127], v[240:243], v[60:63]
    v_mfma_f32_16x16x32_bf16 v[64:67], v[128:131], v[240:243], v[64:67]
    v_mfma_f32_16x16x32_bf16 v[52:55], v[136:139], v[244:247], v[52:55]
    v_mfma_f32_16x16x32_bf16 v[56:59], v[140:143], v[244:247], v[56:59]
    v_mfma_f32_16x16x32_bf16 v[60:63], v[144:147], v[244:247], v[60:63]
    v_mfma_f32_16x16x32_bf16 v[64:67], v[148:151], v[244:247], v[64:67]
    v_mfma_f32_16x16x32_bf16 v[52:55], v[156:159], v[248:251], v[52:55]
    v_mfma_f32_16x16x32_bf16 v[56:59], v[160:163], v[248:251], v[56:59]
    v_mfma_f32_16x16x32_bf16 v[60:63], v[164:167], v[248:251], v[60:63]
    v_mfma_f32_16x16x32_bf16 v[64:67], v[168:171], v[248:251], v[64:67]
    v_mfma_f32_16x16x32_bf16 v[52:55], a[224:227], v[252:255], v[52:55]
    v_mfma_f32_16x16x32_bf16 v[56:59], a[228:231], v[252:255], v[56:59]
    v_mfma_f32_16x16x32_bf16 v[60:63], a[232:235], v[252:255], v[60:63]
    v_mfma_f32_16x16x32_bf16 v[64:67], a[236:239], v[252:255], v[64:67]
    s_nop 7
    s_nop 1
    s_branch FZ_SB0
FZ_RL1:
    buffer_load_dwordx2 v[70:71], v13, s[56:59], s25 offen sc1
    s_waitcnt vmcnt(0)
    v_cmp_u_f32 vcc, v70, v71
    s_cbranch_vccz FZ_RB1
    s_sub_u32 s61, s61, 1
    s_cbranch_scc0 FZ_RL1
    s_mov_b32 s61, 0
    s_branch FZ_RB1
FZ_SL1:
    buffer_load_dwordx4 a[240:243], v14, s[56:59], s7 offen offset:0 sc1
    buffer_load_dwordx4 a[244:247], v14, s[56:59], s7 offen offset:1024 sc1
    buffer_load_dwordx4 a[248:251], v14, s[56:59], s7 offen offset:2048 sc1
    buffer_load_dwordx4 a[252:255], v14, s[56:59], s7 offen offset:3072 sc1
    buffer_load_dwordx4 a[64:67], v14, s[56:59], s8 offen offset:0 sc1
    buffer_load_dwordx4 a[68:71], v14, s[56:59], s8 offen offset:1024 sc1
    buffer_load_dwordx4 a[72:75], v14, s[56:59], s8 offen offset:2048 sc1
    buffer_load_dwordx4 a[76:79], v14, s[56:59], s8 offen offset:3072 sc1
    buffer_load_dwordx4 a[80:83], v14, s[56:59], s9 offen offset:0 sc1
    buffer_load_dwordx4 a[84:87], v14, s[56:59], s9 offen offset:1024 sc1
    buffer_load_dwordx4 a[88:91], v14, s[56:59], s9 offen offset:2048 sc1
    buffer_load_dwordx4 a[92:95], v14, s[56:59], s9 offen offset:3072 sc1
    s_waitcnt vmcnt(0)
    v_mfma_f32_16x16x32_bf16 v[72:75], a[160:163], a[240:243], 0
    v_mfma_f32_16x16x32_bf16 v[72:75], a[180:183], a[244:247], v[72:75]
    v_mfma_f32_16x16x32_bf16 v[72:75], a[8:11], a[248:251], v[72:75]
    v_mfma_f32_16x16x32_bf16 v[72:75], a[28:31], a[252:255], v[72:75]
    v_mfma_f32_16x16x32_bf16 v[72:75], a[112:115], a[64:67], v[72:75]
    v_mfma_f32_16x16x32_bf16 v[72:75], a[132:135], a[68:71], v[72:75]
    v_mfma_f32_16x16x32_bf16 v[72:75], a[152:155], a[72:75], v[72:75]
    v_mfma_f32_16x16x32_bf16 v[72:75], v[188:191], a[76:79], v[72:75]
    v_mfma_f32_16x16x32_bf16 v[72:75], v[112:115], a[80:83], v[72:75]
    v_mfma_f32_16x16x32_bf16 v[72:75], v[132:135], a[84:87], v[72:75]
    v_mfma_f32_16x16x32_bf16 v[72:75], v[152:155], a[88:91], v[72:75]
    v_mfma_f32_16x16x32_bf16 v[72:75], v[172:175], a[92:95], v[72:75]
    s_nop 7
    s_nop 1
    v_cmp_u_f32 vcc, v72, v72
    s_cbranch_vccz FZ_SO1
    s_sub_u32 s61, s61, 1
    s_cbranch_scc0 FZ_SL1
    s_mov_b32 s61, 0
FZ_SO1:
    v_mfma_f32_16x16x32_bf16 v[76:79], a[164:167], a[240:243], 0
    v_mfma_f32_16x16x32_bf16 v[80:83], a[168:171], a[240:243], 0
    v_mfma_f32_16x16x32_bf16 v[84:87], a[172:175], a[240:243], 0
    v_mfma_f32_16x16x32_bf16 v[88:91], a[176:179], a[240:243], 0
    v_mfma_f32_16x16x32_bf16 v[76:79], a[184:187], a[244:247], v[76:79]
    v_mfma_f32_16x16x32_bf16 v[80:83], a[188:191], a[244:247], v[80:83]
    v_mfma_f32_16x16x32_bf16 v[84:87], a[0:3], a[244:247], v[84:87]
    v_mfma_f32_16x16x32_bf16 v[88:91], a[4:7], a[244:247], v[88:91]
    v_mfma_f32_16x16x32_bf16 v[76:79], a[12:15], a[248:251], v[76:79]
    v_mfma_f32_16x16x32_bf16 v[80:83], a[16:19], a[248:251], v[80:83]
    v_mfma_f32_16x16x32_bf16 v[84:87], a[20:23], a[248:251], v[84:87]
    v_mfma_f32_16x16x32_bf16 v[88:91], a[24:27], a[248:251], v[88:91]
    v_mfma_f32_16x16x32_bf16 v[76:79], a[96:99], a[252:255], v[76:79]
    v_mfma_f32_16x16x32_bf16 v[80:83], a[100:103], a[252:255], v[80:83]
    v_mfma_f32_16x16x32_bf16 v[84:87], a[104:107], a[252:255], v[84:87]
    v_mfma_f32_16x16x32_bf16 v[88:91], a[108:111], a[252:255], v[88:91]
    v_mfma_f32_16x16x32_bf16 v[76:79], a[116:119], a[64:67], v[76:79]
    v_mfma_f32_16x16x32_bf16 v[80:83], a[120:123], a[64:67], v[80:83]
    v_mfma_f32_16x16x32_bf16 v[84:87], a[124:127], a[64:67], v[84:87]
    v_mfma_f32_16x16x32_bf16 v[88:91], a[128:131], a[64:67], v[88:91]
    v_mfma_f32_16x16x32_bf16 v[76:79], a[136:139], a[68:71], v[76:79]
    v_mfma_f32_16x16x32_bf16 v[80:83], a[140:143], a[68:71], v[80:83]
    v_mfma_f32_16x16x32_bf16 v[84:87], a[144:147], a[68:71], v[84:87]
    v_mfma_f32_16x16x32_bf16 v[88:91], a[148:151], a[68:71], v[88:91]
    v_mfma_f32_16x16x32_bf16 v[76:79], a[156:159], a[72:75], v[76:79]
    v_mfma_f32_16x16x32_bf16 v[80:83], v[176:179], a[72:75], v[80:83]
    v_mfma_f32_16x16x32_bf16 v[84:87], v[180:183], a[72:75], v[84:87]
    v_mfma_f32_16x16x32_bf16 v[88:91], v[184:187], a[72:75], v[88:91]
    v_mfma_f32_16x16x32_bf16 v[76:79], v[192:195], a[76:79], v[76:79]
    v_mfma_f32_16x16x32_bf16 v[80:83], v[196:199], a[76:79], v[80:83]
    v_mfma_f32_16x16x32_bf16 v[84:87], v[200:203], a[76:79], v[84:87]
    v_mfma_f32_16x16x32_bf16 v[88:91], v[204:207], a[76:79], v[88:91]
    v_mfma_f32_16x16x32_bf16 v[76:79], v[116:119], a[80:83], v[76:79]
    v_mfma_f32_16x16x32_bf16 v[80:83], v[120:123], a[80:83], v[80:83]
    v_mfma_f32_16x16x32_bf16 v[84:87], v[124:127], a[80:83], v[84:87]
    v_mfma_f32_16x16x32_bf16 v[88:91], v[128:131], a[80:83], v[88:91]
    v_mfma_f32_16x16x32_bf16 v[76:79], v[136:139], a[84:87], v[76:79]
    v_mfma_f32_16x16x32_bf16 v[80:83], v[140:143], a[84:87], v[80:83]
    v_mfma_f32_16x16x32_bf16 v[84:87], v[144:147], a[84:87], v[84:87]
    v_mfma_f32_16x16x32_bf16 v[88:91], v[148:151], a[84:87], v[88:91]
    v_mfma_f32_16x16x32_bf16 v[76:79], v[156:159], a[88:91], v[76:79]
    v_mfma_f32_16x16x32_bf16 v[80:83], v[160:163], a[88:91], v[80:83]
    v_mfma_f32_16x16x32_bf16 v[84:87], v[164:167], a[88:91], v[84:87]
    v_mfma_f32_16x16x32_bf16 v[88:91], v[168:171], a[88:91], v[88:91]
    v_mfma_f32_16x16x32_bf16 v[76:79], a[224:227], a[92:95], v[76:79]
    v_mfma_f32_16x16x32_bf16 v[80:83], a[228:231], a[92:95], v[80:83]
    v_mfma_f32_16x16x32_bf16 v[84:87], a[232:235], a[92:95], v[84:87]
    v_mfma_f32_16x16x32_bf16 v[88:91], a[236:239], a[92:95], v[88:91]
    s_nop 7
    s_nop 1
    s_branch FZ_SB1
FZ_RL2:
    buffer_load_dwordx2 v[92:93], v13, s[56:59], s26 offen sc1
    s_waitcnt vmcnt(0)
    v_cmp_u_f32 vcc, v92, v93
    s_cbranch_vccz FZ_RB2
    s_sub_u32 s61, s61, 1
    s_cbranch_scc0 FZ_RL2
    s_mov_b32 s61, 0
    s_branch FZ_RB2
FZ_SL2:
    buffer_load_dwordx4 a[192:195], v14, s[56:59], s10 offen offset:0 sc1
    buffer_load_dwordx4 a[196:199], v14, s[56:59], s10 offen offset:1024 sc1
    buffer_load_dwordx4 a[200:203], v14, s[56:59], s10 offen offset:2048 sc1
    buffer_load_dwordx4 a[204:207], v14, s[56:59], s10 offen offset:3072 sc1
    buffer_load_dwordx4 a[208:211], v14, s[56:59], s11 offen offset:0 sc1
    buffer_load_dwordx4 a[212:215], v14, s[56:59], s11 offen offset:1024 sc1
    buffer_load_dwordx4 a[216:219], v14, s[56:59], s11 offen offset:2048 sc1
    buffer_load_dwordx4 a[220:223], v14, s[56:59], s11 offen offset:3072 sc1
    buffer_load_dwordx4 a[32:35], v14, s[56:59], s12 offen offset:0 sc1
    buffer_load_dwordx4 a[36:39], v14, s[56:59], s12 offen offset:1024 sc1
    buffer_load_dwordx4 a[40:43], v14, s[56:59], s12 offen offset:2048 sc1
    buffer_load_dwordx4 a[44:47], v14, s[56:59], s12 offen offset:3072 sc1
    s_waitcnt vmcnt(0)
    v_mfma_f32_16x16x32_bf16 v[48:51], a[160:163], a[192:195], 0
    v_mfma_f32_16x16x32_bf16 v[48:51], a[180:183], a[196:199], v[48:51]
    v_mfma_f32_16x16x32_bf16 v[48:51], a[8:11], a[200:203], v[48:51]
    v_mfma_f32_16x16x32_bf16 v[48:51], a[28:31], a[204:207], v[48:51]
    v_mfma_f32_16x16x32_bf16 v[48:51], a[112:115], a[208:211], v[48:51]
    v_mfma_f32_16x16x32_bf16 v[48:51], a[132:135], a[212:215], v[48:51]
    v_mfma_f32_16x16x32_bf16 v[48:51], a[152:155], a[216:219], v[48:51]
    v_mfma_f32_16x16x32_bf16 v[48:51], v[188:191], a[220:223], v[48:51]
    v_mfma_f32_16x16x32_bf16 v[48:51], v[112:115], a[32:35], v[48:51]
    v_mfma_f32_16x16x32_bf16 v[48:51], v[132:135], a[36:39], v[48:51]
    v_mfma_f32_16x16x32_bf16 v[48:51], v[152:155], a[40:43], v[48:51]
    v_mfma_f32_16x16x32_bf16 v[48:51], v[172:175], a[44:47], v[48:51]
    s_nop 7
    s_nop 1
    v_cmp_u_f32 vcc, v48, v48
    s_cbranch_vccz FZ_SO2
    s_sub_u32 s61, s61, 1
    s_cbranch_scc0 FZ_SL2
    s_mov_b32 s61, 0
FZ_SO2:
    v_mfma_f32_16x16x32_bf16 v[52:55], a[164:167], a[192:195], 0
    v_mfma_f32_16x16x32_bf16 v[56:59], a[168:171], a[192:195], 0
    v_mfma_f32_16x16x32_bf16 v[60:63], a[172:175], a[192:195], 0
    v_mfma_f32_16x16x32_bf16 v[64:67], a[176:179], a[192:195], 0
    v_mfma_f32_16x16x32_bf16 v[52:55], a[184:187], a[196:199], v[52:55]
    v_mfma_f32_16x16x32_bf16 v[56:59], a[188:191], a[196:199], v[56:59]
    v_mfma_f32_16x16x32_bf16 v[60:63], a[0:3], a[196:199], v[60:63]
    v_mfma_f32_16x16x32_bf16 v[64:67], a[4:7], a[196:199], v[64:67]
    v_mfma_f32_16x16x32_bf16 v[52:55], a[12:15], a[200:203], v[52:55]
    v_mfma_f32_16x16x32_bf16 v[56:59], a[16:19], a[200:203], v[56:59]
    v_mfma_f32_16x16x32_bf16 v[60:63], a[20:23], a[200:203], v[60:63]
    v_mfma_f32_16x16x32_bf16 v[64:67], a[24:27], a[200:203], v[64:67]
    v_mfma_f32_16x16x32_bf16 v[52:55], a[96:99], a[204:207], v[52:55]
    v_mfma_f32_16x16x32_bf16 v[56:59], a[100:103], a[204:207], v[56:59]
    v_mfma_f32_16x16x32_bf16 v[60:63], a[104:107], a[204:207], v[60:63]
    v_mfma_f32_16x16x32_bf16 v[64:67], a[108:111], a[204:207], v[64:67]
    v_mfma_f32_16x16x32_bf16 v[52:55], a[116:119], a[208:211], v[52:55]
    v_mfma_f32_16x16x32_bf16 v[56:59], a[120:123], a[208:211], v[56:59]
    v_mfma_f32_16x16x32_bf16 v[60:63], a[124:127], a[208:211], v[60:63]
    v_mfma_f32_16x16x32_bf16 v[64:67], a[128:131], a[208:211], v[64:67]
    v_mfma_f32_16x16x32_bf16 v[52:55], a[136:139], a[212:215], v[52:55]
    v_mfma_f32_16x16x32_bf16 v[56:59], a[140:143], a[212:215], v[56:59]
    v_mfma_f32_16x16x32_bf16 v[60:63], a[144:147], a[212:215], v[60:63]
    v_mfma_f32_16x16x32_bf16 v[64:67], a[148:151], a[212:215], v[64:67]
    v_mfma_f32_16x16x32_bf16 v[52:55], a[156:159], a[216:219], v[52:55]
    v_mfma_f32_16x16x32_bf16 v[56:59], v[176:179], a[216:219], v[56:59]
    v_mfma_f32_16x16x32_bf16 v[60:63], v[180:183], a[216:219], v[60:63]
    v_mfma_f32_16x16x32_bf16 v[64:67], v[184:187], a[216:219], v[64:67]
    v_mfma_f32_16x16x32_bf16 v[52:55], v[192:195], a[220:223], v[52:55]
    v_mfma_f32_16x16x32_bf16 v[56:59], v[196:199], a[220:223], v[56:59]
    v_mfma_f32_16x16x32_bf16 v[60:63], v[200:203], a[220:223], v[60:63]
    v_mfma_f32_16x16x32_bf16 v[64:67], v[204:207], a[220:223], v[64:67]
    v_mfma_f32_16x16x32_bf16 v[52:55], v[116:119], a[32:35], v[52:55]
    v_mfma_f32_16x16x32_bf16 v[56:59], v[120:123], a[32:35], v[56:59]
    v_mfma_f32_16x16x32_bf16 v[60:63], v[124:127], a[32:35], v[60:63]
    v_mfma_f32_16x16x32_bf16 v[64:67], v[128:131], a[32:35], v[64:67]
    v_mfma_f32_16x16x32_bf16 v[52:55], v[136:139], a[36:39], v[52:55]
    v_mfma_f32_16x16x32_bf16 v[56:59], v[140:143], a[36:39], v[56:59]
    v_mfma_f32_16x16x32_bf16 v[60:63], v[144:147], a[36:39], v[60:63]
    v_mfma_f32_16x16x32_bf16 v[64:67], v[148:151], a[36:39], v[64:67]
    v_mfma_f32_16x16x32_bf16 v[52:55], v[156:159], a[40:43], v[52:55]
    v_mfma_f32_16x16x32_bf16 v[56:59], v[160:163], a[40:43], v[56:59]
    v_mfma_f32_16x16x32_bf16 v[60:63], v[164:167], a[40:43], v[60:63]
    v_mfma_f32_16x16x32_bf16 v[64:67], v[168:171], a[40:43], v[64:67]
    v_mfma_f32_16x16x32_bf16 v[52:55], a[224:227], a[44:47], v[52:55]
    v_mfma_f32_16x16x32_bf16 v[56:59], a[228:231], a[44:47], v[56:59]
    v_mfma_f32_16x16x32_bf16 v[60:63], a[232:235], a[44:47], v[60:63]
    v_mfma_f32_16x16x32_bf16 v[64:67], a[236:239], a[44:47], v[64:67]
    s_nop 7
    s_nop 1
    s_branch FZ_SB2
FZ_RL3:
    buffer_load_dwordx2 v[94:95], v13, s[56:59], s27 offen sc1
    s_waitcnt vmcnt(0)
    v_cmp_u_f32 vcc, v94, v95
    s_cbranch_vccz FZ_RB3
    s_sub_u32 s61, s61, 1
    s_cbranch_scc0 FZ_RL3
    s_mov_b32 s61, 0
    s_branch FZ_RB3
FZ_SL3:
    buffer_load_dwordx4 v[208:211], v14, s[56:59], s13 offen offset:0 sc1
    buffer_load_dwordx4 v[212:215], v14, s[56:59], s13 offen offset:1024 sc1
    buffer_load_dwordx4 v[216:219], v14, s[56:59], s13 offen offset:2048 sc1
    buffer_load_dwordx4 v[220:223], v14, s[56:59], s13 offen offset:3072 sc1
    buffer_load_dwordx4 v[224:227], v14, s[56:59], s14 offen offset:0 sc1
    buffer_load_dwordx4 v[228:231], v14, s[56:59], s14 offen offset:1024 sc1
    buffer_load_dwordx4 v[232:235], v14, s[56:59], s14 offen offset:2048 sc1
    buffer_load_dwordx4 v[236:239], v14, s[56:59], s14 offen offset:3072 sc1
    buffer_load_dwordx4 v[240:243], v14, s[56:59], s15 offen offset:0 sc1
    buffer_load_dwordx4 v[244:247], v14, s[56:59], s15 offen offset:1024 sc1
    buffer_load_dwordx4 v[248:251], v14, s[56:59], s15 offen offset:2048 sc1
    buffer_load_dwordx4 v[252:255], v14, s[56:59], s15 offen offset:3072 sc1
    s_waitcnt vmcnt(0)
    v_mfma_f32_16x16x32_bf16 v[72:75], a[160:163], v[208:211], 0
    v_mfma_f32_16x16x32_bf16 v[72:75], a[180:183], v[212:215], v[72:75]
    v_mfma_f32_16x16x32_bf16 v[72:75], a[8:11], v[216:219], v[72:75]
    v_mfma_f32_16x16x32_bf16 v[72:75], a[28:31], v[220:223], v[72:75]
    v_mfma_f32_16x16x32_bf16 v[72:75], a[112:115], v[224:227], v[72:75]
    v_mfma_f32_16x16x32_bf16 v[72:75], a[132:135], v[228:231], v[72:75]
    v_mfma_f32_16x16x32_bf16 v[72:75], a[152:155], v[232:235], v[72:75]
    v_mfma_f32_16x16x32_bf16 v[72:75], v[188:191], v[236:239], v[72:75]
    v_mfma_f32_16x16x32_bf16 v[72:75], v[112:115], v[240:243], v[72:75]
    v_mfma_f32_16x16x32_bf16 v[72:75], v[132:135], v[244:247], v[72:75]
    v_mfma_f32_16x16x32_bf16 v[72:75], v[152:155], v[248:251], v[72:75]
    v_mfma_f32_16x16x32_bf16 v[72:75], v[172:175], v[252:255], v[72:75]
    s_nop 7
    s_nop 1
    v_cmp_u_f32 vcc, v72, v72
    s_cbranch_vccz FZ_SO3
    s_sub_u32 s61, s61, 1
    s_cbranch_scc0 FZ_SL3
    s_mov_b32 s61, 0
FZ_SO3:
    v_mfma_f32_16x16x32_bf16 v[76:79], a[164:167], v[208:211], 0
    v_mfma_f32_16x16x32_bf16 v[80:83], a[168:171], v[208:211], 0
    v_mfma_f32_16x16x32_bf16 v[84:87], a[172:175], v[208:211], 0
    v_mfma_f32_16x16x32_bf16 v[88:91], a[176:179], v[208:211], 0
    v_mfma_f32_16x16x32_bf16 v[76:79], a[184:187], v[212:215], v[76:79]
    v_mfma_f32_16x16x32_bf16 v[80:83], a[188:191], v[212:215], v[80:83]
    v_mfma_f32_16x16x32_bf16 v[84:87], a[0:3], v[212:215], v[84:87]
    v_mfma_f32_16x16x32_bf16 v[88:91], a[4:7], v[212:215], v[88:91]
    v_mfma_f32_16x16x32_bf16 v[76:79], a[12:15], v[216:219], v[76:79]
    v_mfma_f32_16x16x32_bf16 v[80:83], a[16:19], v[216:219], v[80:83]
    v_mfma_f32_16x16x32_bf16 v[84:87], a[20:23], v[216:219], v[84:87]
    v_mfma_f32_16x16x32_bf16 v[88:91], a[24:27], v[216:219], v[88:91]
    v_mfma_f32_16x16x32_bf16 v[76:79], a[96:99], v[220:223], v[76:79]
    v_mfma_f32_16x16x32_bf16 v[80:83], a[100:103], v[220:223], v[80:83]
    v_mfma_f32_16x16x32_bf16 v[84:87], a[104:107], v[220:223], v[84:87]
    v_mfma_f32_16x16x32_bf16 v[88:91], a[108:111], v[220:223], v[88:91]
    v_mfma_f32_16x16x32_bf16 v[76:79], a[116:119], v[224:227], v[76:79]
    v_mfma_f32_16x16x32_bf16 v[80:83], a[120:123], v[224:227], v[80:83]
    v_mfma_f32_16x16x32_bf16 v[84:87], a[124:127], v[224:227], v[84:87]
    v_mfma_f32_16x16x32_bf16 v[88:91], a[128:131], v[224:227], v[88:91]
    v_mfma_f32_16x16x32_bf16 v[76:79], a[136:139], v[228:231], v[76:79]
    v_mfma_f32_16x16x32_bf16 v[80:83], a[140:143], v[228:231], v[80:83]
    v_mfma_f32_16x16x32_bf16 v[84:87], a[144:147], v[228:231], v[84:87]
    v_mfma_f32_16x16x32_bf16 v[88:91], a[148:151], v[228:231], v[88:91]
    v_mfma_f32_16x16x32_bf16 v[76:79], a[156:159], v[232:235], v[76:79]
    v_mfma_f32_16x16x32_bf16 v[80:83], v[176:179], v[232:235], v[80:83]
    v_mfma_f32_16x16x32_bf16 v[84:87], v[180:183], v[232:235], v[84:87]
    v_mfma_f32_16x16x32_bf16 v[88:91], v[184:187], v[232:235], v[88:91]
    v_mfma_f32_16x16x32_bf16 v[76:79], v[192:195], v[236:239], v[76:79]
    v_mfma_f32_16x16x32_bf16 v[80:83], v[196:199], v[236:239], v[80:83]
    v_mfma_f32_16x16x32_bf16 v[84:87], v[200:203], v[236:239], v[84:87]
    v_mfma_f32_16x16x32_bf16 v[88:91], v[204:207], v[236:239], v[88:91]
    v_mfma_f32_16x16x32_bf16 v[76:79], v[116:119], v[240:243], v[76:79]
    v_mfma_f32_16x16x32_bf16 v[80:83], v[120:123], v[240:243], v[80:83]
    v_mfma_f32_16x16x32_bf16 v[84:87], v[124:127], v[240:243], v[84:87]
    v_mfma_f32_16x16x32_bf16 v[88:91], v[128:131], v[240:243], v[88:91]
    v_mfma_f32_16x16x32_bf16 v[76:79], v[136:139], v[244:247], v[76:79]
    v_mfma_f32_16x16x32_bf16 v[80:83], v[140:143], v[244:247], v[80:83]
    v_mfma_f32_16x16x32_bf16 v[84:87], v[144:147], v[244:247], v[84:87]
    v_mfma_f32_16x16x32_bf16 v[88:91], v[148:151], v[244:247], v[88:91]
    v_mfma_f32_16x16x32_bf16 v[76:79], v[156:159], v[248:251], v[76:79]
    v_mfma_f32_16x16x32_bf16 v[80:83], v[160:163], v[248:251], v[80:83]
    v_mfma_f32_16x16x32_bf16 v[84:87], v[164:167], v[248:251], v[84:87]
    v_mfma_f32_16x16x32_bf16 v[88:91], v[168:171], v[248:251], v[88:91]
    v_mfma_f32_16x16x32_bf16 v[76:79], a[224:227], v[252:255], v[76:79]
    v_mfma_f32_16x16x32_bf16 v[80:83], a[228:231], v[252:255], v[80:83]
    v_mfma_f32_16x16x32_bf16 v[84:87], a[232:235], v[252:255], v[84:87]
    v_mfma_f32_16x16x32_bf16 v[88:91], a[236:239], v[252:255], v[88:91]
    s_nop 7
    s_nop 1
    s_branch FZ_SB3
FZ_FIN:
FZ_END:
    s_endpgm
.section .rodata,"a"
.p2align 6
.amdhsa_kernel sequential_preLN__ssm_conv_h3__glu_gated_bilinear__prompt_kernel
  .amdhsa_next_free_vgpr 512
  .amdhsa_next_free_sgpr 64
  .amdhsa_accum_offset 256
  .amdhsa_group_segment_fixed_size 0
  .amdhsa_kernarg_size 104
  .amdhsa_user_sgpr_count 2
  .amdhsa_user_sgpr_kernarg_segment_ptr 1
  .amdhsa_system_sgpr_workgroup_id_x 1
  .amdhsa_float_denorm_mode_32 3
  .amdhsa_float_denorm_mode_16_64 3
.end_amdhsa_kernel
```
